```python
import torch

def _softmax(x, axis=-1):
    return torch.softmax(x, dim=axis)
def _gelu(x):
    return torch.nn.functional.gelu(x, approximate="tanh")
def _silu(x):
    return torch.nn.functional.silu(x)
def _sigmoid(x):
    return torch.sigmoid(x)
def _layernorm(x, axis=-1, eps=1e-5):
    m = x.mean(dim=axis, keepdim=True)
    v = x.var(dim=axis, keepdim=True, unbiased=False)
    return (x - m) / torch.sqrt(v + eps)
def _scatter_add(tgt, idx, src, axis=0):
    return tgt.clone().index_add_(axis, idx, src)
def _segment_sum(src, seg, n):
    out = torch.zeros((n,) + src.shape[1:], dtype=src.dtype)
    return out.index_add_(0, seg, src)
def _pad(x, pw):
    flat = tuple(v for pair in reversed(pw) for v in pair)
    return torch.nn.functional.pad(x, flat)

kernel_name = 'interleave_layers__softmax_full_mha__moe_arch_mod__prompt'

def setup_inputs():

    _w = (lambda a: (lambda t: t.to(torch.bfloat16) if t.is_floating_point() else t)(torch.as_tensor(a)))
    def _A_setup():
        B, S, D = 1, 2048, 512
        return {
            "x": _w((lambda *s: torch.randn(*s, dtype=torch.bfloat16) * 0.05)(B, S, D)),
            "wqkv": _w((lambda *s: torch.randn(*s, dtype=torch.bfloat16) * 0.05)(D, 3 * D)),
            "wo": _w((lambda *s: torch.randn(*s, dtype=torch.bfloat16) * 0.05)(D, D)),
        }
    _A_in = _A_setup()

    def _B_setup():
        B, S, D, F, C = 1, 2048, 512, 1792, 1
        return {
            "x": _w((lambda *s: torch.randn(*s, dtype=torch.bfloat16) * 0.05)(B, S, D)),
            "w_r": _w((lambda *s: torch.randn(*s, dtype=torch.bfloat16) * 0.05)(D)),
            "w_gate": _w((lambda *s: torch.randn(*s, dtype=torch.bfloat16) * 0.05)(D, F)),
            "w_up": _w((lambda *s: torch.randn(*s, dtype=torch.bfloat16) * 0.05)(D, F)),
            "w_down": _w((lambda *s: torch.randn(*s, dtype=torch.bfloat16) * 0.05)(F, D)),
        }
    _B_in = _B_setup()

    return {
        "A_x": _A_in["x"],
        "A_wqkv": _A_in["wqkv"],
        "A_wo": _A_in["wo"],
        "B_x": _B_in["x"],
        "B_w_r": _B_in["w_r"],
        "B_w_gate": _B_in["w_gate"],
        "B_w_up": _B_in["w_up"],
        "B_w_down": _B_in["w_down"],
    }

def reference(A_x, A_wqkv, A_wo, B_x, B_w_r, B_w_gate, B_w_up, B_w_down):
    def _A_ref(x, wqkv, wo):
        B, S, D = x.shape
        H = 32; Dh = D // H
        qkv = (lambda x, *d: x.permute(*d))((x @ wqkv).reshape(B, S, 3, H, Dh), 2, 0, 3, 1, 4)
        q, k, v = qkv[0], qkv[1], qkv[2]
        scale = Dh ** -0.5
        scores = torch.einsum("bhqd,bhkd->bhqk", q, k) * scale
        p = _softmax(scores, axis=-1)
        o = torch.einsum("bhqk,bhkd->bhqd", p, v)
        return (lambda x, *d: x.permute(*d))(o, 0, 2, 1, 3).reshape(B, S, D) @ wo

    def _B_ref(x, w_r, w_gate, w_up, w_down):
        B, S, D = x.shape
        C = 1
        r = x @ w_r
        idx = torch.argsort(-r, axis=-1)[:, :C]
        idx_e = (lambda x, n, axis: torch.repeat_interleave(x, n, dim=axis))(idx.reshape(B, C, 1), D, axis=2)
        x_sel = (lambda x, i, axis: torch.take_along_dim(x, i, dim=axis))(x, idx_e, axis=1)
        g = _silu(x_sel @ w_gate)
        u = x_sel @ w_up
        y = (g * u) @ w_down
        r_sel = _sigmoid((lambda x, i, axis: torch.take_along_dim(x, i, dim=axis))(r, idx, axis=1))
        y = y * r_sel.reshape(B, C, 1)
        b_off = (torch.arange(B) * S).reshape(B, 1)
        flat_idx = (idx + b_off).reshape(B * C)
        zero = (x * 0.0).reshape(B * S, D)
        upd = _scatter_add(zero, flat_idx, y.reshape(B * C, D), axis=0)
        return x + upd.reshape(B, S, D)

    x = A_x
    x = x + _A_ref(_layernorm(x, axis=-1), A_wqkv, A_wo)
    x = x + _B_ref(_layernorm(x, axis=-1), B_w_r, B_w_gate, B_w_up, B_w_down)
    x = x + _A_ref(_layernorm(x, axis=-1), A_wqkv, A_wo)
    x = x + _B_ref(_layernorm(x, axis=-1), B_w_r, B_w_gate, B_w_up, B_w_down)
    return x
```

```asm
; @launch grid=(256,1,1) block=(512,1,1) lds=157184
.amdgcn_target "amdgcn-amd-amdhsa--gfx950"
.text
.globl interleave_layers__softmax_full_mha__moe_arch_mod__prompt_kernel
.p2align 8
.type interleave_layers__softmax_full_mha__moe_arch_mod__prompt_kernel,@function
interleave_layers__softmax_full_mha__moe_arch_mod__prompt_kernel:
    s_cmp_ge_u32 s2, 256
    s_cbranch_scc1 L_exit
    s_load_dwordx4 s[4:7], s[0:1], 0
    s_load_dwordx2 s[8:9], s[0:1], 16
    s_load_dwordx2 s[10:11], s[0:1], 80
    s_load_dwordx8 s[12:19], s[0:1], 32
    s_load_dwordx2 s[20:21], s[0:1], 64
    v_and_b32 v1, 63, v0
    v_lshrrev_b32 v2, 6, v0
    v_lshlrev_b32 v3, 4, v1
    v_readfirstlane_b32 s24, v2
    s_and_b32 s23, s2, 7
    s_lshr_b32 s22, s2, 3
    s_lshl_b32 s25, s23, 3
    s_add_u32 s25, s25, s24
    s_lshl_b32 s26, s24, 10
    v_bfe_u32 v5, v1, 1, 2
    v_bfe_u32 v6, v1, 3, 1
    v_lshl_add_u32 v5, v6, 3, v5
    v_bfe_u32 v6, v1, 4, 1
    v_lshl_add_u32 v5, v6, 2, v5
    v_bfe_u32 v6, v1, 5, 1
    v_lshl_add_u32 v5, v6, 4, v5
    v_mul_u32_u24 v5, 3072, v5
    v_and_b32 v6, 1, v1
    v_lshl_add_u32 v5, v6, 4, v5
    s_lshl_b32 s45, s22, 5
    v_add_u32 v5, s45, v5
    v_lshrrev_b32 v8, 4, v1
    v_and_b32 v9, 7, v1
    v_xor_b32 v8, v8, v9
    v_lshlrev_b32 v8, 4, v8
    v_lshrrev_b32 v9, 3, v1
    v_lshl_add_u32 v8, v9, 10, v8
    s_lshl_b32 s44, s25, 15
    v_add_u32 v8, s44, v8
    v_xor_b32 v9, 64, v8
    v_add_u32 v9, 0x2000, v9
    s_mul_i32 s47, s24, 12288
    s_add_u32 s47, s47, 57344
    s_mul_i32 s48, s24, 12288
    s_add_u32 s48, s48, 61440
    s_cmp_eq_u32 s24, 7
    s_cselect_b32 s48, 0, s48
    s_mul_i32 s49, s24, 12288
    s_add_u32 s49, s49, 65536
    s_cmp_eq_u32 s24, 7
    s_cselect_b32 s49, 4096, s49
    s_and_b32 s50, s22, 3
    s_waitcnt lgkmcnt(0)
    v_mov_b32 v12, 0x12a2000
    global_load_dword v126, v12, s[10:11] sc0 sc1
    s_mul_i32 s44, s50, 12
    s_add_u32 s44, s44, s24
    s_add_u32 s44, s44, 0
    s_sub_u32 s45, s44, 48
    s_cmp_ge_u32 s44, 48
    s_cselect_b32 s44, s45, s44
    s_mul_i32 s45, s44, 21846
    s_lshr_b32 s45, s45, 16
    s_mul_i32 s46, s45, 3
    s_sub_u32 s44, s44, s46
    s_mul_i32 s46, s45, 98304
    s_lshl_b32 s40, s44, 10
    s_add_u32 s46, s46, s40
    s_add_u32 s40, s6, s46
    s_addc_u32 s41, s7, 0
    s_lshl_b32 s44, s44, 14
    s_lshl_b32 s45, s45, 10
    s_add_u32 s44, s44, s45
    s_add_u32 m0, s44, 8192
    s_nop 0
    global_load_lds_dwordx4 v5, s[40:41]
    s_add_u32 s44, s50, 0
    s_and_b32 s44, s44, 3
    s_lshl_b32 s44, s44, 8
    s_add_u32 s40, s4, s44
    s_addc_u32 s41, s5, 0
    s_add_u32 m0, s47, 0
    s_nop 0
    global_load_lds_dwordx4 v8, s[40:41]
    s_add_u32 m0, s47, 1024
    s_nop 0
    global_load_lds_dwordx4 v9, s[40:41]
    s_add_u32 s40, s40, 0x4000
    s_addc_u32 s41, s41, 0
    s_add_u32 m0, s47, 2048
    s_nop 0
    global_load_lds_dwordx4 v8, s[40:41]
    s_add_u32 m0, s47, 3072
    s_nop 0
    global_load_lds_dwordx4 v9, s[40:41]
    s_mul_i32 s44, s50, 12
    s_add_u32 s44, s44, s24
    s_add_u32 s44, s44, 8
    s_sub_u32 s45, s44, 48
    s_cmp_ge_u32 s44, 48
    s_cselect_b32 s44, s45, s44
    s_mul_i32 s45, s44, 21846
    s_lshr_b32 s45, s45, 16
    s_mul_i32 s46, s45, 3
    s_sub_u32 s44, s44, s46
    s_mul_i32 s46, s45, 98304
    s_lshl_b32 s40, s44, 10
    s_add_u32 s46, s46, s40
    s_add_u32 s40, s6, s46
    s_addc_u32 s41, s7, 0
    s_lshl_b32 s44, s44, 14
    s_lshl_b32 s45, s45, 10
    s_add_u32 s44, s44, s45
    s_add_u32 m0, s44, 8192
    s_nop 0
    global_load_lds_dwordx4 v5, s[40:41]
    s_add_u32 s44, s50, 0
    s_and_b32 s44, s44, 3
    s_lshl_b32 s44, s44, 8
    s_add_u32 s44, s44, 128
    s_add_u32 s40, s4, s44
    s_addc_u32 s41, s5, 0
    s_add_u32 m0, s48, 0
    s_nop 0
    global_load_lds_dwordx4 v8, s[40:41]
    s_add_u32 m0, s48, 1024
    s_nop 0
    global_load_lds_dwordx4 v9, s[40:41]
    s_add_u32 s40, s40, 0x4000
    s_addc_u32 s41, s41, 0
    s_add_u32 m0, s48, 2048
    s_nop 0
    global_load_lds_dwordx4 v8, s[40:41]
    s_add_u32 m0, s48, 3072
    s_nop 0
    global_load_lds_dwordx4 v9, s[40:41]
    s_mul_i32 s44, s50, 12
    s_add_u32 s44, s44, s24
    s_add_u32 s44, s44, 16
    s_sub_u32 s45, s44, 48
    s_cmp_ge_u32 s44, 48
    s_cselect_b32 s44, s45, s44
    s_mul_i32 s45, s44, 21846
    s_lshr_b32 s45, s45, 16
    s_mul_i32 s46, s45, 3
    s_sub_u32 s44, s44, s46
    s_mul_i32 s46, s45, 98304
    s_lshl_b32 s40, s44, 10
    s_add_u32 s46, s46, s40
    s_add_u32 s40, s6, s46
    s_addc_u32 s41, s7, 0
    s_lshl_b32 s44, s44, 14
    s_lshl_b32 s45, s45, 10
    s_add_u32 s44, s44, s45
    s_add_u32 m0, s44, 8192
    s_nop 0
    global_load_lds_dwordx4 v5, s[40:41]
    s_add_u32 s44, s50, 1
    s_and_b32 s44, s44, 3
    s_lshl_b32 s44, s44, 8
    s_add_u32 s40, s4, s44
    s_addc_u32 s41, s5, 0
    s_add_u32 m0, s49, 0
    s_nop 0
    global_load_lds_dwordx4 v8, s[40:41]
    s_add_u32 m0, s49, 1024
    s_nop 0
    global_load_lds_dwordx4 v9, s[40:41]
    s_add_u32 s40, s40, 0x4000
    s_addc_u32 s41, s41, 0
    s_add_u32 m0, s49, 2048
    s_nop 0
    global_load_lds_dwordx4 v8, s[40:41]
    s_add_u32 m0, s49, 3072
    s_nop 0
    global_load_lds_dwordx4 v9, s[40:41]
    s_mul_i32 s44, s50, 12
    s_add_u32 s44, s44, s24
    s_add_u32 s44, s44, 24
    s_sub_u32 s45, s44, 48
    s_cmp_ge_u32 s44, 48
    s_cselect_b32 s44, s45, s44
    s_mul_i32 s45, s44, 21846
    s_lshr_b32 s45, s45, 16
    s_mul_i32 s46, s45, 3
    s_sub_u32 s44, s44, s46
    s_mul_i32 s46, s45, 98304
    s_lshl_b32 s40, s44, 10
    s_add_u32 s46, s46, s40
    s_add_u32 s40, s6, s46
    s_addc_u32 s41, s7, 0
    s_lshl_b32 s44, s44, 14
    s_lshl_b32 s45, s45, 10
    s_add_u32 s44, s44, s45
    s_add_u32 m0, s44, 8192
    s_nop 0
    global_load_lds_dwordx4 v5, s[40:41]
    s_lshr_b32 s32, s22, 2
    s_and_b32 s33, s22, 3
    s_lshl_b32 s44, s23, 2
    s_add_u32 s33, s33, s44
    s_and_b32 s34, s24, 1
    s_lshr_b32 s35, s24, 1
    s_lshl_b32 s36, s33, 1
    s_add_u32 s36, s36, s34
    s_lshl_b32 s37, s32, 2
    s_add_u32 s37, s37, s35
    s_mul_i32 s3, s23, 28
    s_min_u32 s44, s22, 27
    s_add_u32 s3, s3, s44
    s_mov_b32 s27, 0x4e800000
    s_mov_b32 s63, 0x3f803f80
    s_mov_b32 s64, 0x3b000000
    s_mov_b32 s65, 0x3727c5ac
    v_and_b32 v6, 31, v1
    v_lshrrev_b32 v7, 5, v1
    v_bfe_u32 v12, v1, 2, 2
    v_lshl_add_u32 v12, v7, 4, v12
    v_bfe_u32 v13, v1, 4, 1
    v_lshl_add_u32 v12, v13, 2, v12
    v_and_b32 v13, 3, v1
    v_lshlrev_b32 v13, 3, v13
    v_lshl_add_u32 v10, v12, 5, v13
    v_add_u32 v10, 8192, v10
    v_bfe_u32 v12, v1, 1, 3
    v_and_b32 v13, 15, v1
    v_lshlrev_b32 v13, 7, v13
    v_lshrrev_b32 v14, 4, v1
    v_xor_b32 v14, v14, v12
    v_lshl_add_u32 v2, v14, 4, v13
    v_xor_b32 v4, 64, v2
    v_mov_b32 v92, s63
    v_mov_b32 v93, s63
    v_mov_b32 v94, s63
    v_mov_b32 v95, s63
    v_add_u32 v14, s47, v2
    v_add_u32 v15, s47, v4
    s_waitcnt vmcnt(11)
    ds_read_b128 a[0:3], v14 offset:0
    ds_read_b128 a[4:7], v14 offset:2048
    ds_read_b128 a[8:11], v15 offset:0
    ds_read_b128 a[12:15], v15 offset:2048
    s_waitcnt vmcnt(10)
    v_readfirstlane_b32 s31, v126
    s_mul_i32 s31, s31, 0x9E3779B1
    s_add_u32 s31, s31, 0x7F4A7C15
    s_barrier
    s_add_u32 s44, s50, 0
    s_and_b32 s44, s44, 3
    s_lshl_b32 s44, s44, 12
    v_add_u32 v11, s44, v10
    ds_read_b64_tr_b16 v[40:41], v11 offset:0
    ds_read_b64_tr_b16 v[42:43], v11 offset:256
    ds_read_b64_tr_b16 v[44:45], v11 offset:16384
    ds_read_b64_tr_b16 v[46:47], v11 offset:16640
    ds_read_b64_tr_b16 v[48:49], v11 offset:32768
    ds_read_b64_tr_b16 v[50:51], v11 offset:33024
    ds_read_b64_tr_b16 v[52:53], v11 offset:1024
    ds_read_b64_tr_b16 v[54:55], v11 offset:1280
    ds_read_b64_tr_b16 v[56:57], v11 offset:17408
    ds_read_b64_tr_b16 v[58:59], v11 offset:17664
    ds_read_b64_tr_b16 v[60:61], v11 offset:33792
    ds_read_b64_tr_b16 v[62:63], v11 offset:34048
    s_setprio 3
    v_add_u32 v14, s48, v2
    v_add_u32 v15, s48, v4
    s_waitcnt vmcnt(6)
    ds_read_b128 a[16:19], v14 offset:0
    ds_read_b128 a[20:23], v14 offset:2048
    ds_read_b128 a[24:27], v15 offset:0
    ds_read_b128 a[28:31], v15 offset:2048
    ds_read_b64_tr_b16 v[64:65], v11 offset:2048
    ds_read_b64_tr_b16 v[66:67], v11 offset:2304
    ds_read_b64_tr_b16 v[68:69], v11 offset:18432
    ds_read_b64_tr_b16 v[70:71], v11 offset:18688
    ds_read_b64_tr_b16 v[72:73], v11 offset:34816
    ds_read_b64_tr_b16 v[74:75], v11 offset:35072
    s_waitcnt lgkmcnt(15)
    v_mfma_f32_16x16x32_bf16 v[76:79], a[0:3], a[0:3], 0
    s_add_u32 s44, s50, 1
    s_and_b32 s44, s44, 3
    s_lshl_b32 s44, s44, 8
    s_add_u32 s44, s44, 128
    s_add_u32 s40, s4, s44
    v_mfma_f32_16x16x32_bf16 v[80:83], a[4:7], a[4:7], 0
    s_addc_u32 s41, s5, 0
    s_add_u32 m0, s47, 0
    s_nop 0
    global_load_lds_dwordx4 v8, s[40:41]
    s_add_u32 m0, s47, 1024
    v_mfma_f32_16x16x32_bf16 v[16:19], v[40:43], a[0:3], 0
    s_nop 0
    global_load_lds_dwordx4 v9, s[40:41]
    s_add_u32 s40, s40, 0x4000
    s_addc_u32 s41, s41, 0
    s_add_u32 m0, s47, 2048
    v_mfma_f32_16x16x32_bf16 v[20:23], v[40:43], a[4:7], 0
    s_nop 0
    global_load_lds_dwordx4 v8, s[40:41]
    s_add_u32 m0, s47, 3072
    s_nop 0
    global_load_lds_dwordx4 v9, s[40:41]
    v_mfma_f32_16x16x32_bf16 v[24:27], v[44:47], a[0:3], 0
    s_mul_i32 s44, s50, 12
    s_add_u32 s44, s44, s24
    s_add_u32 s44, s44, 32
    s_sub_u32 s45, s44, 48
    s_cmp_ge_u32 s44, 48
    v_mfma_f32_16x16x32_bf16 v[28:31], v[44:47], a[4:7], 0
    s_cselect_b32 s44, s45, s44
    s_mul_i32 s45, s44, 21846
    s_lshr_b32 s45, s45, 16
    s_mul_i32 s46, s45, 3
    s_sub_u32 s44, s44, s46
    v_mfma_f32_16x16x32_bf16 v[32:35], a[0:3], v[48:51], 0
    s_mul_i32 s46, s45, 98304
    s_lshl_b32 s40, s44, 10
    s_add_u32 s46, s46, s40
    s_add_u32 s40, s6, s46
    s_addc_u32 s41, s7, 0
    v_mfma_f32_16x16x32_bf16 v[36:39], a[4:7], v[48:51], 0
    s_lshl_b32 s44, s44, 14
    s_lshl_b32 s45, s45, 10
    s_add_u32 s44, s44, s45
    s_add_u32 m0, s44, 8192
    s_nop 0
    v_mfma_f32_16x16x32_bf16 v[84:87], v[92:95], a[0:3], 0
    global_load_lds_dwordx4 v5, s[40:41]
    v_mfma_f32_16x16x32_bf16 v[88:91], v[92:95], a[4:7], 0
    s_setprio 2
    ds_read_b64_tr_b16 v[40:41], v11 offset:3072
    ds_read_b64_tr_b16 v[42:43], v11 offset:3328
    ds_read_b64_tr_b16 v[44:45], v11 offset:19456
    ds_read_b64_tr_b16 v[46:47], v11 offset:19712
    ds_read_b64_tr_b16 v[48:49], v11 offset:35840
    ds_read_b64_tr_b16 v[50:51], v11 offset:36096
    s_waitcnt lgkmcnt(12)
    v_mfma_f32_16x16x32_bf16 v[76:79], a[8:11], a[8:11], v[76:79]
    s_add_u32 s44, s50, 2
    s_and_b32 s44, s44, 3
    v_mfma_f32_16x16x32_bf16 v[80:83], a[12:15], a[12:15], v[80:83]
    s_lshl_b32 s44, s44, 8
    s_add_u32 s40, s4, s44
    v_mfma_f32_16x16x32_bf16 v[16:19], v[52:55], a[8:11], v[16:19]
    s_addc_u32 s41, s5, 0
    s_add_u32 m0, s48, 0
    v_mfma_f32_16x16x32_bf16 v[20:23], v[52:55], a[12:15], v[20:23]
    s_nop 0
    global_load_lds_dwordx4 v8, s[40:41]
    v_mfma_f32_16x16x32_bf16 v[24:27], v[56:59], a[8:11], v[24:27]
    s_add_u32 m0, s48, 1024
    s_nop 0
    v_mfma_f32_16x16x32_bf16 v[28:31], v[56:59], a[12:15], v[28:31]
    global_load_lds_dwordx4 v9, s[40:41]
    s_add_u32 s40, s40, 0x4000
    v_mfma_f32_16x16x32_bf16 v[32:35], a[8:11], v[60:63], v[32:35]
    s_addc_u32 s41, s41, 0
    s_add_u32 m0, s48, 2048
    v_mfma_f32_16x16x32_bf16 v[36:39], a[12:15], v[60:63], v[36:39]
    s_nop 0
    global_load_lds_dwordx4 v8, s[40:41]
    v_mfma_f32_16x16x32_bf16 v[84:87], v[92:95], a[8:11], v[84:87]
    s_add_u32 m0, s48, 3072
    s_nop 0
    v_mfma_f32_16x16x32_bf16 v[88:91], v[92:95], a[12:15], v[88:91]
    global_load_lds_dwordx4 v9, s[40:41]
    s_setprio 1
    v_add_u32 v14, s49, v2
    v_add_u32 v15, s49, v4
    s_waitcnt vmcnt(10)
    ds_read_b128 a[32:35], v14 offset:0
    ds_read_b128 a[36:39], v14 offset:2048
    ds_read_b128 a[40:43], v15 offset:0
    ds_read_b128 a[44:47], v15 offset:2048
    s_add_u32 s44, s50, 1
    s_and_b32 s44, s44, 3
    s_lshl_b32 s44, s44, 12
    v_add_u32 v11, s44, v10
    ds_read_b64_tr_b16 v[52:53], v11 offset:0
    ds_read_b64_tr_b16 v[54:55], v11 offset:256
    ds_read_b64_tr_b16 v[56:57], v11 offset:16384
    ds_read_b64_tr_b16 v[58:59], v11 offset:16640
    ds_read_b64_tr_b16 v[60:61], v11 offset:32768
    ds_read_b64_tr_b16 v[62:63], v11 offset:33024
    s_waitcnt lgkmcnt(15)
    v_mfma_f32_16x16x32_bf16 v[76:79], a[16:19], a[16:19], v[76:79]
    s_mul_i32 s44, s50, 12
    s_add_u32 s44, s44, s24
    s_add_u32 s44, s44, 40
    v_mfma_f32_16x16x32_bf16 v[80:83], a[20:23], a[20:23], v[80:83]
    s_sub_u32 s45, s44, 48
    s_cmp_ge_u32 s44, 48
    s_cselect_b32 s44, s45, s44
    v_mfma_f32_16x16x32_bf16 v[16:19], v[64:67], a[16:19], v[16:19]
    s_mul_i32 s45, s44, 21846
    s_lshr_b32 s45, s45, 16
    s_mul_i32 s46, s45, 3
    v_mfma_f32_16x16x32_bf16 v[20:23], v[64:67], a[20:23], v[20:23]
    s_sub_u32 s44, s44, s46
    s_mul_i32 s46, s45, 98304
    s_lshl_b32 s40, s44, 10
    v_mfma_f32_16x16x32_bf16 v[24:27], v[68:71], a[16:19], v[24:27]
    s_add_u32 s46, s46, s40
    s_add_u32 s40, s6, s46
    s_addc_u32 s41, s7, 0
    v_mfma_f32_16x16x32_bf16 v[28:31], v[68:71], a[20:23], v[28:31]
    s_lshl_b32 s44, s44, 14
    s_lshl_b32 s45, s45, 10
    s_add_u32 s44, s44, s45
    v_mfma_f32_16x16x32_bf16 v[32:35], a[16:19], v[72:75], v[32:35]
    s_add_u32 m0, s44, 8192
    s_nop 0
    global_load_lds_dwordx4 v5, s[40:41]
    v_mfma_f32_16x16x32_bf16 v[36:39], a[20:23], v[72:75], v[36:39]
    v_mfma_f32_16x16x32_bf16 v[84:87], v[92:95], a[16:19], v[84:87]
    v_mfma_f32_16x16x32_bf16 v[88:91], v[92:95], a[20:23], v[88:91]
    s_setprio 3
    s_waitcnt vmcnt(10)
    s_barrier
    ds_read_b64_tr_b16 v[64:65], v11 offset:1024
    ds_read_b64_tr_b16 v[66:67], v11 offset:1280
    ds_read_b64_tr_b16 v[68:69], v11 offset:17408
    ds_read_b64_tr_b16 v[70:71], v11 offset:17664
    ds_read_b64_tr_b16 v[72:73], v11 offset:33792
    ds_read_b64_tr_b16 v[74:75], v11 offset:34048
    s_waitcnt lgkmcnt(12)
    v_mfma_f32_16x16x32_bf16 v[76:79], a[24:27], a[24:27], v[76:79]
    s_add_u32 s44, s50, 2
    s_and_b32 s44, s44, 3
    v_mfma_f32_16x16x32_bf16 v[80:83], a[28:31], a[28:31], v[80:83]
    s_lshl_b32 s44, s44, 8
    s_add_u32 s44, s44, 128
    v_mfma_f32_16x16x32_bf16 v[16:19], v[40:43], a[24:27], v[16:19]
    s_add_u32 s40, s4, s44
    s_addc_u32 s41, s5, 0
    v_mfma_f32_16x16x32_bf16 v[20:23], v[40:43], a[28:31], v[20:23]
    s_add_u32 m0, s49, 0
    s_nop 0
    v_mfma_f32_16x16x32_bf16 v[24:27], v[44:47], a[24:27], v[24:27]
    global_load_lds_dwordx4 v8, s[40:41]
    s_add_u32 m0, s49, 1024
    v_mfma_f32_16x16x32_bf16 v[28:31], v[44:47], a[28:31], v[28:31]
    s_nop 0
    global_load_lds_dwordx4 v9, s[40:41]
    v_mfma_f32_16x16x32_bf16 v[32:35], a[24:27], v[48:51], v[32:35]
    s_add_u32 s40, s40, 0x4000
    s_addc_u32 s41, s41, 0
    v_mfma_f32_16x16x32_bf16 v[36:39], a[28:31], v[48:51], v[36:39]
    s_add_u32 m0, s49, 2048
    s_nop 0
    v_mfma_f32_16x16x32_bf16 v[84:87], v[92:95], a[24:27], v[84:87]
    global_load_lds_dwordx4 v8, s[40:41]
    s_add_u32 m0, s49, 3072
    v_mfma_f32_16x16x32_bf16 v[88:91], v[92:95], a[28:31], v[88:91]
    s_nop 0
    global_load_lds_dwordx4 v9, s[40:41]
    v_add_u32 v14, s47, v2
    v_add_u32 v15, s47, v4
    s_waitcnt vmcnt(10)
    ds_read_b128 a[48:51], v14 offset:0
    ds_read_b128 a[52:55], v14 offset:2048
    ds_read_b128 a[56:59], v15 offset:0
    ds_read_b128 a[60:63], v15 offset:2048
    ds_read_b64_tr_b16 v[40:41], v11 offset:2048
    ds_read_b64_tr_b16 v[42:43], v11 offset:2304
    ds_read_b64_tr_b16 v[44:45], v11 offset:18432
    ds_read_b64_tr_b16 v[46:47], v11 offset:18688
    ds_read_b64_tr_b16 v[48:49], v11 offset:34816
    ds_read_b64_tr_b16 v[50:51], v11 offset:35072
    s_waitcnt lgkmcnt(15)
    v_mfma_f32_16x16x32_bf16 v[76:79], a[32:35], a[32:35], v[76:79]
    v_mfma_f32_16x16x32_bf16 v[80:83], a[36:39], a[36:39], v[80:83]
    v_mfma_f32_16x16x32_bf16 v[16:19], v[52:55], a[32:35], v[16:19]
    v_mfma_f32_16x16x32_bf16 v[20:23], v[52:55], a[36:39], v[20:23]
    v_mfma_f32_16x16x32_bf16 v[24:27], v[56:59], a[32:35], v[24:27]
    v_mfma_f32_16x16x32_bf16 v[28:31], v[56:59], a[36:39], v[28:31]
    v_mfma_f32_16x16x32_bf16 v[32:35], a[32:35], v[60:63], v[32:35]
    v_mfma_f32_16x16x32_bf16 v[36:39], a[36:39], v[60:63], v[36:39]
    v_mfma_f32_16x16x32_bf16 v[84:87], v[92:95], a[32:35], v[84:87]
    v_mfma_f32_16x16x32_bf16 v[88:91], v[92:95], a[36:39], v[88:91]
    s_setprio 2
    ds_read_b64_tr_b16 v[52:53], v11 offset:3072
    ds_read_b64_tr_b16 v[54:55], v11 offset:3328
    ds_read_b64_tr_b16 v[56:57], v11 offset:19456
    ds_read_b64_tr_b16 v[58:59], v11 offset:19712
    ds_read_b64_tr_b16 v[60:61], v11 offset:35840
    ds_read_b64_tr_b16 v[62:63], v11 offset:36096
    s_waitcnt lgkmcnt(12)
    v_mfma_f32_16x16x32_bf16 v[76:79], a[40:43], a[40:43], v[76:79]
    s_add_u32 s44, s50, 3
    s_and_b32 s44, s44, 3
    v_mfma_f32_16x16x32_bf16 v[80:83], a[44:47], a[44:47], v[80:83]
    s_lshl_b32 s44, s44, 8
    s_add_u32 s40, s4, s44
    v_mfma_f32_16x16x32_bf16 v[16:19], v[64:67], a[40:43], v[16:19]
    s_addc_u32 s41, s5, 0
    s_add_u32 m0, s47, 0
    v_mfma_f32_16x16x32_bf16 v[20:23], v[64:67], a[44:47], v[20:23]
    s_nop 0
    global_load_lds_dwordx4 v8, s[40:41]
    v_mfma_f32_16x16x32_bf16 v[24:27], v[68:71], a[40:43], v[24:27]
    s_add_u32 m0, s47, 1024
    s_nop 0
    v_mfma_f32_16x16x32_bf16 v[28:31], v[68:71], a[44:47], v[28:31]
    global_load_lds_dwordx4 v9, s[40:41]
    s_add_u32 s40, s40, 0x4000
    v_mfma_f32_16x16x32_bf16 v[32:35], a[40:43], v[72:75], v[32:35]
    s_addc_u32 s41, s41, 0
    s_add_u32 m0, s47, 2048
    v_mfma_f32_16x16x32_bf16 v[36:39], a[44:47], v[72:75], v[36:39]
    s_nop 0
    global_load_lds_dwordx4 v8, s[40:41]
    v_mfma_f32_16x16x32_bf16 v[84:87], v[92:95], a[40:43], v[84:87]
    s_add_u32 m0, s47, 3072
    s_nop 0
    v_mfma_f32_16x16x32_bf16 v[88:91], v[92:95], a[44:47], v[88:91]
    global_load_lds_dwordx4 v9, s[40:41]
    s_setprio 1
    v_add_u32 v14, s48, v2
    v_add_u32 v15, s48, v4
    s_waitcnt vmcnt(9)
    ds_read_b128 a[64:67], v14 offset:0
    ds_read_b128 a[68:71], v14 offset:2048
    ds_read_b128 a[72:75], v15 offset:0
    ds_read_b128 a[76:79], v15 offset:2048
    s_add_u32 s44, s50, 2
    s_and_b32 s44, s44, 3
    s_lshl_b32 s44, s44, 12
    v_add_u32 v11, s44, v10
    ds_read_b64_tr_b16 v[64:65], v11 offset:0
    ds_read_b64_tr_b16 v[66:67], v11 offset:256
    ds_read_b64_tr_b16 v[68:69], v11 offset:16384
    ds_read_b64_tr_b16 v[70:71], v11 offset:16640
    ds_read_b64_tr_b16 v[72:73], v11 offset:32768
    ds_read_b64_tr_b16 v[74:75], v11 offset:33024
    s_waitcnt lgkmcnt(15)
    v_mfma_f32_16x16x32_bf16 v[76:79], a[48:51], a[48:51], v[76:79]
    v_mfma_f32_16x16x32_bf16 v[80:83], a[52:55], a[52:55], v[80:83]
    v_mfma_f32_16x16x32_bf16 v[16:19], v[40:43], a[48:51], v[16:19]
    v_mfma_f32_16x16x32_bf16 v[20:23], v[40:43], a[52:55], v[20:23]
    v_mfma_f32_16x16x32_bf16 v[24:27], v[44:47], a[48:51], v[24:27]
    v_mfma_f32_16x16x32_bf16 v[28:31], v[44:47], a[52:55], v[28:31]
    v_mfma_f32_16x16x32_bf16 v[32:35], a[48:51], v[48:51], v[32:35]
    v_mfma_f32_16x16x32_bf16 v[36:39], a[52:55], v[48:51], v[36:39]
    v_mfma_f32_16x16x32_bf16 v[84:87], v[92:95], a[48:51], v[84:87]
    v_mfma_f32_16x16x32_bf16 v[88:91], v[92:95], a[52:55], v[88:91]
    s_setprio 0
    ds_read_b64_tr_b16 v[40:41], v11 offset:1024
    ds_read_b64_tr_b16 v[42:43], v11 offset:1280
    ds_read_b64_tr_b16 v[44:45], v11 offset:17408
    ds_read_b64_tr_b16 v[46:47], v11 offset:17664
    ds_read_b64_tr_b16 v[48:49], v11 offset:33792
    ds_read_b64_tr_b16 v[50:51], v11 offset:34048
    s_waitcnt lgkmcnt(12)
    v_mfma_f32_16x16x32_bf16 v[76:79], a[56:59], a[56:59], v[76:79]
    s_add_u32 s44, s50, 3
    s_and_b32 s44, s44, 3
    v_mfma_f32_16x16x32_bf16 v[80:83], a[60:63], a[60:63], v[80:83]
    s_lshl_b32 s44, s44, 8
    s_add_u32 s44, s44, 128
    v_mfma_f32_16x16x32_bf16 v[16:19], v[52:55], a[56:59], v[16:19]
    s_add_u32 s40, s4, s44
    s_addc_u32 s41, s5, 0
    v_mfma_f32_16x16x32_bf16 v[20:23], v[52:55], a[60:63], v[20:23]
    s_add_u32 m0, s48, 0
    s_nop 0
    v_mfma_f32_16x16x32_bf16 v[24:27], v[56:59], a[56:59], v[24:27]
    global_load_lds_dwordx4 v8, s[40:41]
    s_add_u32 m0, s48, 1024
    v_mfma_f32_16x16x32_bf16 v[28:31], v[56:59], a[60:63], v[28:31]
    s_nop 0
    global_load_lds_dwordx4 v9, s[40:41]
    v_mfma_f32_16x16x32_bf16 v[32:35], a[56:59], v[60:63], v[32:35]
    s_add_u32 s40, s40, 0x4000
    s_addc_u32 s41, s41, 0
    v_mfma_f32_16x16x32_bf16 v[36:39], a[60:63], v[60:63], v[36:39]
    s_add_u32 m0, s48, 2048
    s_nop 0
    v_mfma_f32_16x16x32_bf16 v[84:87], v[92:95], a[56:59], v[84:87]
    global_load_lds_dwordx4 v8, s[40:41]
    s_add_u32 m0, s48, 3072
    v_mfma_f32_16x16x32_bf16 v[88:91], v[92:95], a[60:63], v[88:91]
    s_nop 0
    global_load_lds_dwordx4 v9, s[40:41]
    s_setprio 3
    v_add_u32 v14, s49, v2
    v_add_u32 v15, s49, v4
    s_waitcnt vmcnt(8)
    ds_read_b128 a[80:83], v14 offset:0
    ds_read_b128 a[84:87], v14 offset:2048
    ds_read_b128 a[88:91], v15 offset:0
    ds_read_b128 a[92:95], v15 offset:2048
    s_waitcnt vmcnt(12)
    s_barrier
    ds_read_b64_tr_b16 v[52:53], v11 offset:2048
    ds_read_b64_tr_b16 v[54:55], v11 offset:2304
    ds_read_b64_tr_b16 v[56:57], v11 offset:18432
    ds_read_b64_tr_b16 v[58:59], v11 offset:18688
    ds_read_b64_tr_b16 v[60:61], v11 offset:34816
    ds_read_b64_tr_b16 v[62:63], v11 offset:35072
    s_waitcnt lgkmcnt(15)
    v_mfma_f32_16x16x32_bf16 v[76:79], a[64:67], a[64:67], v[76:79]
    v_mfma_f32_16x16x32_bf16 v[80:83], a[68:71], a[68:71], v[80:83]
    v_mfma_f32_16x16x32_bf16 v[16:19], v[64:67], a[64:67], v[16:19]
    v_mfma_f32_16x16x32_bf16 v[20:23], v[64:67], a[68:71], v[20:23]
    v_mfma_f32_16x16x32_bf16 v[24:27], v[68:71], a[64:67], v[24:27]
    v_mfma_f32_16x16x32_bf16 v[28:31], v[68:71], a[68:71], v[28:31]
    v_mfma_f32_16x16x32_bf16 v[32:35], a[64:67], v[72:75], v[32:35]
    v_mfma_f32_16x16x32_bf16 v[36:39], a[68:71], v[72:75], v[36:39]
    v_mfma_f32_16x16x32_bf16 v[84:87], v[92:95], a[64:67], v[84:87]
    v_mfma_f32_16x16x32_bf16 v[88:91], v[92:95], a[68:71], v[88:91]
    ds_read_b64_tr_b16 v[64:65], v11 offset:3072
    ds_read_b64_tr_b16 v[66:67], v11 offset:3328
    ds_read_b64_tr_b16 v[68:69], v11 offset:19456
    ds_read_b64_tr_b16 v[70:71], v11 offset:19712
    ds_read_b64_tr_b16 v[72:73], v11 offset:35840
    ds_read_b64_tr_b16 v[74:75], v11 offset:36096
    s_waitcnt lgkmcnt(12)
    v_mfma_f32_16x16x32_bf16 v[76:79], a[72:75], a[72:75], v[76:79]
    v_add_u32 v13, s26, v10
    v_mfma_f32_16x16x32_bf16 v[80:83], a[76:79], a[76:79], v[80:83]
    ds_read_b64_tr_b16 v[100:101], v13 offset:0
    v_mfma_f32_16x16x32_bf16 v[16:19], v[40:43], a[72:75], v[16:19]
    ds_read_b64_tr_b16 v[102:103], v13 offset:256
    v_mfma_f32_16x16x32_bf16 v[20:23], v[40:43], a[76:79], v[20:23]
    ds_read_b64_tr_b16 v[104:105], v13 offset:16384
    v_mfma_f32_16x16x32_bf16 v[24:27], v[44:47], a[72:75], v[24:27]
    ds_read_b64_tr_b16 v[106:107], v13 offset:16640
    v_mfma_f32_16x16x32_bf16 v[28:31], v[44:47], a[76:79], v[28:31]
    ds_read_b64_tr_b16 v[108:109], v13 offset:32768
    v_mfma_f32_16x16x32_bf16 v[32:35], a[72:75], v[48:51], v[32:35]
    ds_read_b64_tr_b16 v[110:111], v13 offset:33024
    v_mfma_f32_16x16x32_bf16 v[36:39], a[76:79], v[48:51], v[36:39]
    v_mfma_f32_16x16x32_bf16 v[84:87], v[92:95], a[72:75], v[84:87]
    v_mfma_f32_16x16x32_bf16 v[88:91], v[92:95], a[76:79], v[88:91]
    s_setprio 2
    v_add_u32 v14, s47, v2
    v_add_u32 v15, s47, v4
    s_waitcnt vmcnt(4)
    ds_read_b128 a[96:99], v14 offset:0
    ds_read_b128 a[100:103], v14 offset:2048
    ds_read_b128 a[104:107], v15 offset:0
    ds_read_b128 a[108:111], v15 offset:2048
    s_add_u32 s44, s50, 3
    s_and_b32 s44, s44, 3
    s_lshl_b32 s44, s44, 12
    v_add_u32 v11, s44, v10
    ds_read_b64_tr_b16 v[40:41], v11 offset:0
    ds_read_b64_tr_b16 v[42:43], v11 offset:256
    ds_read_b64_tr_b16 v[44:45], v11 offset:16384
    ds_read_b64_tr_b16 v[46:47], v11 offset:16640
    ds_read_b64_tr_b16 v[48:49], v11 offset:32768
    ds_read_b64_tr_b16 v[50:51], v11 offset:33024
    s_waitcnt lgkmcnt(15)
    v_mfma_f32_16x16x32_bf16 v[76:79], a[80:83], a[80:83], v[76:79]
    v_mfma_f32_16x16x32_bf16 v[80:83], a[84:87], a[84:87], v[80:83]
    v_mfma_f32_16x16x32_bf16 v[16:19], v[52:55], a[80:83], v[16:19]
    v_mfma_f32_16x16x32_bf16 v[20:23], v[52:55], a[84:87], v[20:23]
    v_mfma_f32_16x16x32_bf16 v[24:27], v[56:59], a[80:83], v[24:27]
    v_mfma_f32_16x16x32_bf16 v[28:31], v[56:59], a[84:87], v[28:31]
    v_mfma_f32_16x16x32_bf16 v[32:35], a[80:83], v[60:63], v[32:35]
    v_mfma_f32_16x16x32_bf16 v[36:39], a[84:87], v[60:63], v[36:39]
    v_mfma_f32_16x16x32_bf16 v[84:87], v[92:95], a[80:83], v[84:87]
    v_mfma_f32_16x16x32_bf16 v[88:91], v[92:95], a[84:87], v[88:91]
    s_waitcnt lgkmcnt(10)
    v_mfma_f32_16x16x32_bf16 v[96:99], v[100:103], v[92:95], 0
    v_mfma_f32_16x16x32_bf16 v[116:119], v[104:107], v[92:95], 0
    v_mfma_f32_16x16x32_bf16 v[120:123], v[92:95], v[108:111], 0
    ds_read_b64_tr_b16 v[100:101], v13 offset:8192
    ds_read_b64_tr_b16 v[102:103], v13 offset:8448
    ds_read_b64_tr_b16 v[104:105], v13 offset:24576
    ds_read_b64_tr_b16 v[106:107], v13 offset:24832
    ds_read_b64_tr_b16 v[108:109], v13 offset:40960
    ds_read_b64_tr_b16 v[110:111], v13 offset:41216
    s_setprio 1
    ds_read_b64_tr_b16 v[52:53], v11 offset:1024
    ds_read_b64_tr_b16 v[54:55], v11 offset:1280
    ds_read_b64_tr_b16 v[56:57], v11 offset:17408
    ds_read_b64_tr_b16 v[58:59], v11 offset:17664
    ds_read_b64_tr_b16 v[60:61], v11 offset:33792
    ds_read_b64_tr_b16 v[62:63], v11 offset:34048
    s_waitcnt lgkmcnt(12)
    v_mfma_f32_16x16x32_bf16 v[76:79], a[88:91], a[88:91], v[76:79]
    v_mfma_f32_16x16x32_bf16 v[80:83], a[92:95], a[92:95], v[80:83]
    v_mfma_f32_16x16x32_bf16 v[16:19], v[64:67], a[88:91], v[16:19]
    v_mfma_f32_16x16x32_bf16 v[20:23], v[64:67], a[92:95], v[20:23]
    v_mfma_f32_16x16x32_bf16 v[24:27], v[68:71], a[88:91], v[24:27]
    v_mfma_f32_16x16x32_bf16 v[28:31], v[68:71], a[92:95], v[28:31]
    v_mfma_f32_16x16x32_bf16 v[32:35], a[88:91], v[72:75], v[32:35]
    v_mfma_f32_16x16x32_bf16 v[36:39], a[92:95], v[72:75], v[36:39]
    v_mfma_f32_16x16x32_bf16 v[84:87], v[92:95], a[88:91], v[84:87]
    v_mfma_f32_16x16x32_bf16 v[88:91], v[92:95], a[92:95], v[88:91]
    s_waitcnt lgkmcnt(6)
    v_mfma_f32_16x16x32_bf16 v[96:99], v[100:103], v[92:95], v[96:99]
    v_mfma_f32_16x16x32_bf16 v[116:119], v[104:107], v[92:95], v[116:119]
    v_mfma_f32_16x16x32_bf16 v[120:123], v[92:95], v[108:111], v[120:123]
    s_setprio 0
    v_add_u32 v14, s48, v2
    v_add_u32 v15, s48, v4
    s_waitcnt vmcnt(0)
    ds_read_b128 a[112:115], v14 offset:0
    ds_read_b128 a[116:119], v14 offset:2048
    ds_read_b128 a[120:123], v15 offset:0
    ds_read_b128 a[124:127], v15 offset:2048
    ds_read_b64_tr_b16 v[64:65], v11 offset:2048
    ds_read_b64_tr_b16 v[66:67], v11 offset:2304
    ds_read_b64_tr_b16 v[68:69], v11 offset:18432
    ds_read_b64_tr_b16 v[70:71], v11 offset:18688
    ds_read_b64_tr_b16 v[72:73], v11 offset:34816
    ds_read_b64_tr_b16 v[74:75], v11 offset:35072
    s_waitcnt lgkmcnt(15)
    v_mfma_f32_16x16x32_bf16 v[76:79], a[96:99], a[96:99], v[76:79]
    s_lshl_b32 s44, s24, 8
    v_mfma_f32_16x16x32_bf16 v[80:83], a[100:103], a[100:103], v[80:83]
    s_add_u32 s44, s44, 152064
    v_mfma_f32_16x16x32_bf16 v[16:19], v[40:43], a[96:99], v[16:19]
    v_and_b32 v13, 48, v1
    v_mfma_f32_16x16x32_bf16 v[20:23], v[40:43], a[100:103], v[20:23]
    v_add_u32 v13, s44, v13
    v_mfma_f32_16x16x32_bf16 v[24:27], v[44:47], a[96:99], v[24:27]
    v_and_b32 v14, 15, v1
    v_mfma_f32_16x16x32_bf16 v[28:31], v[44:47], a[100:103], v[28:31]
    v_lshl_add_u32 v14, v14, 2, s44
    v_mfma_f32_16x16x32_bf16 v[32:35], a[96:99], v[48:51], v[32:35]
    ds_write_b32 v14, v120 offset:128
    v_mfma_f32_16x16x32_bf16 v[36:39], a[100:103], v[48:51], v[36:39]
    s_mov_b32 exec_lo, 0x00010001
    s_mov_b32 exec_hi, 0x00010001
    ds_write_b128 v13, v[96:99] offset:0
    ds_write_b128 v13, v[116:119] offset:64
    s_mov_b64 exec, -1
    v_mfma_f32_16x16x32_bf16 v[84:87], v[92:95], a[96:99], v[84:87]
    v_mfma_f32_16x16x32_bf16 v[88:91], v[92:95], a[100:103], v[88:91]
    s_setprio 3
    s_waitcnt lgkmcnt(0)
    s_barrier
    ds_read_b64_tr_b16 v[40:41], v11 offset:3072
    ds_read_b64_tr_b16 v[42:43], v11 offset:3328
    ds_read_b64_tr_b16 v[44:45], v11 offset:19456
    ds_read_b64_tr_b16 v[46:47], v11 offset:19712
    ds_read_b64_tr_b16 v[48:49], v11 offset:35840
    ds_read_b64_tr_b16 v[50:51], v11 offset:36096
    s_waitcnt lgkmcnt(12)
    v_mfma_f32_16x16x32_bf16 v[76:79], a[104:107], a[104:107], v[76:79]
    v_lshlrev_b32 v13, 2, v1
    v_add_u32 v14, 152064, v13
    v_mfma_f32_16x16x32_bf16 v[80:83], a[108:111], a[108:111], v[80:83]
    ds_read_b32 v104, v14 offset:0
    ds_read_b32 v105, v14 offset:256
    v_mfma_f32_16x16x32_bf16 v[84:87], v[92:95], a[104:107], v[84:87]
    ds_read_b32 v106, v14 offset:512
    ds_read_b32 v107, v14 offset:768
    v_mfma_f32_16x16x32_bf16 v[88:91], v[92:95], a[108:111], v[88:91]
    ds_read_b32 v108, v14 offset:1024
    ds_read_b32 v109, v14 offset:1280
    v_mfma_f32_16x16x32_bf16 v[76:79], a[112:115], a[112:115], v[76:79]
    ds_read_b32 v110, v14 offset:1536
    ds_read_b32 v111, v14 offset:1792
    v_mfma_f32_16x16x32_bf16 v[80:83], a[116:119], a[116:119], v[80:83]
    v_add_u32 v13, 149504, v13
    s_waitcnt lgkmcnt(0)
    v_mfma_f32_16x16x32_bf16 v[84:87], v[92:95], a[112:115], v[84:87]
    v_add_f32 v104, v104, v105
    v_add_f32 v106, v106, v107
    v_mfma_f32_16x16x32_bf16 v[88:91], v[92:95], a[116:119], v[88:91]
    v_add_f32 v108, v108, v109
    v_add_f32 v110, v110, v111
    v_mfma_f32_16x16x32_bf16 v[76:79], a[120:123], a[120:123], v[76:79]
    v_add_f32 v104, v104, v106
    v_add_f32 v108, v108, v110
    v_mfma_f32_16x16x32_bf16 v[80:83], a[124:127], a[124:127], v[80:83]
    v_add_f32 v104, v104, v108
    ds_write_b32 v13, v104
    v_mfma_f32_16x16x32_bf16 v[84:87], v[92:95], a[120:123], v[84:87]
    v_and_b32 v13, 11, v0
    v_mov_b32 v14, s63
    v_mfma_f32_16x16x32_bf16 v[88:91], v[92:95], a[124:127], v[88:91]
    v_cmp_eq_u32 vcc, 0, v13
    v_lshlrev_b32 v13, 4, v0
    v_mfma_f32_16x16x32_bf16 v[16:19], v[52:55], a[104:107], v[16:19]
    v_add_u32 v13, 131072, v13
    v_cndmask_b32 v100, 0, v14, vcc
    v_mfma_f32_16x16x32_bf16 v[20:23], v[52:55], a[108:111], v[20:23]
    v_mov_b32 v101, v100
    v_mov_b32 v102, v100
    v_mfma_f32_16x16x32_bf16 v[24:27], v[56:59], a[104:107], v[24:27]
    v_mov_b32 v103, v100
    ds_write_b128 v13, v[100:103]
    v_mfma_f32_16x16x32_bf16 v[28:31], v[56:59], a[108:111], v[28:31]
    v_cmp_gt_u32 vcc, 128, v0
    s_and_saveexec_b64 s[42:43], vcc
    ds_write_b128 v13, v[100:103] offset:8192
    s_mov_b64 exec, -1
    v_mfma_f32_16x16x32_bf16 v[32:35], a[104:107], v[60:63], v[32:35]
    v_mfma_f32_16x16x32_bf16 v[36:39], a[108:111], v[60:63], v[36:39]
    s_setprio 2
    s_waitcnt lgkmcnt(0)
    v_mfma_f32_16x16x32_bf16 v[16:19], v[64:67], a[112:115], v[16:19]
    s_mul_i32 s44, s24, 6144
    s_add_u32 s44, s44, 8192
    v_add_u32 v13, s44, v3
    ds_read_b128 a[88:91], v13 offset:0
    ds_read_b128 a[92:95], v13 offset:1024
    ds_read_b128 a[96:99], v13 offset:2048
    ds_read_b128 a[100:103], v13 offset:3072
    ds_read_b128 a[104:107], v13 offset:4096
    ds_read_b128 a[108:111], v13 offset:5120
    v_lshrrev_b32 v12, 4, v1
    v_mfma_f32_16x16x32_bf16 v[20:23], v[64:67], a[116:119], v[20:23]
    v_lshlrev_b32 v12, 2, v12
    v_and_b32 v13, 15, v1
    v_sub_u32 v12, v13, v12
    v_mov_b32 v92, 0
    v_mov_b32 v93, 0
    v_cmp_eq_u32 vcc, 0, v12
    s_nop 1
    v_cndmask_b32 v92, v92, v76, vcc
    v_cndmask_b32 v93, v93, v80, vcc
    v_cmp_eq_u32 vcc, 1, v12
    v_mfma_f32_16x16x32_bf16 v[24:27], v[68:71], a[112:115], v[24:27]
    s_nop 1
    v_cndmask_b32 v92, v92, v77, vcc
    v_cndmask_b32 v93, v93, v81, vcc
    v_cmp_eq_u32 vcc, 2, v12
    s_nop 1
    v_cndmask_b32 v92, v92, v78, vcc
    v_cndmask_b32 v93, v93, v82, vcc
    v_cmp_eq_u32 vcc, 3, v12
    s_nop 1
    v_cndmask_b32 v92, v92, v79, vcc
    v_mfma_f32_16x16x32_bf16 v[28:31], v[68:71], a[116:119], v[28:31]
    v_cndmask_b32 v93, v93, v83, vcc
    v_mov_b32 v12, v92
    s_nop 1
    v_permlane16_swap_b32 v92, v12
    v_add_f32 v92, v92, v12
    v_mov_b32 v12, v92
    s_nop 1
    v_permlane32_swap_b32 v92, v12
    v_add_f32 v92, v92, v12
    v_mov_b32 v12, v93
    v_mfma_f32_16x16x32_bf16 v[32:35], a[112:115], v[72:75], v[32:35]
    s_nop 1
    v_permlane16_swap_b32 v93, v12
    v_add_f32 v93, v93, v12
    v_mov_b32 v12, v93
    s_nop 1
    v_permlane32_swap_b32 v93, v12
    v_add_f32 v93, v93, v12
    v_mul_f32 v112, s64, v84
    v_mul_f32 v12, s64, v92
    v_fma_f32 v12, -v112, v112, v12
    v_mfma_f32_16x16x32_bf16 v[36:39], a[116:119], v[72:75], v[36:39]
    v_max_f32 v12, 0, v12
    v_add_f32 v113, s65, v12
    v_rsq_f32 v113, v113
    v_mul_f32 v114, s64, v88
    v_mul_f32 v12, s64, v93
    v_fma_f32 v12, -v114, v114, v12
    v_max_f32 v12, 0, v12
    v_add_f32 v115, s65, v12
    v_rsq_f32 v115, v115
    s_setprio 1
    v_mfma_f32_16x16x32_bf16 v[16:19], v[40:43], a[120:123], v[16:19]
    v_mfma_f32_16x16x32_bf16 v[20:23], v[40:43], a[124:127], v[20:23]
    v_mfma_f32_16x16x32_bf16 v[24:27], v[44:47], a[120:123], v[24:27]
    v_mfma_f32_16x16x32_bf16 v[28:31], v[44:47], a[124:127], v[28:31]
    v_mfma_f32_16x16x32_bf16 v[32:35], a[120:123], v[48:51], v[32:35]
    v_mfma_f32_16x16x32_bf16 v[36:39], a[124:127], v[48:51], v[36:39]
    s_lshl_b32 s44, s24, 8
    s_add_u32 s44, s44, 150016
    v_and_b32 v13, 15, v1
    v_lshl_add_u32 v12, v13, 2, s44
    ds_write_b32 v12, v112 offset:0
    ds_write_b32 v12, v113 offset:128
    ds_write_b32 v12, v114 offset:64
    ds_write_b32 v12, v115 offset:192
    v_and_b32 v14, 48, v1
    v_add_u32 v12, s44, v14
    ds_read_b128 v[76:79], v12 offset:0
    ds_read_b128 v[84:87], v12 offset:128
    ds_read_b128 v[80:83], v12 offset:64
    ds_read_b128 v[88:91], v12 offset:192
    v_add_u32 v12, 149504, v14
    ds_read_b128 v[96:99], v12 offset:0
    ds_read_b128 v[100:103], v12 offset:64
    v_lshlrev_b32 v12, 2, v13
    v_add_u32 v12, 149632, v12
    ds_read_b32 v108, v12
    s_add_u32 s52, s10, 0x400000
    s_addc_u32 s53, s11, 0
    s_add_u32 s54, s10, 0x600000
    s_addc_u32 s55, s11, 0
    s_add_u32 s56, s10, 0xc00000
    s_addc_u32 s57, s11, 0
    v_mul_f32 v13, 0x3eb8aa3b, v113
    v_mul_f32 v14, 0x3eb8aa3b, v115
    s_lshl_b32 s44, s22, 16
    s_lshl_b32 s45, s25, 10
    s_add_u32 s44, s44, s45
    v_add_u32 v4, s44, v3
    v_add_u32 v15, s26, v3
    v_add_u32 v5, 0x10000, v15
    s_waitcnt lgkmcnt(0)
    v_fma_f32 v24, -v112, v100, v24
    v_fma_f32 v25, -v112, v101, v25
    v_fma_f32 v26, -v112, v102, v26
    v_fma_f32 v27, -v112, v103, v27
    v_fma_f32 v28, -v114, v100, v28
    v_fma_f32 v29, -v114, v101, v29
    v_fma_f32 v30, -v114, v102, v30
    v_fma_f32 v31, -v114, v103, v31
    v_mul_f32 v24, v113, v24
    v_mul_f32 v25, v113, v25
    v_mul_f32 v26, v113, v26
    v_mul_f32 v27, v113, v27
    v_mul_f32 v28, v115, v28
    v_mul_f32 v29, v115, v29
    v_mul_f32 v30, v115, v30
    v_mul_f32 v31, v115, v31
    v_cvt_pk_bf16_f32 v64, v24, v25
    v_cvt_pk_bf16_f32 v65, v26, v27
    v_cvt_pk_bf16_f32 v66, v28, v29
    v_cvt_pk_bf16_f32 v67, v30, v31
    v_fma_f32 v16, -v112, v96, v16
    v_fma_f32 v17, -v112, v97, v17
    v_fma_f32 v18, -v112, v98, v18
    v_fma_f32 v19, -v112, v99, v19
    v_fma_f32 v20, -v114, v96, v20
    v_fma_f32 v21, -v114, v97, v21
    v_fma_f32 v22, -v114, v98, v22
    v_fma_f32 v23, -v114, v99, v23
    v_mul_f32 v16, v13, v16
    v_mul_f32 v17, v13, v17
    v_mul_f32 v18, v13, v18
    v_mul_f32 v19, v13, v19
    v_mul_f32 v20, v14, v20
    v_mul_f32 v21, v14, v21
    v_mul_f32 v22, v14, v22
    v_mul_f32 v23, v14, v23
    v_cvt_pk_bf16_f32 v104, v16, v17
    v_cvt_pk_bf16_f32 v105, v18, v19
    v_cvt_pk_bf16_f32 v106, v20, v21
    v_cvt_pk_bf16_f32 v107, v22, v23
    v_fma_f32 v32, -v76, v108, v32
    v_permlane16_swap_b32 v64, v66
    v_permlane16_swap_b32 v65, v67
    v_permlane16_swap_b32 v104, v106
    v_permlane16_swap_b32 v105, v107
    global_store_dwordx4 v4, v[64:67], s[52:53] sc1
    ds_write_b128 v15, v[64:67]
    v_mfma_f32_32x32x16_bf16 v[16:31], v[64:67], v[104:107], 0
    v_fma_f32 v33, -v77, v108, v33
    v_fma_f32 v34, -v78, v108, v34
    v_fma_f32 v35, -v79, v108, v35
    v_fma_f32 v36, -v80, v108, v36
    v_fma_f32 v37, -v81, v108, v37
    v_fma_f32 v38, -v82, v108, v38
    v_fma_f32 v39, -v83, v108, v39
    v_mul_f32 v32, v84, v32
    v_mul_f32 v33, v85, v33
    v_mul_f32 v34, v86, v34
    v_mul_f32 v35, v87, v35
    v_mul_f32 v36, v88, v36
    v_mul_f32 v37, v89, v37
    v_mul_f32 v38, v90, v38
    v_mul_f32 v39, v91, v39
    v_cvt_pk_bf16_f32 v68, v32, v33
    v_cvt_pk_bf16_f32 v69, v34, v35
    v_cvt_pk_bf16_f32 v70, v36, v37
    v_cvt_pk_bf16_f32 v71, v38, v39
    v_max3_f32 v2, v16, v17, v18
    v_max3_f32 v13, v19, v20, v21
    v_permlane32_swap_b32 v68, v70
    v_permlane32_swap_b32 v69, v71
    global_store_dwordx4 v4, v[68:71], s[54:55] sc1
    ds_write_b128 v5, v[68:71]
    s_cmp_ge_u32 s2, 224
    s_cbranch_scc1 L_nomark
    s_and_b32 s44, s24, 1
    s_lshl_b32 s44, s44, 4
    v_lshrrev_b32 v10, 2, v1
    v_add_u32 v10, s44, v10
    v_mul_u32_u24 v10, 14336, v10
    v_and_b32 v11, 3, v1
    v_lshl_add_u32 v10, v11, 4, v10
    s_lshr_b32 s44, s24, 1
    s_lshl_b32 s44, s44, 19
    s_lshl_b32 s45, s3, 6
    s_add_u32 s44, s44, s45
    s_add_u32 s44, s44, 0x1080000
    v_add_u32 v10, s44, v10
    v_mov_b32 v32, -1
    v_mov_b32 v33, -1
    v_mov_b32 v34, -1
    v_mov_b32 v35, -1
    global_store_dwordx4 v10, v[32:35], s[10:11] sc0 sc1
L_nomark:
    v_max3_f32 v2, v2, v22, v23
    v_max3_f32 v2, v2, v26, v27
    v_max3_f32 v2, v2, v30, v31
    v_max3_f32 v13, v13, v24, v25
    v_max3_f32 v13, v13, v28, v29
    v_max_f32 v2, v2, v13
    v_mov_b32 v13, v2
    s_nop 1
    v_permlane32_swap_b32 v2, v13
    v_max_f32 v2, v2, v13
    v_sub_f32 v72, 0, v2
    v_sub_f32 v73, 0, v2
    v_sub_f32 v74, 0, v2
    v_sub_f32 v75, 0, v2
    v_sub_f32 v76, 0, v2
    v_sub_f32 v77, 0, v2
    v_sub_f32 v78, 0, v2
    v_sub_f32 v79, 0, v2
    v_sub_f32 v80, 0, v2
    v_sub_f32 v81, 0, v2
    v_sub_f32 v82, 0, v2
    v_sub_f32 v83, 0, v2
    v_sub_f32 v84, 0, v2
    v_sub_f32 v85, 0, v2
    v_sub_f32 v86, 0, v2
    v_sub_f32 v87, 0, v2
    v_and_b32 v8, 15, v1
    v_bfe_u32 v9, v1, 4, 1
    v_lshlrev_b32 v10, 4, v8
    v_lshl_add_u32 v10, v7, 8, v10
    v_lshl_add_u32 v115, v9, 16, v10
    v_add_u32 v115, 0x10000, v115
    v_xor_b32 v9, 1, v9
    v_lshlrev_b32 v114, 13, v9
    v_mov_b32 v112, v3
    v_mov_b32 v113, v115
    s_mov_b32 s30, 0
    s_lshl_b32 s44, s22, 10
    s_add_u32 s44, s44, 0x1280000
    v_lshl_add_u32 v8, v1, 7, s44
    s_lshl_b32 s45, s23, 7
    s_add_u32 s44, s44, s45
    v_mov_b32 v9, s44
    s_waitcnt lgkmcnt(0)
    s_barrier
    ds_read_b128 v[108:111], v112
    ds_read_b128 v[56:59], v113
    ds_read_b128 v[60:63], v113 offset:512
    s_waitcnt lgkmcnt(0)
    v_mfma_f32_32x32x16_bf16 v[16:31], v[108:111], v[104:107], v[72:87]
    ds_read_b128 v[108:111], v112 offset:1024
    s_nop 10
    s_setprio 3
    v_exp_f32 v16, v16
    v_exp_f32 v17, v17
    v_exp_f32 v18, v18
    v_exp_f32 v19, v19
    v_exp_f32 v20, v20
    s_waitcnt lgkmcnt(0)
    v_exp_f32 v21, v21
    v_mfma_f32_32x32x16_bf16 v[32:47], v[108:111], v[104:107], v[72:87]
    v_exp_f32 v22, v22
    ds_read_b128 v[108:111], v112 offset:2048
    v_exp_f32 v23, v23
    ds_read_b128 v[64:67], v113 offset:1024
    v_cvt_pk_bf16_f32 v48, v16, v17
    v_cvt_pk_bf16_f32 v49, v18, v19
    v_cvt_pk_bf16_f32 v50, v20, v21
    v_cvt_pk_bf16_f32 v51, v22, v23
    v_exp_f32 v24, v24
    ds_read_b128 v[68:71], v113 offset:1536
    v_exp_f32 v25, v25
    v_mfma_f32_32x32x16_bf16 v[88:103], v[56:59], v[48:51], 0
    v_exp_f32 v26, v26
    v_exp_f32 v27, v27
    v_exp_f32 v28, v28
    v_exp_f32 v29, v29
    v_exp_f32 v30, v30
    v_exp_f32 v31, v31
    v_cvt_pk_bf16_f32 v52, v24, v25
    v_cvt_pk_bf16_f32 v53, v26, v27
    v_cvt_pk_bf16_f32 v54, v28, v29
    v_cvt_pk_bf16_f32 v55, v30, v31
    v_exp_f32 v32, v32
    v_exp_f32 v33, v33
    v_mfma_f32_32x32x16_bf16 v[88:103], v[60:63], v[52:55], v[88:103]
    s_waitcnt vmcnt(0)
    s_barrier
    s_cmp_lg_u32 s24, 0
    s_cbranch_scc1 L_l0_noflag
    v_mov_b32 v14, s31
    s_mov_b64 exec, 1
    global_store_dword v9, v14, s[10:11] sc0 sc1
    s_mov_b64 exec, -1
L_l0_noflag:
    v_exp_f32 v34, v34
    v_exp_f32 v35, v35
    v_exp_f32 v36, v36
    s_waitcnt lgkmcnt(0)
    v_exp_f32 v37, v37
    v_mfma_f32_32x32x16_bf16 v[16:31], v[108:111], v[104:107], v[72:87]
    v_exp_f32 v38, v38
    ds_read_b128 v[108:111], v112 offset:3072
    v_exp_f32 v39, v39
    ds_read_b128 v[56:59], v113 offset:2048
    v_cvt_pk_bf16_f32 v48, v32, v33
    v_cvt_pk_bf16_f32 v49, v34, v35
    v_cvt_pk_bf16_f32 v50, v36, v37
    v_cvt_pk_bf16_f32 v51, v38, v39
    v_exp_f32 v40, v40
    ds_read_b128 v[60:63], v113 offset:2560
    v_exp_f32 v41, v41
    v_mfma_f32_32x32x16_bf16 v[88:103], v[64:67], v[48:51], v[88:103]
    v_exp_f32 v42, v42
    v_exp_f32 v43, v43
    v_exp_f32 v44, v44
    v_exp_f32 v45, v45
    v_exp_f32 v46, v46
    v_exp_f32 v47, v47
    v_cvt_pk_bf16_f32 v52, v40, v41
    v_cvt_pk_bf16_f32 v53, v42, v43
    v_cvt_pk_bf16_f32 v54, v44, v45
    v_cvt_pk_bf16_f32 v55, v46, v47
    v_exp_f32 v16, v16
    v_exp_f32 v17, v17
    v_mfma_f32_32x32x16_bf16 v[88:103], v[68:71], v[52:55], v[88:103]
    v_exp_f32 v18, v18
    v_exp_f32 v19, v19
    v_exp_f32 v20, v20
    s_waitcnt lgkmcnt(0)
    v_exp_f32 v21, v21
    v_mfma_f32_32x32x16_bf16 v[32:47], v[108:111], v[104:107], v[72:87]
    v_exp_f32 v22, v22
    ds_read_b128 v[108:111], v112 offset:4096
    v_exp_f32 v23, v23
    ds_read_b128 v[64:67], v113 offset:3072
    v_cvt_pk_bf16_f32 v48, v16, v17
    v_cvt_pk_bf16_f32 v49, v18, v19
    v_cvt_pk_bf16_f32 v50, v20, v21
    v_cvt_pk_bf16_f32 v51, v22, v23
    v_exp_f32 v24, v24
    ds_read_b128 v[68:71], v113 offset:3584
    v_exp_f32 v25, v25
    v_mfma_f32_32x32x16_bf16 v[88:103], v[56:59], v[48:51], v[88:103]
    v_exp_f32 v26, v26
    v_exp_f32 v27, v27
    v_exp_f32 v28, v28
    v_exp_f32 v29, v29
    v_exp_f32 v30, v30
    v_exp_f32 v31, v31
    v_cvt_pk_bf16_f32 v52, v24, v25
    v_cvt_pk_bf16_f32 v53, v26, v27
    v_cvt_pk_bf16_f32 v54, v28, v29
    v_cvt_pk_bf16_f32 v55, v30, v31
    v_exp_f32 v32, v32
    v_exp_f32 v33, v33
    v_mfma_f32_32x32x16_bf16 v[88:103], v[60:63], v[52:55], v[88:103]
    v_exp_f32 v34, v34
    v_exp_f32 v35, v35
    v_exp_f32 v36, v36
    s_waitcnt lgkmcnt(0)
    v_exp_f32 v37, v37
    v_mfma_f32_32x32x16_bf16 v[16:31], v[108:111], v[104:107], v[72:87]
    v_exp_f32 v38, v38
    ds_read_b128 v[108:111], v112 offset:5120
    v_exp_f32 v39, v39
    ds_read_b128 v[56:59], v113 offset:4096
    v_cvt_pk_bf16_f32 v48, v32, v33
    v_cvt_pk_bf16_f32 v49, v34, v35
    v_cvt_pk_bf16_f32 v50, v36, v37
    v_cvt_pk_bf16_f32 v51, v38, v39
    v_exp_f32 v40, v40
    ds_read_b128 v[60:63], v113 offset:4608
    v_exp_f32 v41, v41
    v_mfma_f32_32x32x16_bf16 v[88:103], v[64:67], v[48:51], v[88:103]
    v_exp_f32 v42, v42
    v_exp_f32 v43, v43
    v_exp_f32 v44, v44
    v_exp_f32 v45, v45
    v_exp_f32 v46, v46
    v_exp_f32 v47, v47
    v_cvt_pk_bf16_f32 v52, v40, v41
    v_cvt_pk_bf16_f32 v53, v42, v43
    v_cvt_pk_bf16_f32 v54, v44, v45
    v_cvt_pk_bf16_f32 v55, v46, v47
    s_setprio 2
    v_exp_f32 v16, v16
    v_exp_f32 v17, v17
    v_mfma_f32_32x32x16_bf16 v[88:103], v[68:71], v[52:55], v[88:103]
    s_mov_b64 exec, 0xff
    global_load_dword v14, v8, s[10:11] sc0 sc1
    s_mov_b64 exec, -1
    v_exp_f32 v18, v18
    v_exp_f32 v19, v19
    v_exp_f32 v20, v20
    s_waitcnt lgkmcnt(0)
    v_exp_f32 v21, v21
    v_mfma_f32_32x32x16_bf16 v[32:47], v[108:111], v[104:107], v[72:87]
    v_exp_f32 v22, v22
    ds_read_b128 v[108:111], v112 offset:6144
    v_exp_f32 v23, v23
    ds_read_b128 v[64:67], v113 offset:5120
    v_cvt_pk_bf16_f32 v48, v16, v17
    v_cvt_pk_bf16_f32 v49, v18, v19
    v_cvt_pk_bf16_f32 v50, v20, v21
    v_cvt_pk_bf16_f32 v51, v22, v23
    v_exp_f32 v24, v24
    ds_read_b128 v[68:71], v113 offset:5632
    v_exp_f32 v25, v25
    v_mfma_f32_32x32x16_bf16 v[88:103], v[56:59], v[48:51], v[88:103]
    v_exp_f32 v26, v26
    v_exp_f32 v27, v27
    v_exp_f32 v28, v28
    v_exp_f32 v29, v29
    v_exp_f32 v30, v30
    v_exp_f32 v31, v31
    v_cvt_pk_bf16_f32 v52, v24, v25
    v_cvt_pk_bf16_f32 v53, v26, v27
    v_cvt_pk_bf16_f32 v54, v28, v29
    v_cvt_pk_bf16_f32 v55, v30, v31
    v_exp_f32 v32, v32
    v_exp_f32 v33, v33
    v_mfma_f32_32x32x16_bf16 v[88:103], v[60:63], v[52:55], v[88:103]
    s_mov_b64 exec, 0xff
    s_mov_b32 s29, 65536
    s_branch L_l0_pk_w
L_l0_pk:
L_l0_pk_l:
    global_load_dword v14, v8, s[10:11] sc0 sc1
L_l0_pk_w:
    s_waitcnt vmcnt(0)
    v_cmp_ne_u32 vcc, s31, v14
    s_sub_u32 s29, s29, 1
    s_cbranch_vccz L_l0_pk_ok
    s_cbranch_scc0 L_l0_pk
L_l0_pk_ok:
    s_mov_b64 exec, -1
    s_add_u32 s44, s23, 1
    s_and_b32 s44, s44, 7
    s_sub_u32 s44, s44, s23
    s_lshl_b32 s44, s44, 13
    v_add_u32 v13, s44, v4
    global_load_dwordx4 a[32:35], v13, s[52:53] sc1
    global_load_dwordx4 a[36:39], v13, s[54:55] sc1
    s_add_u32 s44, s23, 2
    s_and_b32 s44, s44, 7
    s_sub_u32 s44, s44, s23
    s_lshl_b32 s44, s44, 13
    v_add_u32 v13, s44, v4
    global_load_dwordx4 a[40:43], v13, s[52:53] sc1
    global_load_dwordx4 a[44:47], v13, s[54:55] sc1
    v_exp_f32 v34, v34
    v_exp_f32 v35, v35
    v_exp_f32 v36, v36
    s_waitcnt lgkmcnt(0)
    v_exp_f32 v37, v37
    v_mfma_f32_32x32x16_bf16 v[16:31], v[108:111], v[104:107], v[72:87]
    v_exp_f32 v38, v38
    ds_read_b128 v[108:111], v112 offset:7168
    v_exp_f32 v39, v39
    ds_read_b128 v[56:59], v113 offset:6144
    v_cvt_pk_bf16_f32 v48, v32, v33
    v_cvt_pk_bf16_f32 v49, v34, v35
    v_cvt_pk_bf16_f32 v50, v36, v37
    v_cvt_pk_bf16_f32 v51, v38, v39
    v_exp_f32 v40, v40
    ds_read_b128 v[60:63], v113 offset:6656
    v_exp_f32 v41, v41
    v_mfma_f32_32x32x16_bf16 v[88:103], v[64:67], v[48:51], v[88:103]
    v_exp_f32 v42, v42
    v_exp_f32 v43, v43
    v_exp_f32 v44, v44
    v_exp_f32 v45, v45
    v_exp_f32 v46, v46
    v_exp_f32 v47, v47
    v_cvt_pk_bf16_f32 v52, v40, v41
    v_cvt_pk_bf16_f32 v53, v42, v43
    v_cvt_pk_bf16_f32 v54, v44, v45
    v_cvt_pk_bf16_f32 v55, v46, v47
    s_setprio 1
    v_exp_f32 v16, v16
    v_exp_f32 v17, v17
    v_mfma_f32_32x32x16_bf16 v[88:103], v[68:71], v[52:55], v[88:103]
    v_exp_f32 v18, v18
    v_exp_f32 v19, v19
    v_exp_f32 v20, v20
    s_waitcnt lgkmcnt(0)
    v_exp_f32 v21, v21
    v_mfma_f32_32x32x16_bf16 v[32:47], v[108:111], v[104:107], v[72:87]
    v_exp_f32 v22, v22
    v_exp_f32 v23, v23
    ds_read_b128 v[64:67], v113 offset:7168
    v_cvt_pk_bf16_f32 v48, v16, v17
    v_cvt_pk_bf16_f32 v49, v18, v19
    v_cvt_pk_bf16_f32 v50, v20, v21
    v_cvt_pk_bf16_f32 v51, v22, v23
    v_exp_f32 v24, v24
    ds_read_b128 v[68:71], v113 offset:7680
    v_exp_f32 v25, v25
    v_mfma_f32_32x32x16_bf16 v[88:103], v[56:59], v[48:51], v[88:103]
    v_exp_f32 v26, v26
    v_exp_f32 v27, v27
    v_exp_f32 v28, v28
    v_exp_f32 v29, v29
    v_exp_f32 v30, v30
    v_exp_f32 v31, v31
    v_cvt_pk_bf16_f32 v52, v24, v25
    v_cvt_pk_bf16_f32 v53, v26, v27
    v_cvt_pk_bf16_f32 v54, v28, v29
    v_cvt_pk_bf16_f32 v55, v30, v31
    s_setprio 0
    v_exp_f32 v32, v32
    v_exp_f32 v33, v33
    v_mfma_f32_32x32x16_bf16 v[88:103], v[60:63], v[52:55], v[88:103]
    v_exp_f32 v34, v34
    v_exp_f32 v35, v35
    v_exp_f32 v36, v36
    s_waitcnt lgkmcnt(0)
    v_exp_f32 v37, v37
    v_exp_f32 v38, v38
    v_exp_f32 v39, v39
    v_cvt_pk_bf16_f32 v48, v32, v33
    v_cvt_pk_bf16_f32 v49, v34, v35
    v_cvt_pk_bf16_f32 v50, v36, v37
    v_cvt_pk_bf16_f32 v51, v38, v39
    v_exp_f32 v40, v40
    v_exp_f32 v41, v41
    v_mfma_f32_32x32x16_bf16 v[88:103], v[64:67], v[48:51], v[88:103]
    v_exp_f32 v42, v42
    v_exp_f32 v43, v43
    v_exp_f32 v44, v44
    v_exp_f32 v45, v45
    v_exp_f32 v46, v46
    v_exp_f32 v47, v47
    v_cvt_pk_bf16_f32 v52, v40, v41
    v_cvt_pk_bf16_f32 v53, v42, v43
    v_cvt_pk_bf16_f32 v54, v44, v45
    v_cvt_pk_bf16_f32 v55, v46, v47
    v_add_u32 v112, 0x2000, v112
    v_add_u32 v113, v114, v113
    s_waitcnt vmcnt(2)
    ds_write_b128 v15, a[32:35] offset:8192
    ds_write_b128 v5, a[36:39] offset:8192
    s_waitcnt lgkmcnt(0)
    s_barrier
    ds_read_b128 v[108:111], v112
    ds_read_b128 v[56:59], v113
    ds_read_b128 v[60:63], v113 offset:512
    s_waitcnt lgkmcnt(0)
    v_mfma_f32_32x32x16_bf16 v[16:31], v[108:111], v[104:107], v[72:87]
    ds_read_b128 v[108:111], v112 offset:1024
    s_nop 10
    s_setprio 3
    v_exp_f32 v16, v16
    v_exp_f32 v17, v17
    v_mfma_f32_32x32x16_bf16 v[88:103], v[68:71], v[52:55], v[88:103]
    s_add_u32 s44, s23, 3
    s_and_b32 s44, s44, 7
    s_sub_u32 s44, s44, s23
    s_lshl_b32 s44, s44, 13
    v_add_u32 v13, s44, v4
    global_load_dwordx4 a[48:51], v13, s[52:53] sc1
    global_load_dwordx4 a[52:55], v13, s[54:55] sc1
    v_exp_f32 v18, v18
    v_exp_f32 v19, v19
    v_exp_f32 v20, v20
    s_waitcnt lgkmcnt(0)
    v_exp_f32 v21, v21
    v_mfma_f32_32x32x16_bf16 v[32:47], v[108:111], v[104:107], v[72:87]
    v_exp_f32 v22, v22
    ds_read_b128 v[108:111], v112 offset:2048
    v_exp_f32 v23, v23
    ds_read_b128 v[64:67], v113 offset:1024
    v_cvt_pk_bf16_f32 v48, v16, v17
    v_cvt_pk_bf16_f32 v49, v18, v19
    v_cvt_pk_bf16_f32 v50, v20, v21
    v_cvt_pk_bf16_f32 v51, v22, v23
    v_exp_f32 v24, v24
    ds_read_b128 v[68:71], v113 offset:1536
    v_exp_f32 v25, v25
    v_mfma_f32_32x32x16_bf16 v[88:103], v[56:59], v[48:51], v[88:103]
    v_exp_f32 v26, v26
    v_exp_f32 v27, v27
    v_exp_f32 v28, v28
    v_exp_f32 v29, v29
    v_exp_f32 v30, v30
    v_exp_f32 v31, v31
    v_cvt_pk_bf16_f32 v52, v24, v25
    v_cvt_pk_bf16_f32 v53, v26, v27
    v_cvt_pk_bf16_f32 v54, v28, v29
    v_cvt_pk_bf16_f32 v55, v30, v31
    v_exp_f32 v32, v32
    v_exp_f32 v33, v33
    v_mfma_f32_32x32x16_bf16 v[88:103], v[60:63], v[52:55], v[88:103]
    v_exp_f32 v34, v34
    v_exp_f32 v35, v35
    v_exp_f32 v36, v36
    s_waitcnt lgkmcnt(0)
    v_exp_f32 v37, v37
    v_mfma_f32_32x32x16_bf16 v[16:31], v[108:111], v[104:107], v[72:87]
    v_exp_f32 v38, v38
    ds_read_b128 v[108:111], v112 offset:3072
    v_exp_f32 v39, v39
    ds_read_b128 v[56:59], v113 offset:2048
    v_cvt_pk_bf16_f32 v48, v32, v33
    v_cvt_pk_bf16_f32 v49, v34, v35
    v_cvt_pk_bf16_f32 v50, v36, v37
    v_cvt_pk_bf16_f32 v51, v38, v39
    v_exp_f32 v40, v40
    ds_read_b128 v[60:63], v113 offset:2560
    v_exp_f32 v41, v41
    v_mfma_f32_32x32x16_bf16 v[88:103], v[64:67], v[48:51], v[88:103]
    v_exp_f32 v42, v42
    v_exp_f32 v43, v43
    v_exp_f32 v44, v44
    v_exp_f32 v45, v45
    v_exp_f32 v46, v46
    v_exp_f32 v47, v47
    v_cvt_pk_bf16_f32 v52, v40, v41
    v_cvt_pk_bf16_f32 v53, v42, v43
    v_cvt_pk_bf16_f32 v54, v44, v45
    v_cvt_pk_bf16_f32 v55, v46, v47
    v_exp_f32 v16, v16
    v_exp_f32 v17, v17
    v_mfma_f32_32x32x16_bf16 v[88:103], v[68:71], v[52:55], v[88:103]
    v_exp_f32 v18, v18
    v_exp_f32 v19, v19
    v_exp_f32 v20, v20
    s_waitcnt lgkmcnt(0)
    v_exp_f32 v21, v21
    v_mfma_f32_32x32x16_bf16 v[32:47], v[108:111], v[104:107], v[72:87]
    v_exp_f32 v22, v22
    ds_read_b128 v[108:111], v112 offset:4096
    v_exp_f32 v23, v23
    ds_read_b128 v[64:67], v113 offset:3072
    v_cvt_pk_bf16_f32 v48, v16, v17
    v_cvt_pk_bf16_f32 v49, v18, v19
    v_cvt_pk_bf16_f32 v50, v20, v21
    v_cvt_pk_bf16_f32 v51, v22, v23
    v_exp_f32 v24, v24
    ds_read_b128 v[68:71], v113 offset:3584
    v_exp_f32 v25, v25
    v_mfma_f32_32x32x16_bf16 v[88:103], v[56:59], v[48:51], v[88:103]
    v_exp_f32 v26, v26
    v_exp_f32 v27, v27
    v_exp_f32 v28, v28
    v_exp_f32 v29, v29
    v_exp_f32 v30, v30
    v_exp_f32 v31, v31
    v_cvt_pk_bf16_f32 v52, v24, v25
    v_cvt_pk_bf16_f32 v53, v26, v27
    v_cvt_pk_bf16_f32 v54, v28, v29
    v_cvt_pk_bf16_f32 v55, v30, v31
    s_setprio 2
    v_exp_f32 v32, v32
    v_exp_f32 v33, v33
    v_mfma_f32_32x32x16_bf16 v[88:103], v[60:63], v[52:55], v[88:103]
    s_add_u32 s44, s23, 4
    s_and_b32 s44, s44, 7
    s_sub_u32 s44, s44, s23
    s_lshl_b32 s44, s44, 13
    v_add_u32 v13, s44, v4
    global_load_dwordx4 a[56:59], v13, s[52:53] sc1
    global_load_dwordx4 a[60:63], v13, s[54:55] sc1
    v_exp_f32 v34, v34
    v_exp_f32 v35, v35
    v_exp_f32 v36, v36
    s_waitcnt lgkmcnt(0)
    v_exp_f32 v37, v37
    v_mfma_f32_32x32x16_bf16 v[16:31], v[108:111], v[104:107], v[72:87]
    v_exp_f32 v38, v38
    ds_read_b128 v[108:111], v112 offset:5120
    v_exp_f32 v39, v39
    ds_read_b128 v[56:59], v113 offset:4096
    v_cvt_pk_bf16_f32 v48, v32, v33
    v_cvt_pk_bf16_f32 v49, v34, v35
    v_cvt_pk_bf16_f32 v50, v36, v37
    v_cvt_pk_bf16_f32 v51, v38, v39
    v_exp_f32 v40, v40
    ds_read_b128 v[60:63], v113 offset:4608
    v_exp_f32 v41, v41
    v_mfma_f32_32x32x16_bf16 v[88:103], v[64:67], v[48:51], v[88:103]
    v_exp_f32 v42, v42
    v_exp_f32 v43, v43
    v_exp_f32 v44, v44
    v_exp_f32 v45, v45
    v_exp_f32 v46, v46
    v_exp_f32 v47, v47
    v_cvt_pk_bf16_f32 v52, v40, v41
    v_cvt_pk_bf16_f32 v53, v42, v43
    v_cvt_pk_bf16_f32 v54, v44, v45
    v_cvt_pk_bf16_f32 v55, v46, v47
    s_setprio 1
    v_exp_f32 v16, v16
    v_exp_f32 v17, v17
    v_mfma_f32_32x32x16_bf16 v[88:103], v[68:71], v[52:55], v[88:103]
    s_waitcnt vmcnt(4)
    ds_write_b128 v15, a[40:43] offset:16384
    ds_write_b128 v5, a[44:47] offset:16384
    v_exp_f32 v18, v18
    v_exp_f32 v19, v19
    v_exp_f32 v20, v20
    s_waitcnt lgkmcnt(0)
    v_exp_f32 v21, v21
    v_mfma_f32_32x32x16_bf16 v[32:47], v[108:111], v[104:107], v[72:87]
    v_exp_f32 v22, v22
    ds_read_b128 v[108:111], v112 offset:6144
    v_exp_f32 v23, v23
    ds_read_b128 v[64:67], v113 offset:5120
    v_cvt_pk_bf16_f32 v48, v16, v17
    v_cvt_pk_bf16_f32 v49, v18, v19
    v_cvt_pk_bf16_f32 v50, v20, v21
    v_cvt_pk_bf16_f32 v51, v22, v23
    v_exp_f32 v24, v24
    ds_read_b128 v[68:71], v113 offset:5632
    v_exp_f32 v25, v25
    v_mfma_f32_32x32x16_bf16 v[88:103], v[56:59], v[48:51], v[88:103]
    v_exp_f32 v26, v26
    v_exp_f32 v27, v27
    v_exp_f32 v28, v28
    v_exp_f32 v29, v29
    v_exp_f32 v30, v30
    v_exp_f32 v31, v31
    v_cvt_pk_bf16_f32 v52, v24, v25
    v_cvt_pk_bf16_f32 v53, v26, v27
    v_cvt_pk_bf16_f32 v54, v28, v29
    v_cvt_pk_bf16_f32 v55, v30, v31
    s_setprio 0
    v_exp_f32 v32, v32
    v_exp_f32 v33, v33
    v_mfma_f32_32x32x16_bf16 v[88:103], v[60:63], v[52:55], v[88:103]
    v_exp_f32 v34, v34
    v_exp_f32 v35, v35
    v_exp_f32 v36, v36
    s_waitcnt lgkmcnt(0)
    v_exp_f32 v37, v37
    v_mfma_f32_32x32x16_bf16 v[16:31], v[108:111], v[104:107], v[72:87]
    v_exp_f32 v38, v38
    ds_read_b128 v[108:111], v112 offset:7168
    v_exp_f32 v39, v39
    ds_read_b128 v[56:59], v113 offset:6144
    v_cvt_pk_bf16_f32 v48, v32, v33
    v_cvt_pk_bf16_f32 v49, v34, v35
    v_cvt_pk_bf16_f32 v50, v36, v37
    v_cvt_pk_bf16_f32 v51, v38, v39
    v_exp_f32 v40, v40
    ds_read_b128 v[60:63], v113 offset:6656
    v_exp_f32 v41, v41
    v_mfma_f32_32x32x16_bf16 v[88:103], v[64:67], v[48:51], v[88:103]
    v_exp_f32 v42, v42
    v_exp_f32 v43, v43
    v_exp_f32 v44, v44
    v_exp_f32 v45, v45
    v_exp_f32 v46, v46
    v_exp_f32 v47, v47
    v_cvt_pk_bf16_f32 v52, v40, v41
    v_cvt_pk_bf16_f32 v53, v42, v43
    v_cvt_pk_bf16_f32 v54, v44, v45
    v_cvt_pk_bf16_f32 v55, v46, v47
    s_setprio 3
    v_exp_f32 v16, v16
    v_exp_f32 v17, v17
    v_mfma_f32_32x32x16_bf16 v[88:103], v[68:71], v[52:55], v[88:103]
    s_waitcnt lgkmcnt(0)
    s_barrier
    v_exp_f32 v18, v18
    v_exp_f32 v19, v19
    v_exp_f32 v20, v20
    s_waitcnt lgkmcnt(0)
    v_exp_f32 v21, v21
    v_mfma_f32_32x32x16_bf16 v[32:47], v[108:111], v[104:107], v[72:87]
    v_exp_f32 v22, v22
    ds_read_b128 v[108:111], v112 offset:8192
    v_exp_f32 v23, v23
    ds_read_b128 v[64:67], v113 offset:7168
    v_cvt_pk_bf16_f32 v48, v16, v17
    v_cvt_pk_bf16_f32 v49, v18, v19
    v_cvt_pk_bf16_f32 v50, v20, v21
    v_cvt_pk_bf16_f32 v51, v22, v23
    v_exp_f32 v24, v24
    ds_read_b128 v[68:71], v113 offset:7680
    v_exp_f32 v25, v25
    v_mfma_f32_32x32x16_bf16 v[88:103], v[56:59], v[48:51], v[88:103]
    v_exp_f32 v26, v26
    v_exp_f32 v27, v27
    v_exp_f32 v28, v28
    v_exp_f32 v29, v29
    v_exp_f32 v30, v30
    v_exp_f32 v31, v31
    v_cvt_pk_bf16_f32 v52, v24, v25
    v_cvt_pk_bf16_f32 v53, v26, v27
    v_cvt_pk_bf16_f32 v54, v28, v29
    v_cvt_pk_bf16_f32 v55, v30, v31
    v_exp_f32 v32, v32
    v_exp_f32 v33, v33
    v_mfma_f32_32x32x16_bf16 v[88:103], v[60:63], v[52:55], v[88:103]
    v_exp_f32 v34, v34
    v_exp_f32 v35, v35
    v_exp_f32 v36, v36
    s_waitcnt lgkmcnt(0)
    v_exp_f32 v37, v37
    v_mfma_f32_32x32x16_bf16 v[16:31], v[108:111], v[104:107], v[72:87]
    v_exp_f32 v38, v38
    ds_read_b128 v[108:111], v112 offset:9216
    v_exp_f32 v39, v39
    ds_read_b128 v[56:59], v113 offset:8192
    v_cvt_pk_bf16_f32 v48, v32, v33
    v_cvt_pk_bf16_f32 v49, v34, v35
    v_cvt_pk_bf16_f32 v50, v36, v37
    v_cvt_pk_bf16_f32 v51, v38, v39
    v_exp_f32 v40, v40
    ds_read_b128 v[60:63], v113 offset:8704
    v_exp_f32 v41, v41
    v_mfma_f32_32x32x16_bf16 v[88:103], v[64:67], v[48:51], v[88:103]
    v_exp_f32 v42, v42
    v_exp_f32 v43, v43
    v_exp_f32 v44, v44
    v_exp_f32 v45, v45
    v_exp_f32 v46, v46
    v_exp_f32 v47, v47
    v_cvt_pk_bf16_f32 v52, v40, v41
    v_cvt_pk_bf16_f32 v53, v42, v43
    v_cvt_pk_bf16_f32 v54, v44, v45
    v_cvt_pk_bf16_f32 v55, v46, v47
    v_add_u32 v112, 0x2000, v112
    v_add_u32 v113, v114, v113
    v_exp_f32 v16, v16
    v_exp_f32 v17, v17
    v_mfma_f32_32x32x16_bf16 v[88:103], v[68:71], v[52:55], v[88:103]
    s_add_u32 s44, s23, 5
    s_and_b32 s44, s44, 7
    s_sub_u32 s44, s44, s23
    s_lshl_b32 s44, s44, 13
    v_add_u32 v13, s44, v4
    global_load_dwordx4 a[64:67], v13, s[52:53] sc1
    global_load_dwordx4 a[68:71], v13, s[54:55] sc1
    v_exp_f32 v18, v18
    v_exp_f32 v19, v19
    v_exp_f32 v20, v20
    s_waitcnt lgkmcnt(0)
    v_exp_f32 v21, v21
    v_mfma_f32_32x32x16_bf16 v[32:47], v[108:111], v[104:107], v[72:87]
    v_exp_f32 v22, v22
    ds_read_b128 v[108:111], v112 offset:2048
    v_exp_f32 v23, v23
    ds_read_b128 v[64:67], v113 offset:1024
    v_cvt_pk_bf16_f32 v48, v16, v17
    v_cvt_pk_bf16_f32 v49, v18, v19
    v_cvt_pk_bf16_f32 v50, v20, v21
    v_cvt_pk_bf16_f32 v51, v22, v23
    v_exp_f32 v24, v24
    ds_read_b128 v[68:71], v113 offset:1536
    v_exp_f32 v25, v25
    v_mfma_f32_32x32x16_bf16 v[88:103], v[56:59], v[48:51], v[88:103]
    v_exp_f32 v26, v26
    v_exp_f32 v27, v27
    v_exp_f32 v28, v28
    v_exp_f32 v29, v29
    v_exp_f32 v30, v30
    v_exp_f32 v31, v31
    v_cvt_pk_bf16_f32 v52, v24, v25
    v_cvt_pk_bf16_f32 v53, v26, v27
    v_cvt_pk_bf16_f32 v54, v28, v29
    v_cvt_pk_bf16_f32 v55, v30, v31
    v_exp_f32 v32, v32
    v_exp_f32 v33, v33
    v_mfma_f32_32x32x16_bf16 v[88:103], v[60:63], v[52:55], v[88:103]
    v_exp_f32 v34, v34
    v_exp_f32 v35, v35
    v_exp_f32 v36, v36
    s_waitcnt lgkmcnt(0)
    v_exp_f32 v37, v37
    v_mfma_f32_32x32x16_bf16 v[16:31], v[108:111], v[104:107], v[72:87]
    v_exp_f32 v38, v38
    ds_read_b128 v[108:111], v112 offset:3072
    v_exp_f32 v39, v39
    ds_read_b128 v[56:59], v113 offset:2048
    v_cvt_pk_bf16_f32 v48, v32, v33
    v_cvt_pk_bf16_f32 v49, v34, v35
    v_cvt_pk_bf16_f32 v50, v36, v37
    v_cvt_pk_bf16_f32 v51, v38, v39
    v_exp_f32 v40, v40
    ds_read_b128 v[60:63], v113 offset:2560
    v_exp_f32 v41, v41
    v_mfma_f32_32x32x16_bf16 v[88:103], v[64:67], v[48:51], v[88:103]
    v_exp_f32 v42, v42
    v_exp_f32 v43, v43
    v_exp_f32 v44, v44
    v_exp_f32 v45, v45
    v_exp_f32 v46, v46
    v_exp_f32 v47, v47
    v_cvt_pk_bf16_f32 v52, v40, v41
    v_cvt_pk_bf16_f32 v53, v42, v43
    v_cvt_pk_bf16_f32 v54, v44, v45
    v_cvt_pk_bf16_f32 v55, v46, v47
    s_setprio 2
    v_exp_f32 v16, v16
    v_exp_f32 v17, v17
    v_mfma_f32_32x32x16_bf16 v[88:103], v[68:71], v[52:55], v[88:103]
    v_exp_f32 v18, v18
    v_exp_f32 v19, v19
    v_exp_f32 v20, v20
    s_waitcnt lgkmcnt(0)
    v_exp_f32 v21, v21
    v_mfma_f32_32x32x16_bf16 v[32:47], v[108:111], v[104:107], v[72:87]
    v_exp_f32 v22, v22
    ds_read_b128 v[108:111], v112 offset:4096
    v_exp_f32 v23, v23
    ds_read_b128 v[64:67], v113 offset:3072
    v_cvt_pk_bf16_f32 v48, v16, v17
    v_cvt_pk_bf16_f32 v49, v18, v19
    v_cvt_pk_bf16_f32 v50, v20, v21
    v_cvt_pk_bf16_f32 v51, v22, v23
    v_exp_f32 v24, v24
    ds_read_b128 v[68:71], v113 offset:3584
    v_exp_f32 v25, v25
    v_mfma_f32_32x32x16_bf16 v[88:103], v[56:59], v[48:51], v[88:103]
    v_exp_f32 v26, v26
    v_exp_f32 v27, v27
    v_exp_f32 v28, v28
    v_exp_f32 v29, v29
    v_exp_f32 v30, v30
    v_exp_f32 v31, v31
    v_cvt_pk_bf16_f32 v52, v24, v25
    v_cvt_pk_bf16_f32 v53, v26, v27
    v_cvt_pk_bf16_f32 v54, v28, v29
    v_cvt_pk_bf16_f32 v55, v30, v31
    v_exp_f32 v32, v32
    v_exp_f32 v33, v33
    v_mfma_f32_32x32x16_bf16 v[88:103], v[60:63], v[52:55], v[88:103]
    s_add_u32 s44, s23, 6
    s_and_b32 s44, s44, 7
    s_sub_u32 s44, s44, s23
    s_lshl_b32 s44, s44, 13
    v_add_u32 v13, s44, v4
    global_load_dwordx4 a[72:75], v13, s[52:53] sc1
    global_load_dwordx4 a[76:79], v13, s[54:55] sc1
    v_exp_f32 v34, v34
    v_exp_f32 v35, v35
    v_exp_f32 v36, v36
    s_waitcnt lgkmcnt(0)
    v_exp_f32 v37, v37
    v_mfma_f32_32x32x16_bf16 v[16:31], v[108:111], v[104:107], v[72:87]
    v_exp_f32 v38, v38
    ds_read_b128 v[108:111], v112 offset:5120
    v_exp_f32 v39, v39
    ds_read_b128 v[56:59], v113 offset:4096
    v_cvt_pk_bf16_f32 v48, v32, v33
    v_cvt_pk_bf16_f32 v49, v34, v35
    v_cvt_pk_bf16_f32 v50, v36, v37
    v_cvt_pk_bf16_f32 v51, v38, v39
    v_exp_f32 v40, v40
    ds_read_b128 v[60:63], v113 offset:4608
    v_exp_f32 v41, v41
    v_mfma_f32_32x32x16_bf16 v[88:103], v[64:67], v[48:51], v[88:103]
    v_exp_f32 v42, v42
    v_exp_f32 v43, v43
    v_exp_f32 v44, v44
    v_exp_f32 v45, v45
    v_exp_f32 v46, v46
    v_exp_f32 v47, v47
    v_cvt_pk_bf16_f32 v52, v40, v41
    v_cvt_pk_bf16_f32 v53, v42, v43
    v_cvt_pk_bf16_f32 v54, v44, v45
    v_cvt_pk_bf16_f32 v55, v46, v47
    s_setprio 1
    v_exp_f32 v16, v16
    v_exp_f32 v17, v17
    v_mfma_f32_32x32x16_bf16 v[88:103], v[68:71], v[52:55], v[88:103]
    s_waitcnt vmcnt(6)
    ds_write_b128 v15, a[48:51] offset:24576
    ds_write_b128 v5, a[52:55] offset:24576
    v_exp_f32 v18, v18
    v_exp_f32 v19, v19
    v_exp_f32 v20, v20
    s_waitcnt lgkmcnt(0)
    v_exp_f32 v21, v21
    v_mfma_f32_32x32x16_bf16 v[32:47], v[108:111], v[104:107], v[72:87]
    v_exp_f32 v22, v22
    ds_read_b128 v[108:111], v112 offset:6144
    v_exp_f32 v23, v23
    ds_read_b128 v[64:67], v113 offset:5120
    v_cvt_pk_bf16_f32 v48, v16, v17
    v_cvt_pk_bf16_f32 v49, v18, v19
    v_cvt_pk_bf16_f32 v50, v20, v21
    v_cvt_pk_bf16_f32 v51, v22, v23
    v_exp_f32 v24, v24
    ds_read_b128 v[68:71], v113 offset:5632
    v_exp_f32 v25, v25
    v_mfma_f32_32x32x16_bf16 v[88:103], v[56:59], v[48:51], v[88:103]
    v_exp_f32 v26, v26
    v_exp_f32 v27, v27
    v_exp_f32 v28, v28
    v_exp_f32 v29, v29
    v_exp_f32 v30, v30
    v_exp_f32 v31, v31
    v_cvt_pk_bf16_f32 v52, v24, v25
    v_cvt_pk_bf16_f32 v53, v26, v27
    v_cvt_pk_bf16_f32 v54, v28, v29
    v_cvt_pk_bf16_f32 v55, v30, v31
    s_setprio 0
    v_exp_f32 v32, v32
    v_exp_f32 v33, v33
    v_mfma_f32_32x32x16_bf16 v[88:103], v[60:63], v[52:55], v[88:103]
    s_waitcnt vmcnt(4)
    ds_write_b128 v15, a[56:59] offset:32768
    ds_write_b128 v5, a[60:63] offset:32768
    v_exp_f32 v34, v34
    v_exp_f32 v35, v35
    v_exp_f32 v36, v36
    s_waitcnt lgkmcnt(0)
    v_exp_f32 v37, v37
    v_mfma_f32_32x32x16_bf16 v[16:31], v[108:111], v[104:107], v[72:87]
    v_exp_f32 v38, v38
    ds_read_b128 v[108:111], v112 offset:7168
    v_exp_f32 v39, v39
    ds_read_b128 v[56:59], v113 offset:6144
    v_cvt_pk_bf16_f32 v48, v32, v33
    v_cvt_pk_bf16_f32 v49, v34, v35
    v_cvt_pk_bf16_f32 v50, v36, v37
    v_cvt_pk_bf16_f32 v51, v38, v39
    v_exp_f32 v40, v40
    ds_read_b128 v[60:63], v113 offset:6656
    v_exp_f32 v41, v41
    v_mfma_f32_32x32x16_bf16 v[88:103], v[64:67], v[48:51], v[88:103]
    v_exp_f32 v42, v42
    v_exp_f32 v43, v43
    v_exp_f32 v44, v44
    v_exp_f32 v45, v45
    v_exp_f32 v46, v46
    v_exp_f32 v47, v47
    v_cvt_pk_bf16_f32 v52, v40, v41
    v_cvt_pk_bf16_f32 v53, v42, v43
    v_cvt_pk_bf16_f32 v54, v44, v45
    v_cvt_pk_bf16_f32 v55, v46, v47
    s_setprio 3
    v_exp_f32 v16, v16
    v_exp_f32 v17, v17
    v_mfma_f32_32x32x16_bf16 v[88:103], v[68:71], v[52:55], v[88:103]
    s_waitcnt lgkmcnt(0)
    s_barrier
    v_exp_f32 v18, v18
    v_exp_f32 v19, v19
    v_exp_f32 v20, v20
    s_waitcnt lgkmcnt(0)
    v_exp_f32 v21, v21
    v_mfma_f32_32x32x16_bf16 v[32:47], v[108:111], v[104:107], v[72:87]
    v_exp_f32 v22, v22
    ds_read_b128 v[108:111], v112 offset:8192
    v_exp_f32 v23, v23
    ds_read_b128 v[64:67], v113 offset:7168
    v_cvt_pk_bf16_f32 v48, v16, v17
    v_cvt_pk_bf16_f32 v49, v18, v19
    v_cvt_pk_bf16_f32 v50, v20, v21
    v_cvt_pk_bf16_f32 v51, v22, v23
    v_exp_f32 v24, v24
    ds_read_b128 v[68:71], v113 offset:7680
    v_exp_f32 v25, v25
    v_mfma_f32_32x32x16_bf16 v[88:103], v[56:59], v[48:51], v[88:103]
    v_exp_f32 v26, v26
    v_exp_f32 v27, v27
    v_exp_f32 v28, v28
    v_exp_f32 v29, v29
    v_exp_f32 v30, v30
    v_exp_f32 v31, v31
    v_cvt_pk_bf16_f32 v52, v24, v25
    v_cvt_pk_bf16_f32 v53, v26, v27
    v_cvt_pk_bf16_f32 v54, v28, v29
    v_cvt_pk_bf16_f32 v55, v30, v31
    v_exp_f32 v32, v32
    v_exp_f32 v33, v33
    v_mfma_f32_32x32x16_bf16 v[88:103], v[60:63], v[52:55], v[88:103]
    v_exp_f32 v34, v34
    v_exp_f32 v35, v35
    v_exp_f32 v36, v36
    s_waitcnt lgkmcnt(0)
    v_exp_f32 v37, v37
    v_mfma_f32_32x32x16_bf16 v[16:31], v[108:111], v[104:107], v[72:87]
    v_exp_f32 v38, v38
    ds_read_b128 v[108:111], v112 offset:9216
    v_exp_f32 v39, v39
    ds_read_b128 v[56:59], v113 offset:8192
    v_cvt_pk_bf16_f32 v48, v32, v33
    v_cvt_pk_bf16_f32 v49, v34, v35
    v_cvt_pk_bf16_f32 v50, v36, v37
    v_cvt_pk_bf16_f32 v51, v38, v39
    v_exp_f32 v40, v40
    ds_read_b128 v[60:63], v113 offset:8704
    v_exp_f32 v41, v41
    v_mfma_f32_32x32x16_bf16 v[88:103], v[64:67], v[48:51], v[88:103]
    v_exp_f32 v42, v42
    v_exp_f32 v43, v43
    v_exp_f32 v44, v44
    v_exp_f32 v45, v45
    v_exp_f32 v46, v46
    v_exp_f32 v47, v47
    v_cvt_pk_bf16_f32 v52, v40, v41
    v_cvt_pk_bf16_f32 v53, v42, v43
    v_cvt_pk_bf16_f32 v54, v44, v45
    v_cvt_pk_bf16_f32 v55, v46, v47
    v_add_u32 v112, 0x2000, v112
    v_add_u32 v113, v114, v113
    v_exp_f32 v16, v16
    v_exp_f32 v17, v17
    v_mfma_f32_32x32x16_bf16 v[88:103], v[68:71], v[52:55], v[88:103]
    s_add_u32 s44, s23, 7
    s_and_b32 s44, s44, 7
    s_sub_u32 s44, s44, s23
    s_lshl_b32 s44, s44, 13
    v_add_u32 v13, s44, v4
    global_load_dwordx4 a[80:83], v13, s[52:53] sc1
    global_load_dwordx4 a[84:87], v13, s[54:55] sc1
    v_exp_f32 v18, v18
    v_exp_f32 v19, v19
    v_exp_f32 v20, v20
    s_waitcnt lgkmcnt(0)
    v_exp_f32 v21, v21
    v_mfma_f32_32x32x16_bf16 v[32:47], v[108:111], v[104:107], v[72:87]
    v_exp_f32 v22, v22
    ds_read_b128 v[108:111], v112 offset:2048
    v_exp_f32 v23, v23
    ds_read_b128 v[64:67], v113 offset:1024
    v_cvt_pk_bf16_f32 v48, v16, v17
    v_cvt_pk_bf16_f32 v49, v18, v19
    v_cvt_pk_bf16_f32 v50, v20, v21
    v_cvt_pk_bf16_f32 v51, v22, v23
    v_exp_f32 v24, v24
    ds_read_b128 v[68:71], v113 offset:1536
    v_exp_f32 v25, v25
    v_mfma_f32_32x32x16_bf16 v[88:103], v[56:59], v[48:51], v[88:103]
    s_cmp_ge_u32 s24, 5
    s_cbranch_scc1 L_t_done
    s_cmp_ge_u32 s24, 2
    s_cbranch_scc1 L_t_lin
    s_mul_i32 s44, s23, 7
    s_lshr_b32 s44, s44, 1
    s_lshl_b32 s44, s44, 7
    s_mul_i32 s45, s22, 57344
    s_add_u32 s44, s44, s45
    v_lshrrev_b32 v14, 2, v1
    v_mul_u32_u24 v14, 3584, v14
    v_and_b32 v10, 3, v1
    v_lshl_add_u32 v14, v10, 7, v14
    v_add_u32 v14, s44, v14
    s_cmp_eq_u32 s24, 0
    s_cselect_b32 s40, s14, s16
    s_cselect_b32 s41, s15, s17
    s_branch L_t_go
L_t_lin:
    s_lshl_b32 s44, s3, 13
    s_lshl_b32 s45, s22, 14
    s_and_b32 s46, s24, 1
    s_lshl_b32 s46, s46, 13
    s_add_u32 s45, s45, s46
    s_cmp_eq_u32 s24, 2
    s_cselect_b32 s44, s44, s45
    s_cselect_b32 s40, s18, s8
    s_cselect_b32 s41, s19, s9
    v_lshl_add_u32 v14, v1, 7, s44
L_t_go:
    global_load_dword v9, v14, s[40:41]
L_t_done:
    v_exp_f32 v26, v26
    v_exp_f32 v27, v27
    v_exp_f32 v28, v28
    v_exp_f32 v29, v29
    v_exp_f32 v30, v30
    v_exp_f32 v31, v31
    v_cvt_pk_bf16_f32 v52, v24, v25
    v_cvt_pk_bf16_f32 v53, v26, v27
    v_cvt_pk_bf16_f32 v54, v28, v29
    v_cvt_pk_bf16_f32 v55, v30, v31
    v_exp_f32 v32, v32
    v_exp_f32 v33, v33
    v_mfma_f32_32x32x16_bf16 v[88:103], v[60:63], v[52:55], v[88:103]
    v_exp_f32 v34, v34
    v_exp_f32 v35, v35
    v_exp_f32 v36, v36
    s_waitcnt lgkmcnt(0)
    v_exp_f32 v37, v37
    v_mfma_f32_32x32x16_bf16 v[16:31], v[108:111], v[104:107], v[72:87]
    v_exp_f32 v38, v38
    ds_read_b128 v[108:111], v112 offset:3072
    v_exp_f32 v39, v39
    ds_read_b128 v[56:59], v113 offset:2048
    v_cvt_pk_bf16_f32 v48, v32, v33
    v_cvt_pk_bf16_f32 v49, v34, v35
    v_cvt_pk_bf16_f32 v50, v36, v37
    v_cvt_pk_bf16_f32 v51, v38, v39
    v_exp_f32 v40, v40
    ds_read_b128 v[60:63], v113 offset:2560
    v_exp_f32 v41, v41
    v_mfma_f32_32x32x16_bf16 v[88:103], v[64:67], v[48:51], v[88:103]
    v_exp_f32 v42, v42
    v_exp_f32 v43, v43
    v_exp_f32 v44, v44
    v_exp_f32 v45, v45
    v_exp_f32 v46, v46
    v_exp_f32 v47, v47
    v_cvt_pk_bf16_f32 v52, v40, v41
    v_cvt_pk_bf16_f32 v53, v42, v43
    v_cvt_pk_bf16_f32 v54, v44, v45
    v_cvt_pk_bf16_f32 v55, v46, v47
    v_exp_f32 v16, v16
    v_exp_f32 v17, v17
    v_mfma_f32_32x32x16_bf16 v[88:103], v[68:71], v[52:55], v[88:103]
    v_exp_f32 v18, v18
    v_exp_f32 v19, v19
    v_exp_f32 v20, v20
    s_waitcnt lgkmcnt(0)
    v_exp_f32 v21, v21
    v_mfma_f32_32x32x16_bf16 v[32:47], v[108:111], v[104:107], v[72:87]
    v_exp_f32 v22, v22
    ds_read_b128 v[108:111], v112 offset:4096
    v_exp_f32 v23, v23
    ds_read_b128 v[64:67], v113 offset:3072
    v_cvt_pk_bf16_f32 v48, v16, v17
    v_cvt_pk_bf16_f32 v49, v18, v19
    v_cvt_pk_bf16_f32 v50, v20, v21
    v_cvt_pk_bf16_f32 v51, v22, v23
    v_exp_f32 v24, v24
    ds_read_b128 v[68:71], v113 offset:3584
    v_exp_f32 v25, v25
    v_mfma_f32_32x32x16_bf16 v[88:103], v[56:59], v[48:51], v[88:103]
    v_exp_f32 v26, v26
    v_exp_f32 v27, v27
    v_exp_f32 v28, v28
    v_exp_f32 v29, v29
    v_exp_f32 v30, v30
    v_exp_f32 v31, v31
    v_cvt_pk_bf16_f32 v52, v24, v25
    v_cvt_pk_bf16_f32 v53, v26, v27
    v_cvt_pk_bf16_f32 v54, v28, v29
    v_cvt_pk_bf16_f32 v55, v30, v31
    v_exp_f32 v32, v32
    v_exp_f32 v33, v33
    v_mfma_f32_32x32x16_bf16 v[88:103], v[60:63], v[52:55], v[88:103]
    v_exp_f32 v34, v34
    v_exp_f32 v35, v35
    v_exp_f32 v36, v36
    s_waitcnt lgkmcnt(0)
    v_exp_f32 v37, v37
    v_mfma_f32_32x32x16_bf16 v[16:31], v[108:111], v[104:107], v[72:87]
    v_exp_f32 v38, v38
    ds_read_b128 v[108:111], v112 offset:5120
    v_exp_f32 v39, v39
    ds_read_b128 v[56:59], v113 offset:4096
    v_cvt_pk_bf16_f32 v48, v32, v33
    v_cvt_pk_bf16_f32 v49, v34, v35
    v_cvt_pk_bf16_f32 v50, v36, v37
    v_cvt_pk_bf16_f32 v51, v38, v39
    v_exp_f32 v40, v40
    ds_read_b128 v[60:63], v113 offset:4608
    v_exp_f32 v41, v41
    v_mfma_f32_32x32x16_bf16 v[88:103], v[64:67], v[48:51], v[88:103]
    v_exp_f32 v42, v42
    v_exp_f32 v43, v43
    v_exp_f32 v44, v44
    v_exp_f32 v45, v45
    v_exp_f32 v46, v46
    v_exp_f32 v47, v47
    v_cvt_pk_bf16_f32 v52, v40, v41
    v_cvt_pk_bf16_f32 v53, v42, v43
    v_cvt_pk_bf16_f32 v54, v44, v45
    v_cvt_pk_bf16_f32 v55, v46, v47
    v_exp_f32 v16, v16
    v_exp_f32 v17, v17
    v_mfma_f32_32x32x16_bf16 v[88:103], v[68:71], v[52:55], v[88:103]
    v_exp_f32 v18, v18
    v_exp_f32 v19, v19
    v_exp_f32 v20, v20
    s_waitcnt lgkmcnt(0)
    v_exp_f32 v21, v21
    v_mfma_f32_32x32x16_bf16 v[32:47], v[108:111], v[104:107], v[72:87]
    v_exp_f32 v22, v22
    ds_read_b128 v[108:111], v112 offset:6144
    v_exp_f32 v23, v23
    ds_read_b128 v[64:67], v113 offset:5120
    v_cvt_pk_bf16_f32 v48, v16, v17
    v_cvt_pk_bf16_f32 v49, v18, v19
    v_cvt_pk_bf16_f32 v50, v20, v21
    v_cvt_pk_bf16_f32 v51, v22, v23
    v_exp_f32 v24, v24
    ds_read_b128 v[68:71], v113 offset:5632
    v_exp_f32 v25, v25
    v_mfma_f32_32x32x16_bf16 v[88:103], v[56:59], v[48:51], v[88:103]
    v_exp_f32 v26, v26
    v_exp_f32 v27, v27
    v_exp_f32 v28, v28
    v_exp_f32 v29, v29
    v_exp_f32 v30, v30
    v_exp_f32 v31, v31
    v_cvt_pk_bf16_f32 v52, v24, v25
    v_cvt_pk_bf16_f32 v53, v26, v27
    v_cvt_pk_bf16_f32 v54, v28, v29
    v_cvt_pk_bf16_f32 v55, v30, v31
    v_exp_f32 v32, v32
    v_exp_f32 v33, v33
    v_mfma_f32_32x32x16_bf16 v[88:103], v[60:63], v[52:55], v[88:103]
    v_exp_f32 v34, v34
    v_exp_f32 v35, v35
    v_exp_f32 v36, v36
    s_waitcnt lgkmcnt(0)
    v_exp_f32 v37, v37
    v_mfma_f32_32x32x16_bf16 v[16:31], v[108:111], v[104:107], v[72:87]
    v_exp_f32 v38, v38
    ds_read_b128 v[108:111], v112 offset:7168
    v_exp_f32 v39, v39
    ds_read_b128 v[56:59], v113 offset:6144
    v_cvt_pk_bf16_f32 v48, v32, v33
    v_cvt_pk_bf16_f32 v49, v34, v35
    v_cvt_pk_bf16_f32 v50, v36, v37
    v_cvt_pk_bf16_f32 v51, v38, v39
    v_exp_f32 v40, v40
    ds_read_b128 v[60:63], v113 offset:6656
    v_exp_f32 v41, v41
    v_mfma_f32_32x32x16_bf16 v[88:103], v[64:67], v[48:51], v[88:103]
    v_exp_f32 v42, v42
    v_exp_f32 v43, v43
    v_exp_f32 v44, v44
    v_exp_f32 v45, v45
    v_exp_f32 v46, v46
    v_exp_f32 v47, v47
    v_cvt_pk_bf16_f32 v52, v40, v41
    v_cvt_pk_bf16_f32 v53, v42, v43
    v_cvt_pk_bf16_f32 v54, v44, v45
    v_cvt_pk_bf16_f32 v55, v46, v47
    s_setprio 2
    v_exp_f32 v16, v16
    v_exp_f32 v17, v17
    v_mfma_f32_32x32x16_bf16 v[88:103], v[68:71], v[52:55], v[88:103]
    v_exp_f32 v18, v18
    v_exp_f32 v19, v19
    v_exp_f32 v20, v20
    s_waitcnt lgkmcnt(0)
    v_exp_f32 v21, v21
    v_mfma_f32_32x32x16_bf16 v[32:47], v[108:111], v[104:107], v[72:87]
    v_exp_f32 v22, v22
    ds_read_b128 v[108:111], v112 offset:8192
    v_exp_f32 v23, v23
    ds_read_b128 v[64:67], v113 offset:7168
    v_cvt_pk_bf16_f32 v48, v16, v17
    v_cvt_pk_bf16_f32 v49, v18, v19
    v_cvt_pk_bf16_f32 v50, v20, v21
    v_cvt_pk_bf16_f32 v51, v22, v23
    v_exp_f32 v24, v24
    ds_read_b128 v[68:71], v113 offset:7680
    v_exp_f32 v25, v25
    v_mfma_f32_32x32x16_bf16 v[88:103], v[56:59], v[48:51], v[88:103]
    v_exp_f32 v26, v26
    v_exp_f32 v27, v27
    v_exp_f32 v28, v28
    v_exp_f32 v29, v29
    v_exp_f32 v30, v30
    v_exp_f32 v31, v31
    v_cvt_pk_bf16_f32 v52, v24, v25
    v_cvt_pk_bf16_f32 v53, v26, v27
    v_cvt_pk_bf16_f32 v54, v28, v29
    v_cvt_pk_bf16_f32 v55, v30, v31
    v_exp_f32 v32, v32
    v_exp_f32 v33, v33
    v_mfma_f32_32x32x16_bf16 v[88:103], v[60:63], v[52:55], v[88:103]
    v_exp_f32 v34, v34
    v_exp_f32 v35, v35
    v_exp_f32 v36, v36
    s_waitcnt lgkmcnt(0)
    v_exp_f32 v37, v37
    v_mfma_f32_32x32x16_bf16 v[16:31], v[108:111], v[104:107], v[72:87]
    v_exp_f32 v38, v38
    ds_read_b128 v[108:111], v112 offset:9216
    v_exp_f32 v39, v39
    ds_read_b128 v[56:59], v113 offset:8192
    v_cvt_pk_bf16_f32 v48, v32, v33
    v_cvt_pk_bf16_f32 v49, v34, v35
    v_cvt_pk_bf16_f32 v50, v36, v37
    v_cvt_pk_bf16_f32 v51, v38, v39
    v_exp_f32 v40, v40
    ds_read_b128 v[60:63], v113 offset:8704
    v_exp_f32 v41, v41
    v_mfma_f32_32x32x16_bf16 v[88:103], v[64:67], v[48:51], v[88:103]
    v_exp_f32 v42, v42
    v_exp_f32 v43, v43
    v_exp_f32 v44, v44
    v_exp_f32 v45, v45
    v_exp_f32 v46, v46
    v_exp_f32 v47, v47
    v_cvt_pk_bf16_f32 v52, v40, v41
    v_cvt_pk_bf16_f32 v53, v42, v43
    v_cvt_pk_bf16_f32 v54, v44, v45
    v_cvt_pk_bf16_f32 v55, v46, v47
    v_add_u32 v112, 0x2000, v112
    v_add_u32 v113, v114, v113
    v_exp_f32 v16, v16
    v_exp_f32 v17, v17
    v_mfma_f32_32x32x16_bf16 v[88:103], v[68:71], v[52:55], v[88:103]
    s_waitcnt vmcnt(4)
    ds_write_b128 v15, a[64:67] offset:40960
    ds_write_b128 v5, a[68:71] offset:40960
    v_exp_f32 v18, v18
    v_exp_f32 v19, v19
    v_exp_f32 v20, v20
    s_waitcnt lgkmcnt(0)
    v_exp_f32 v21, v21
    v_mfma_f32_32x32x16_bf16 v[32:47], v[108:111], v[104:107], v[72:87]
    v_exp_f32 v22, v22
    ds_read_b128 v[108:111], v112 offset:2048
    v_exp_f32 v23, v23
    ds_read_b128 v[64:67], v113 offset:1024
    v_cvt_pk_bf16_f32 v48, v16, v17
    v_cvt_pk_bf16_f32 v49, v18, v19
    v_cvt_pk_bf16_f32 v50, v20, v21
    v_cvt_pk_bf16_f32 v51, v22, v23
    v_exp_f32 v24, v24
    ds_read_b128 v[68:71], v113 offset:1536
    v_exp_f32 v25, v25
    v_mfma_f32_32x32x16_bf16 v[88:103], v[56:59], v[48:51], v[88:103]
    v_exp_f32 v26, v26
    v_exp_f32 v27, v27
    v_exp_f32 v28, v28
    v_exp_f32 v29, v29
    v_exp_f32 v30, v30
    v_exp_f32 v31, v31
    v_cvt_pk_bf16_f32 v52, v24, v25
    v_cvt_pk_bf16_f32 v53, v26, v27
    v_cvt_pk_bf16_f32 v54, v28, v29
    v_cvt_pk_bf16_f32 v55, v30, v31
    v_exp_f32 v32, v32
    v_exp_f32 v33, v33
    v_mfma_f32_32x32x16_bf16 v[88:103], v[60:63], v[52:55], v[88:103]
    s_waitcnt vmcnt(2)
    ds_write_b128 v15, a[72:75] offset:49152
    ds_write_b128 v5, a[76:79] offset:49152
    v_exp_f32 v34, v34
    v_exp_f32 v35, v35
    v_exp_f32 v36, v36
    s_waitcnt lgkmcnt(0)
    v_exp_f32 v37, v37
    v_mfma_f32_32x32x16_bf16 v[16:31], v[108:111], v[104:107], v[72:87]
    v_exp_f32 v38, v38
    ds_read_b128 v[108:111], v112 offset:3072
    v_exp_f32 v39, v39
    ds_read_b128 v[56:59], v113 offset:2048
    v_cvt_pk_bf16_f32 v48, v32, v33
    v_cvt_pk_bf16_f32 v49, v34, v35
    v_cvt_pk_bf16_f32 v50, v36, v37
    v_cvt_pk_bf16_f32 v51, v38, v39
    v_exp_f32 v40, v40
    ds_read_b128 v[60:63], v113 offset:2560
    v_exp_f32 v41, v41
    v_mfma_f32_32x32x16_bf16 v[88:103], v[64:67], v[48:51], v[88:103]
    v_exp_f32 v42, v42
    v_exp_f32 v43, v43
    v_exp_f32 v44, v44
    v_exp_f32 v45, v45
    v_exp_f32 v46, v46
    v_exp_f32 v47, v47
    v_cvt_pk_bf16_f32 v52, v40, v41
    v_cvt_pk_bf16_f32 v53, v42, v43
    v_cvt_pk_bf16_f32 v54, v44, v45
    v_cvt_pk_bf16_f32 v55, v46, v47
    s_setprio 1
    v_exp_f32 v16, v16
    v_exp_f32 v17, v17
    v_mfma_f32_32x32x16_bf16 v[88:103], v[68:71], v[52:55], v[88:103]
    s_waitcnt vmcnt(0)
    ds_write_b128 v15, a[80:83] offset:57344
    ds_write_b128 v5, a[84:87] offset:57344
    v_exp_f32 v18, v18
    v_exp_f32 v19, v19
    v_exp_f32 v20, v20
    s_waitcnt lgkmcnt(0)
    v_exp_f32 v21, v21
    v_mfma_f32_32x32x16_bf16 v[32:47], v[108:111], v[104:107], v[72:87]
    v_exp_f32 v22, v22
    ds_read_b128 v[108:111], v112 offset:4096
    v_exp_f32 v23, v23
    ds_read_b128 v[64:67], v113 offset:3072
    v_cvt_pk_bf16_f32 v48, v16, v17
    v_cvt_pk_bf16_f32 v49, v18, v19
    v_cvt_pk_bf16_f32 v50, v20, v21
    v_cvt_pk_bf16_f32 v51, v22, v23
    v_exp_f32 v24, v24
    ds_read_b128 v[68:71], v113 offset:3584
    v_exp_f32 v25, v25
    v_mfma_f32_32x32x16_bf16 v[88:103], v[56:59], v[48:51], v[88:103]
    v_exp_f32 v26, v26
    v_exp_f32 v27, v27
    v_exp_f32 v28, v28
    v_exp_f32 v29, v29
    v_exp_f32 v30, v30
    v_exp_f32 v31, v31
    v_cvt_pk_bf16_f32 v52, v24, v25
    v_cvt_pk_bf16_f32 v53, v26, v27
    v_cvt_pk_bf16_f32 v54, v28, v29
    v_cvt_pk_bf16_f32 v55, v30, v31
    v_exp_f32 v32, v32
    v_exp_f32 v33, v33
    v_mfma_f32_32x32x16_bf16 v[88:103], v[60:63], v[52:55], v[88:103]
    s_lshl_b32 s44, s24, 16
    s_lshl_b32 s45, s32, 7
    s_add_u32 s44, s44, s45
    v_lshrrev_b32 v2, 3, v1
    v_lshl_add_u32 v2, v2, 10, s44
    v_and_b32 v14, 7, v1
    v_lshl_add_u32 v2, v14, 4, v2
    v_exp_f32 v34, v34
    v_exp_f32 v35, v35
    v_exp_f32 v36, v36
    s_waitcnt lgkmcnt(0)
    v_exp_f32 v37, v37
    v_mfma_f32_32x32x16_bf16 v[16:31], v[108:111], v[104:107], v[72:87]
    v_exp_f32 v38, v38
    ds_read_b128 v[108:111], v112 offset:5120
    v_exp_f32 v39, v39
    ds_read_b128 v[56:59], v113 offset:4096
    v_cvt_pk_bf16_f32 v48, v32, v33
    v_cvt_pk_bf16_f32 v49, v34, v35
    v_cvt_pk_bf16_f32 v50, v36, v37
    v_cvt_pk_bf16_f32 v51, v38, v39
    v_exp_f32 v40, v40
    ds_read_b128 v[60:63], v113 offset:4608
    v_exp_f32 v41, v41
    v_mfma_f32_32x32x16_bf16 v[88:103], v[64:67], v[48:51], v[88:103]
    v_exp_f32 v42, v42
    v_exp_f32 v43, v43
    v_exp_f32 v44, v44
    v_exp_f32 v45, v45
    v_exp_f32 v46, v46
    v_exp_f32 v47, v47
    v_cvt_pk_bf16_f32 v52, v40, v41
    v_cvt_pk_bf16_f32 v53, v42, v43
    v_cvt_pk_bf16_f32 v54, v44, v45
    v_cvt_pk_bf16_f32 v55, v46, v47
    s_setprio 0
    v_exp_f32 v16, v16
    v_exp_f32 v17, v17
    v_mfma_f32_32x32x16_bf16 v[88:103], v[68:71], v[52:55], v[88:103]
    global_load_dwordx4 a[0:3], v2, s[8:9]
    v_add_u32 v2, 0x2000, v2
    v_exp_f32 v18, v18
    v_exp_f32 v19, v19
    v_exp_f32 v20, v20
    s_waitcnt lgkmcnt(0)
    v_exp_f32 v21, v21
    v_mfma_f32_32x32x16_bf16 v[32:47], v[108:111], v[104:107], v[72:87]
    v_exp_f32 v22, v22
    ds_read_b128 v[108:111], v112 offset:6144
    v_exp_f32 v23, v23
    ds_read_b128 v[64:67], v113 offset:5120
    v_cvt_pk_bf16_f32 v48, v16, v17
    v_cvt_pk_bf16_f32 v49, v18, v19
    v_cvt_pk_bf16_f32 v50, v20, v21
    v_cvt_pk_bf16_f32 v51, v22, v23
    v_exp_f32 v24, v24
    ds_read_b128 v[68:71], v113 offset:5632
    v_exp_f32 v25, v25
    v_mfma_f32_32x32x16_bf16 v[88:103], v[56:59], v[48:51], v[88:103]
    v_exp_f32 v26, v26
    v_exp_f32 v27, v27
    v_exp_f32 v28, v28
    v_exp_f32 v29, v29
    v_exp_f32 v30, v30
    v_exp_f32 v31, v31
    v_cvt_pk_bf16_f32 v52, v24, v25
    v_cvt_pk_bf16_f32 v53, v26, v27
    v_cvt_pk_bf16_f32 v54, v28, v29
    v_cvt_pk_bf16_f32 v55, v30, v31
    v_exp_f32 v32, v32
    v_exp_f32 v33, v33
    v_mfma_f32_32x32x16_bf16 v[88:103], v[60:63], v[52:55], v[88:103]
    global_load_dwordx4 a[4:7], v2, s[8:9]
    v_add_u32 v2, 0x2000, v2
    v_exp_f32 v34, v34
    v_exp_f32 v35, v35
    v_exp_f32 v36, v36
    s_waitcnt lgkmcnt(0)
    v_exp_f32 v37, v37
    v_mfma_f32_32x32x16_bf16 v[16:31], v[108:111], v[104:107], v[72:87]
    v_exp_f32 v38, v38
    ds_read_b128 v[108:111], v112 offset:7168
    v_exp_f32 v39, v39
    ds_read_b128 v[56:59], v113 offset:6144
    v_cvt_pk_bf16_f32 v48, v32, v33
    v_cvt_pk_bf16_f32 v49, v34, v35
    v_cvt_pk_bf16_f32 v50, v36, v37
    v_cvt_pk_bf16_f32 v51, v38, v39
    v_exp_f32 v40, v40
    ds_read_b128 v[60:63], v113 offset:6656
    v_exp_f32 v41, v41
    v_mfma_f32_32x32x16_bf16 v[88:103], v[64:67], v[48:51], v[88:103]
    v_exp_f32 v42, v42
    v_exp_f32 v43, v43
    v_exp_f32 v44, v44
    v_exp_f32 v45, v45
    v_exp_f32 v46, v46
    v_exp_f32 v47, v47
    v_cvt_pk_bf16_f32 v52, v40, v41
    v_cvt_pk_bf16_f32 v53, v42, v43
    v_cvt_pk_bf16_f32 v54, v44, v45
    v_cvt_pk_bf16_f32 v55, v46, v47
    s_setprio 3
    v_exp_f32 v16, v16
    v_exp_f32 v17, v17
    v_mfma_f32_32x32x16_bf16 v[88:103], v[68:71], v[52:55], v[88:103]
    s_waitcnt lgkmcnt(0)
    s_barrier
    v_exp_f32 v18, v18
    v_exp_f32 v19, v19
    v_exp_f32 v20, v20
    s_waitcnt lgkmcnt(0)
    v_exp_f32 v21, v21
    v_mfma_f32_32x32x16_bf16 v[32:47], v[108:111], v[104:107], v[72:87]
    v_exp_f32 v22, v22
    ds_read_b128 v[108:111], v112 offset:8192
    v_exp_f32 v23, v23
    ds_read_b128 v[64:67], v113 offset:7168
    v_cvt_pk_bf16_f32 v48, v16, v17
    v_cvt_pk_bf16_f32 v49, v18, v19
    v_cvt_pk_bf16_f32 v50, v20, v21
    v_cvt_pk_bf16_f32 v51, v22, v23
    v_exp_f32 v24, v24
    ds_read_b128 v[68:71], v113 offset:7680
    v_exp_f32 v25, v25
    v_mfma_f32_32x32x16_bf16 v[88:103], v[56:59], v[48:51], v[88:103]
    v_exp_f32 v26, v26
    v_exp_f32 v27, v27
    v_exp_f32 v28, v28
    v_exp_f32 v29, v29
    v_exp_f32 v30, v30
    v_exp_f32 v31, v31
    v_cvt_pk_bf16_f32 v52, v24, v25
    v_cvt_pk_bf16_f32 v53, v26, v27
    v_cvt_pk_bf16_f32 v54, v28, v29
    v_cvt_pk_bf16_f32 v55, v30, v31
    v_exp_f32 v32, v32
    v_exp_f32 v33, v33
    v_mfma_f32_32x32x16_bf16 v[88:103], v[60:63], v[52:55], v[88:103]
    global_load_dwordx4 a[8:11], v2, s[8:9]
    v_add_u32 v2, 0x2000, v2
    v_exp_f32 v34, v34
    v_exp_f32 v35, v35
    v_exp_f32 v36, v36
    s_waitcnt lgkmcnt(0)
    v_exp_f32 v37, v37
    v_mfma_f32_32x32x16_bf16 v[16:31], v[108:111], v[104:107], v[72:87]
    v_exp_f32 v38, v38
    ds_read_b128 v[108:111], v112 offset:9216
    v_exp_f32 v39, v39
    ds_read_b128 v[56:59], v113 offset:8192
    v_cvt_pk_bf16_f32 v48, v32, v33
    v_cvt_pk_bf16_f32 v49, v34, v35
    v_cvt_pk_bf16_f32 v50, v36, v37
    v_cvt_pk_bf16_f32 v51, v38, v39
    v_exp_f32 v40, v40
    ds_read_b128 v[60:63], v113 offset:8704
    v_exp_f32 v41, v41
    v_mfma_f32_32x32x16_bf16 v[88:103], v[64:67], v[48:51], v[88:103]
    v_exp_f32 v42, v42
    v_exp_f32 v43, v43
    v_exp_f32 v44, v44
    v_exp_f32 v45, v45
    v_exp_f32 v46, v46
    v_exp_f32 v47, v47
    v_cvt_pk_bf16_f32 v52, v40, v41
    v_cvt_pk_bf16_f32 v53, v42, v43
    v_cvt_pk_bf16_f32 v54, v44, v45
    v_cvt_pk_bf16_f32 v55, v46, v47
    v_add_u32 v112, 0x2000, v112
    v_add_u32 v113, v114, v113
    s_setprio 3
    v_exp_f32 v16, v16
    v_exp_f32 v17, v17
    v_mfma_f32_32x32x16_bf16 v[88:103], v[68:71], v[52:55], v[88:103]
    global_load_dwordx4 a[12:15], v2, s[8:9]
    v_add_u32 v2, 0x2000, v2
    v_exp_f32 v18, v18
    v_exp_f32 v19, v19
    v_exp_f32 v20, v20
    s_waitcnt lgkmcnt(0)
    v_exp_f32 v21, v21
    v_mfma_f32_32x32x16_bf16 v[32:47], v[108:111], v[104:107], v[72:87]
    v_exp_f32 v22, v22
    ds_read_b128 v[108:111], v112 offset:2048
    v_exp_f32 v23, v23
    ds_read_b128 v[64:67], v113 offset:1024
    v_cvt_pk_bf16_f32 v48, v16, v17
    v_cvt_pk_bf16_f32 v49, v18, v19
    v_cvt_pk_bf16_f32 v50, v20, v21
    v_cvt_pk_bf16_f32 v51, v22, v23
    v_exp_f32 v24, v24
    ds_read_b128 v[68:71], v113 offset:1536
    v_exp_f32 v25, v25
    v_mfma_f32_32x32x16_bf16 v[88:103], v[56:59], v[48:51], v[88:103]
    v_exp_f32 v26, v26
    v_exp_f32 v27, v27
    v_exp_f32 v28, v28
    v_exp_f32 v29, v29
    v_exp_f32 v30, v30
    v_exp_f32 v31, v31
    v_cvt_pk_bf16_f32 v52, v24, v25
    v_cvt_pk_bf16_f32 v53, v26, v27
    v_cvt_pk_bf16_f32 v54, v28, v29
    v_cvt_pk_bf16_f32 v55, v30, v31
    v_exp_f32 v32, v32
    v_exp_f32 v33, v33
    v_mfma_f32_32x32x16_bf16 v[88:103], v[60:63], v[52:55], v[88:103]
    global_load_dwordx4 a[16:19], v2, s[8:9]
    v_add_u32 v2, 0x2000, v2
    v_exp_f32 v34, v34
    v_exp_f32 v35, v35
    v_exp_f32 v36, v36
    s_waitcnt lgkmcnt(0)
    v_exp_f32 v37, v37
    v_mfma_f32_32x32x16_bf16 v[16:31], v[108:111], v[104:107], v[72:87]
    v_exp_f32 v38, v38
    ds_read_b128 v[108:111], v112 offset:3072
    v_exp_f32 v39, v39
    ds_read_b128 v[56:59], v113 offset:2048
    v_cvt_pk_bf16_f32 v48, v32, v33
    v_cvt_pk_bf16_f32 v49, v34, v35
    v_cvt_pk_bf16_f32 v50, v36, v37
    v_cvt_pk_bf16_f32 v51, v38, v39
    v_exp_f32 v40, v40
    ds_read_b128 v[60:63], v113 offset:2560
    v_exp_f32 v41, v41
    v_mfma_f32_32x32x16_bf16 v[88:103], v[64:67], v[48:51], v[88:103]
    v_exp_f32 v42, v42
    v_exp_f32 v43, v43
    v_exp_f32 v44, v44
    v_exp_f32 v45, v45
    v_exp_f32 v46, v46
    v_exp_f32 v47, v47
    v_cvt_pk_bf16_f32 v52, v40, v41
    v_cvt_pk_bf16_f32 v53, v42, v43
    v_cvt_pk_bf16_f32 v54, v44, v45
    v_cvt_pk_bf16_f32 v55, v46, v47
    v_exp_f32 v16, v16
    v_exp_f32 v17, v17
    v_mfma_f32_32x32x16_bf16 v[88:103], v[68:71], v[52:55], v[88:103]
    global_load_dwordx4 a[20:23], v2, s[8:9]
    v_add_u32 v2, 0x2000, v2
    v_exp_f32 v18, v18
    v_exp_f32 v19, v19
    v_exp_f32 v20, v20
    s_waitcnt lgkmcnt(0)
    v_exp_f32 v21, v21
    v_mfma_f32_32x32x16_bf16 v[32:47], v[108:111], v[104:107], v[72:87]
    v_exp_f32 v22, v22
    ds_read_b128 v[108:111], v112 offset:4096
    v_exp_f32 v23, v23
    ds_read_b128 v[64:67], v113 offset:3072
    v_cvt_pk_bf16_f32 v48, v16, v17
    v_cvt_pk_bf16_f32 v49, v18, v19
    v_cvt_pk_bf16_f32 v50, v20, v21
    v_cvt_pk_bf16_f32 v51, v22, v23
    v_exp_f32 v24, v24
    ds_read_b128 v[68:71], v113 offset:3584
    v_exp_f32 v25, v25
    v_mfma_f32_32x32x16_bf16 v[88:103], v[56:59], v[48:51], v[88:103]
    v_exp_f32 v26, v26
    v_exp_f32 v27, v27
    v_exp_f32 v28, v28
    v_exp_f32 v29, v29
    v_exp_f32 v30, v30
    v_exp_f32 v31, v31
    v_cvt_pk_bf16_f32 v52, v24, v25
    v_cvt_pk_bf16_f32 v53, v26, v27
    v_cvt_pk_bf16_f32 v54, v28, v29
    v_cvt_pk_bf16_f32 v55, v30, v31
    v_exp_f32 v32, v32
    v_exp_f32 v33, v33
    v_mfma_f32_32x32x16_bf16 v[88:103], v[60:63], v[52:55], v[88:103]
    global_load_dwordx4 a[24:27], v2, s[8:9]
    v_add_u32 v2, 0x2000, v2
    v_exp_f32 v34, v34
    v_exp_f32 v35, v35
    v_exp_f32 v36, v36
    s_waitcnt lgkmcnt(0)
    v_exp_f32 v37, v37
    v_mfma_f32_32x32x16_bf16 v[16:31], v[108:111], v[104:107], v[72:87]
    v_exp_f32 v38, v38
    ds_read_b128 v[108:111], v112 offset:5120
    v_exp_f32 v39, v39
    ds_read_b128 v[56:59], v113 offset:4096
    v_cvt_pk_bf16_f32 v48, v32, v33
    v_cvt_pk_bf16_f32 v49, v34, v35
    v_cvt_pk_bf16_f32 v50, v36, v37
    v_cvt_pk_bf16_f32 v51, v38, v39
    v_exp_f32 v40, v40
    ds_read_b128 v[60:63], v113 offset:4608
    v_exp_f32 v41, v41
    v_mfma_f32_32x32x16_bf16 v[88:103], v[64:67], v[48:51], v[88:103]
    v_exp_f32 v42, v42
    v_exp_f32 v43, v43
    v_exp_f32 v44, v44
    v_exp_f32 v45, v45
    v_exp_f32 v46, v46
    v_exp_f32 v47, v47
    v_cvt_pk_bf16_f32 v52, v40, v41
    v_cvt_pk_bf16_f32 v53, v42, v43
    v_cvt_pk_bf16_f32 v54, v44, v45
    v_cvt_pk_bf16_f32 v55, v46, v47
    v_exp_f32 v16, v16
    v_exp_f32 v17, v17
    v_mfma_f32_32x32x16_bf16 v[88:103], v[68:71], v[52:55], v[88:103]
    global_load_dwordx4 a[28:31], v2, s[8:9]
    v_exp_f32 v18, v18
    v_exp_f32 v19, v19
    v_exp_f32 v20, v20
    s_waitcnt lgkmcnt(0)
    v_exp_f32 v21, v21
    v_mfma_f32_32x32x16_bf16 v[32:47], v[108:111], v[104:107], v[72:87]
    v_exp_f32 v22, v22
    ds_read_b128 v[108:111], v112 offset:6144
    v_exp_f32 v23, v23
    ds_read_b128 v[64:67], v113 offset:5120
    v_cvt_pk_bf16_f32 v48, v16, v17
    v_cvt_pk_bf16_f32 v49, v18, v19
    v_cvt_pk_bf16_f32 v50, v20, v21
    v_cvt_pk_bf16_f32 v51, v22, v23
    v_exp_f32 v24, v24
    ds_read_b128 v[68:71], v113 offset:5632
    v_exp_f32 v25, v25
    v_mfma_f32_32x32x16_bf16 v[88:103], v[56:59], v[48:51], v[88:103]
    v_exp_f32 v26, v26
    v_exp_f32 v27, v27
    v_exp_f32 v28, v28
    v_exp_f32 v29, v29
    v_exp_f32 v30, v30
    v_exp_f32 v31, v31
    v_cvt_pk_bf16_f32 v52, v24, v25
    v_cvt_pk_bf16_f32 v53, v26, v27
    v_cvt_pk_bf16_f32 v54, v28, v29
    v_cvt_pk_bf16_f32 v55, v30, v31
    v_exp_f32 v32, v32
    v_exp_f32 v33, v33
    v_mfma_f32_32x32x16_bf16 v[88:103], v[60:63], v[52:55], v[88:103]
    s_lshl_b32 s45, s3, 4
    v_mul_u32_u24 v14, 3584, v0
    v_add_u32 v14, s45, v14
    global_load_dwordx4 a[112:115], v14, s[14:15]
    v_exp_f32 v34, v34
    v_exp_f32 v35, v35
    v_exp_f32 v36, v36
    s_waitcnt lgkmcnt(0)
    v_exp_f32 v37, v37
    v_mfma_f32_32x32x16_bf16 v[16:31], v[108:111], v[104:107], v[72:87]
    v_exp_f32 v38, v38
    ds_read_b128 v[108:111], v112 offset:7168
    v_exp_f32 v39, v39
    ds_read_b128 v[56:59], v113 offset:6144
    v_cvt_pk_bf16_f32 v48, v32, v33
    v_cvt_pk_bf16_f32 v49, v34, v35
    v_cvt_pk_bf16_f32 v50, v36, v37
    v_cvt_pk_bf16_f32 v51, v38, v39
    v_exp_f32 v40, v40
    ds_read_b128 v[60:63], v113 offset:6656
    v_exp_f32 v41, v41
    v_mfma_f32_32x32x16_bf16 v[88:103], v[64:67], v[48:51], v[88:103]
    v_exp_f32 v42, v42
    v_exp_f32 v43, v43
    v_exp_f32 v44, v44
    v_exp_f32 v45, v45
    v_exp_f32 v46, v46
    v_exp_f32 v47, v47
    v_cvt_pk_bf16_f32 v52, v40, v41
    v_cvt_pk_bf16_f32 v53, v42, v43
    v_cvt_pk_bf16_f32 v54, v44, v45
    v_cvt_pk_bf16_f32 v55, v46, v47
    v_exp_f32 v16, v16
    v_exp_f32 v17, v17
    v_mfma_f32_32x32x16_bf16 v[88:103], v[68:71], v[52:55], v[88:103]
    s_lshl_b32 s45, s3, 4
    v_mul_u32_u24 v14, 3584, v0
    v_add_u32 v14, s45, v14
    global_load_dwordx4 a[116:119], v14, s[16:17]
    v_exp_f32 v18, v18
    v_exp_f32 v19, v19
    v_exp_f32 v20, v20
    s_waitcnt lgkmcnt(0)
    v_exp_f32 v21, v21
    v_mfma_f32_32x32x16_bf16 v[32:47], v[108:111], v[104:107], v[72:87]
    v_exp_f32 v22, v22
    ds_read_b128 v[108:111], v112 offset:8192
    v_exp_f32 v23, v23
    ds_read_b128 v[64:67], v113 offset:7168
    v_cvt_pk_bf16_f32 v48, v16, v17
    v_cvt_pk_bf16_f32 v49, v18, v19
    v_cvt_pk_bf16_f32 v50, v20, v21
    v_cvt_pk_bf16_f32 v51, v22, v23
    v_exp_f32 v24, v24
    ds_read_b128 v[68:71], v113 offset:7680
    v_exp_f32 v25, v25
    v_mfma_f32_32x32x16_bf16 v[88:103], v[56:59], v[48:51], v[88:103]
    v_exp_f32 v26, v26
    v_exp_f32 v27, v27
    v_exp_f32 v28, v28
    v_exp_f32 v29, v29
    v_exp_f32 v30, v30
    v_exp_f32 v31, v31
    v_cvt_pk_bf16_f32 v52, v24, v25
    v_cvt_pk_bf16_f32 v53, v26, v27
    v_cvt_pk_bf16_f32 v54, v28, v29
    v_cvt_pk_bf16_f32 v55, v30, v31
    v_exp_f32 v32, v32
    v_exp_f32 v33, v33
    v_mfma_f32_32x32x16_bf16 v[88:103], v[60:63], v[52:55], v[88:103]
    s_lshl_b32 s45, s3, 13
    s_add_u32 s45, s45, s26
    v_add_u32 v14, s45, v3
    global_load_dwordx4 a[120:123], v14, s[18:19]
    v_exp_f32 v34, v34
    v_exp_f32 v35, v35
    v_exp_f32 v36, v36
    s_waitcnt lgkmcnt(0)
    v_exp_f32 v37, v37
    v_mfma_f32_32x32x16_bf16 v[16:31], v[108:111], v[104:107], v[72:87]
    v_exp_f32 v38, v38
    ds_read_b128 v[108:111], v112 offset:9216
    v_exp_f32 v39, v39
    ds_read_b128 v[56:59], v113 offset:8192
    v_cvt_pk_bf16_f32 v48, v32, v33
    v_cvt_pk_bf16_f32 v49, v34, v35
    v_cvt_pk_bf16_f32 v50, v36, v37
    v_cvt_pk_bf16_f32 v51, v38, v39
    v_exp_f32 v40, v40
    ds_read_b128 v[60:63], v113 offset:8704
    v_exp_f32 v41, v41
    v_mfma_f32_32x32x16_bf16 v[88:103], v[64:67], v[48:51], v[88:103]
    s_lshl_b32 s44, s37, 9
    s_lshl_b32 s45, s36, 15
    s_add_u32 s44, s44, s45
    v_and_b32 v10, 15, v1
    v_lshl_add_u32 v124, v10, 4, s44
    v_lshrrev_b32 v10, 5, v1
    v_lshl_add_u32 v124, v10, 8, v124
    v_bfe_u32 v10, v1, 4, 1
    v_lshl_add_u32 v124, v10, 14, v124
    v_and_b32 v10, 31, v1
    s_lshl_b32 s44, s36, 5
    v_add_u32 v125, s44, v10
    v_lshrrev_b32 v10, 5, v1
    s_lshl_b32 s44, s37, 5
    v_lshl_add_u32 v14, v10, 3, s44
    global_load_dwordx2 v[120:121], v14, s[12:13]
    global_load_dwordx2 v[122:123], v14, s[12:13] offset:16
    v_lshl_add_u32 v14, v125, 10, v14
    global_load_dwordx2 v[116:117], v14, s[4:5]
    global_load_dwordx2 v[118:119], v14, s[4:5] offset:16
    v_exp_f32 v42, v42
    v_exp_f32 v43, v43
    v_exp_f32 v44, v44
    v_exp_f32 v45, v45
    v_exp_f32 v46, v46
    v_exp_f32 v47, v47
    v_cvt_pk_bf16_f32 v52, v40, v41
    v_cvt_pk_bf16_f32 v53, v42, v43
    v_cvt_pk_bf16_f32 v54, v44, v45
    v_cvt_pk_bf16_f32 v55, v46, v47
    v_add_u32 v112, 0x2000, v112
    v_add_u32 v113, v114, v113
    s_mov_b32 s28, 6
.p2align 6
L_l0_loop:
    s_cmp_lt_u32 s28, 6
    s_cbranch_scc1 L_l0_pd
    s_setprio 2
    s_cmp_lt_u32 s28, 7
    s_cbranch_scc1 L_l0_pd
    s_setprio 1
L_l0_pd:
    v_exp_f32 v16, v16
    v_exp_f32 v17, v17
    v_mfma_f32_32x32x16_bf16 v[88:103], v[68:71], v[52:55], v[88:103]
    v_exp_f32 v18, v18
    v_exp_f32 v19, v19
    v_exp_f32 v20, v20
    s_waitcnt lgkmcnt(0)
    v_exp_f32 v21, v21
    v_mfma_f32_32x32x16_bf16 v[32:47], v[108:111], v[104:107], v[72:87]
    v_exp_f32 v22, v22
    ds_read_b128 v[108:111], v112 offset:2048
    v_exp_f32 v23, v23
    ds_read_b128 v[64:67], v113 offset:1024
    v_cvt_pk_bf16_f32 v48, v16, v17
    v_cvt_pk_bf16_f32 v49, v18, v19
    v_cvt_pk_bf16_f32 v50, v20, v21
    v_cvt_pk_bf16_f32 v51, v22, v23
    v_exp_f32 v24, v24
    ds_read_b128 v[68:71], v113 offset:1536
    v_exp_f32 v25, v25
    v_mfma_f32_32x32x16_bf16 v[88:103], v[56:59], v[48:51], v[88:103]
    v_exp_f32 v26, v26
    v_exp_f32 v27, v27
    v_exp_f32 v28, v28
    v_exp_f32 v29, v29
    v_exp_f32 v30, v30
    v_exp_f32 v31, v31
    v_cvt_pk_bf16_f32 v52, v24, v25
    v_cvt_pk_bf16_f32 v53, v26, v27
    v_cvt_pk_bf16_f32 v54, v28, v29
    v_cvt_pk_bf16_f32 v55, v30, v31
    v_exp_f32 v32, v32
    v_exp_f32 v33, v33
    v_mfma_f32_32x32x16_bf16 v[88:103], v[60:63], v[52:55], v[88:103]
    v_exp_f32 v34, v34
    v_exp_f32 v35, v35
    v_exp_f32 v36, v36
    s_waitcnt lgkmcnt(0)
    v_exp_f32 v37, v37
    v_mfma_f32_32x32x16_bf16 v[16:31], v[108:111], v[104:107], v[72:87]
    v_exp_f32 v38, v38
    ds_read_b128 v[108:111], v112 offset:3072
    v_exp_f32 v39, v39
    ds_read_b128 v[56:59], v113 offset:2048
    v_cvt_pk_bf16_f32 v48, v32, v33
    v_cvt_pk_bf16_f32 v49, v34, v35
    v_cvt_pk_bf16_f32 v50, v36, v37
    v_cvt_pk_bf16_f32 v51, v38, v39
    v_exp_f32 v40, v40
    ds_read_b128 v[60:63], v113 offset:2560
    v_exp_f32 v41, v41
    v_mfma_f32_32x32x16_bf16 v[88:103], v[64:67], v[48:51], v[88:103]
    v_exp_f32 v42, v42
    v_exp_f32 v43, v43
    v_exp_f32 v44, v44
    v_exp_f32 v45, v45
    v_exp_f32 v46, v46
    v_exp_f32 v47, v47
    v_cvt_pk_bf16_f32 v52, v40, v41
    v_cvt_pk_bf16_f32 v53, v42, v43
    v_cvt_pk_bf16_f32 v54, v44, v45
    v_cvt_pk_bf16_f32 v55, v46, v47
    v_exp_f32 v16, v16
    v_exp_f32 v17, v17
    v_mfma_f32_32x32x16_bf16 v[88:103], v[68:71], v[52:55], v[88:103]
    v_exp_f32 v18, v18
    v_exp_f32 v19, v19
    v_exp_f32 v20, v20
    s_waitcnt lgkmcnt(0)
    v_exp_f32 v21, v21
    v_mfma_f32_32x32x16_bf16 v[32:47], v[108:111], v[104:107], v[72:87]
    v_exp_f32 v22, v22
    ds_read_b128 v[108:111], v112 offset:4096
    v_exp_f32 v23, v23
    ds_read_b128 v[64:67], v113 offset:3072
    v_cvt_pk_bf16_f32 v48, v16, v17
    v_cvt_pk_bf16_f32 v49, v18, v19
    v_cvt_pk_bf16_f32 v50, v20, v21
    v_cvt_pk_bf16_f32 v51, v22, v23
    v_exp_f32 v24, v24
    ds_read_b128 v[68:71], v113 offset:3584
    v_exp_f32 v25, v25
    v_mfma_f32_32x32x16_bf16 v[88:103], v[56:59], v[48:51], v[88:103]
    v_exp_f32 v26, v26
    v_exp_f32 v27, v27
    v_exp_f32 v28, v28
    v_exp_f32 v29, v29
    v_exp_f32 v30, v30
    v_exp_f32 v31, v31
    v_cvt_pk_bf16_f32 v52, v24, v25
    v_cvt_pk_bf16_f32 v53, v26, v27
    v_cvt_pk_bf16_f32 v54, v28, v29
    v_cvt_pk_bf16_f32 v55, v30, v31
    v_exp_f32 v32, v32
    v_exp_f32 v33, v33
    v_mfma_f32_32x32x16_bf16 v[88:103], v[60:63], v[52:55], v[88:103]
    v_exp_f32 v34, v34
    v_exp_f32 v35, v35
    v_exp_f32 v36, v36
    s_waitcnt lgkmcnt(0)
    v_exp_f32 v37, v37
    v_mfma_f32_32x32x16_bf16 v[16:31], v[108:111], v[104:107], v[72:87]
    v_exp_f32 v38, v38
    ds_read_b128 v[108:111], v112 offset:5120
    v_exp_f32 v39, v39
    ds_read_b128 v[56:59], v113 offset:4096
    v_cvt_pk_bf16_f32 v48, v32, v33
    v_cvt_pk_bf16_f32 v49, v34, v35
    v_cvt_pk_bf16_f32 v50, v36, v37
    v_cvt_pk_bf16_f32 v51, v38, v39
    v_exp_f32 v40, v40
    ds_read_b128 v[60:63], v113 offset:4608
    v_exp_f32 v41, v41
    v_mfma_f32_32x32x16_bf16 v[88:103], v[64:67], v[48:51], v[88:103]
    v_exp_f32 v42, v42
    v_exp_f32 v43, v43
    v_exp_f32 v44, v44
    v_exp_f32 v45, v45
    v_exp_f32 v46, v46
    v_exp_f32 v47, v47
    v_cvt_pk_bf16_f32 v52, v40, v41
    v_cvt_pk_bf16_f32 v53, v42, v43
    v_cvt_pk_bf16_f32 v54, v44, v45
    v_cvt_pk_bf16_f32 v55, v46, v47
    v_exp_f32 v16, v16
    v_exp_f32 v17, v17
    v_mfma_f32_32x32x16_bf16 v[88:103], v[68:71], v[52:55], v[88:103]
    v_exp_f32 v18, v18
    v_exp_f32 v19, v19
    v_exp_f32 v20, v20
    s_waitcnt lgkmcnt(0)
    v_exp_f32 v21, v21
    v_mfma_f32_32x32x16_bf16 v[32:47], v[108:111], v[104:107], v[72:87]
    v_exp_f32 v22, v22
    ds_read_b128 v[108:111], v112 offset:6144
    v_exp_f32 v23, v23
    ds_read_b128 v[64:67], v113 offset:5120
    v_cvt_pk_bf16_f32 v48, v16, v17
    v_cvt_pk_bf16_f32 v49, v18, v19
    v_cvt_pk_bf16_f32 v50, v20, v21
    v_cvt_pk_bf16_f32 v51, v22, v23
    v_exp_f32 v24, v24
    ds_read_b128 v[68:71], v113 offset:5632
    v_exp_f32 v25, v25
    v_mfma_f32_32x32x16_bf16 v[88:103], v[56:59], v[48:51], v[88:103]
    v_exp_f32 v26, v26
    v_exp_f32 v27, v27
    v_exp_f32 v28, v28
    v_exp_f32 v29, v29
    v_exp_f32 v30, v30
    v_exp_f32 v31, v31
    v_cvt_pk_bf16_f32 v52, v24, v25
    v_cvt_pk_bf16_f32 v53, v26, v27
    v_cvt_pk_bf16_f32 v54, v28, v29
    v_cvt_pk_bf16_f32 v55, v30, v31
    s_cmp_lt_u32 s28, 7
    s_cbranch_scc1 L_l0_pe
    s_setprio 0
L_l0_pe:
    v_exp_f32 v32, v32
    v_exp_f32 v33, v33
    v_mfma_f32_32x32x16_bf16 v[88:103], v[60:63], v[52:55], v[88:103]
    v_exp_f32 v34, v34
    v_exp_f32 v35, v35
    v_exp_f32 v36, v36
    s_waitcnt lgkmcnt(0)
    v_exp_f32 v37, v37
    v_mfma_f32_32x32x16_bf16 v[16:31], v[108:111], v[104:107], v[72:87]
    v_exp_f32 v38, v38
    ds_read_b128 v[108:111], v112 offset:7168
    v_exp_f32 v39, v39
    ds_read_b128 v[56:59], v113 offset:6144
    v_cvt_pk_bf16_f32 v48, v32, v33
    v_cvt_pk_bf16_f32 v49, v34, v35
    v_cvt_pk_bf16_f32 v50, v36, v37
    v_cvt_pk_bf16_f32 v51, v38, v39
    v_exp_f32 v40, v40
    ds_read_b128 v[60:63], v113 offset:6656
    v_exp_f32 v41, v41
    v_mfma_f32_32x32x16_bf16 v[88:103], v[64:67], v[48:51], v[88:103]
    v_exp_f32 v42, v42
    v_exp_f32 v43, v43
    v_exp_f32 v44, v44
    v_exp_f32 v45, v45
    v_exp_f32 v46, v46
    v_exp_f32 v47, v47
    v_cvt_pk_bf16_f32 v52, v40, v41
    v_cvt_pk_bf16_f32 v53, v42, v43
    v_cvt_pk_bf16_f32 v54, v44, v45
    v_cvt_pk_bf16_f32 v55, v46, v47
    v_exp_f32 v16, v16
    v_exp_f32 v17, v17
    v_mfma_f32_32x32x16_bf16 v[88:103], v[68:71], v[52:55], v[88:103]
    v_exp_f32 v18, v18
    v_exp_f32 v19, v19
    v_exp_f32 v20, v20
    s_waitcnt lgkmcnt(0)
    v_exp_f32 v21, v21
    v_mfma_f32_32x32x16_bf16 v[32:47], v[108:111], v[104:107], v[72:87]
    v_exp_f32 v22, v22
    ds_read_b128 v[108:111], v112 offset:8192
    v_exp_f32 v23, v23
    ds_read_b128 v[64:67], v113 offset:7168
    v_cvt_pk_bf16_f32 v48, v16, v17
    v_cvt_pk_bf16_f32 v49, v18, v19
    v_cvt_pk_bf16_f32 v50, v20, v21
    v_cvt_pk_bf16_f32 v51, v22, v23
    v_exp_f32 v24, v24
    ds_read_b128 v[68:71], v113 offset:7680
    v_exp_f32 v25, v25
    v_mfma_f32_32x32x16_bf16 v[88:103], v[56:59], v[48:51], v[88:103]
    v_exp_f32 v26, v26
    v_exp_f32 v27, v27
    v_exp_f32 v28, v28
    v_exp_f32 v29, v29
    v_exp_f32 v30, v30
    v_exp_f32 v31, v31
    v_cvt_pk_bf16_f32 v52, v24, v25
    v_cvt_pk_bf16_f32 v53, v26, v27
    v_cvt_pk_bf16_f32 v54, v28, v29
    v_cvt_pk_bf16_f32 v55, v30, v31
    v_exp_f32 v32, v32
    v_exp_f32 v33, v33
    v_mfma_f32_32x32x16_bf16 v[88:103], v[60:63], v[52:55], v[88:103]
    v_exp_f32 v34, v34
    v_exp_f32 v35, v35
    v_exp_f32 v36, v36
    s_waitcnt lgkmcnt(0)
    v_exp_f32 v37, v37
    v_mfma_f32_32x32x16_bf16 v[16:31], v[108:111], v[104:107], v[72:87]
    v_exp_f32 v38, v38
    ds_read_b128 v[108:111], v112 offset:9216
    v_exp_f32 v39, v39
    ds_read_b128 v[56:59], v113 offset:8192
    v_cvt_pk_bf16_f32 v48, v32, v33
    v_cvt_pk_bf16_f32 v49, v34, v35
    v_cvt_pk_bf16_f32 v50, v36, v37
    v_cvt_pk_bf16_f32 v51, v38, v39
    v_exp_f32 v40, v40
    ds_read_b128 v[60:63], v113 offset:8704
    v_exp_f32 v41, v41
    v_mfma_f32_32x32x16_bf16 v[88:103], v[64:67], v[48:51], v[88:103]
    v_exp_f32 v42, v42
    v_exp_f32 v43, v43
    v_exp_f32 v44, v44
    v_exp_f32 v45, v45
    v_exp_f32 v46, v46
    v_exp_f32 v47, v47
    v_cvt_pk_bf16_f32 v52, v40, v41
    v_cvt_pk_bf16_f32 v53, v42, v43
    v_cvt_pk_bf16_f32 v54, v44, v45
    v_cvt_pk_bf16_f32 v55, v46, v47
    v_add_u32 v112, 0x2000, v112
    v_add_u32 v113, v114, v113
    s_add_u32 s28, s28, 1
    s_cmp_lt_u32 s28, 8
    s_cbranch_scc1 L_l0_loop
    v_mfma_f32_32x32x16_bf16 v[88:103], v[68:71], v[52:55], v[88:103]
    s_waitcnt lgkmcnt(0)
    s_nop 11
    s_cmp_lg_u32 s30, 0
    s_cbranch_scc1 L_l0_fin
    v_cmp_nge_f32 vcc, s27, v96
    s_nop 1
    s_cbranch_vccz L_l0_fin
    s_mov_b32 s30, 1
    v_mov_b32 v112, v3
    v_mov_b32 v2, 0xff800000
    s_mov_b32 s28, 0
L_l0_maxloop:
    ds_read_b128 v[108:111], v112
    s_waitcnt lgkmcnt(0)
    v_mfma_f32_32x32x16_bf16 v[16:31], v[108:111], v[104:107], 0
    v_add_u32 v112, 0x400, v112
    s_nop 11
    v_max3_f32 v2, v2, v16, v17
    v_max3_f32 v2, v2, v18, v19
    v_max3_f32 v2, v2, v20, v21
    v_max3_f32 v2, v2, v22, v23
    v_max3_f32 v2, v2, v24, v25
    v_max3_f32 v2, v2, v26, v27
    v_max3_f32 v2, v2, v28, v29
    v_max3_f32 v2, v2, v30, v31
    s_add_u32 s28, s28, 1
    s_cmp_lt_u32 s28, 64
    s_cbranch_scc1 L_l0_maxloop
    v_mov_b32 v7, v2
    s_nop 1
    v_permlane32_swap_b32 v2, v7
    v_max_f32 v2, v2, v7
    v_sub_f32 v72, 0, v2
    v_sub_f32 v73, 0, v2
    v_sub_f32 v74, 0, v2
    v_sub_f32 v75, 0, v2
    v_sub_f32 v76, 0, v2
    v_sub_f32 v77, 0, v2
    v_sub_f32 v78, 0, v2
    v_sub_f32 v79, 0, v2
    v_sub_f32 v80, 0, v2
    v_sub_f32 v81, 0, v2
    v_sub_f32 v82, 0, v2
    v_sub_f32 v83, 0, v2
    v_sub_f32 v84, 0, v2
    v_sub_f32 v85, 0, v2
    v_sub_f32 v86, 0, v2
    v_sub_f32 v87, 0, v2
    v_mov_b32 v112, v3
    v_mov_b32 v113, v115
    v_mov_b32 v88, 0
    v_mov_b32 v89, 0
    v_mov_b32 v90, 0
    v_mov_b32 v91, 0
    v_mov_b32 v92, 0
    v_mov_b32 v93, 0
    v_mov_b32 v94, 0
    v_mov_b32 v95, 0
    v_mov_b32 v96, 0
    v_mov_b32 v97, 0
    v_mov_b32 v98, 0
    v_mov_b32 v99, 0
    v_mov_b32 v100, 0
    v_mov_b32 v101, 0
    v_mov_b32 v102, 0
    v_mov_b32 v103, 0
    v_mov_b32 v52, 0
    v_mov_b32 v53, 0
    v_mov_b32 v54, 0
    v_mov_b32 v55, 0
    v_mov_b32 v68, 0
    v_mov_b32 v69, 0
    v_mov_b32 v70, 0
    v_mov_b32 v71, 0
    ds_read_b128 v[108:111], v112
    ds_read_b128 v[56:59], v113
    ds_read_b128 v[60:63], v113 offset:512
    s_waitcnt lgkmcnt(0)
    v_mfma_f32_32x32x16_bf16 v[16:31], v[108:111], v[104:107], v[72:87]
    ds_read_b128 v[108:111], v112 offset:1024
    s_nop 10
    s_mov_b32 s28, 0
    s_branch L_l0_loop
L_l0_fin:
    v_rcp_f32 v2, v96
    s_nop 0
    v_mul_f32 v88, v88, v2
    v_mul_f32 v89, v89, v2
    v_mul_f32 v90, v90, v2
    v_mul_f32 v91, v91, v2
    v_mul_f32 v92, v92, v2
    v_mul_f32 v93, v93, v2
    v_mul_f32 v94, v94, v2
    v_mul_f32 v95, v95, v2
    v_cvt_pk_bf16_f32 v48, v88, v89
    v_cvt_pk_bf16_f32 v49, v90, v91
    v_cvt_pk_bf16_f32 v50, v92, v93
    v_cvt_pk_bf16_f32 v51, v94, v95
    global_store_dwordx4 v4, v[48:51], s[56:57] sc1
    v_and_b32 v6, 31, v1
    v_lshrrev_b32 v7, 5, v1
    s_lshl_b32 s44, s35, 19
    s_lshl_b32 s45, s36, 10
    s_add_u32 s44, s44, s45
    v_add_u32 v10, s44, v3
    s_lshl_b32 s44, s24, 13
    s_add_u32 s44, s44, 0x10000
    v_add_u32 v12, s44, v3
    s_lshl_b32 s44, s25, 12
    s_lshl_b32 s45, s22, 7
    s_add_u32 s44, s44, s45
    s_add_u32 s44, s44, 0x1300000
    v_mov_b32 v13, s44
    v_mov_b32 v14, s31
    s_lshl_b32 s44, s36, 12
    s_lshl_b32 s45, s35, 10
    s_add_u32 s44, s44, s45
    s_add_u32 s44, s44, 0x1300000
    v_lshl_add_u32 v31, v1, 7, s44
    s_lshl_b32 s44, s23, 15
    s_add_u32 s44, s44, 0x1300000
    v_lshl_add_u32 v31, v6, 7, s44
    s_waitcnt vmcnt(0)
    s_barrier
    s_cmp_lg_u32 s24, 0
    s_cbranch_scc1 L_l0_nof
    s_mov_b64 exec, 1
    global_store_dword v13, v14, s[10:11] sc0 sc1
    s_mov_b64 exec, -1
L_l0_nof:
    ds_write_b128 v12, a[0:3] offset:0
    ds_write_b128 v12, a[4:7] offset:1024
    ds_write_b128 v12, a[8:11] offset:2048
    ds_write_b128 v12, a[12:15] offset:3072
    ds_write_b128 v12, a[16:19] offset:4096
    ds_write_b128 v12, a[20:23] offset:5120
    ds_write_b128 v12, a[24:27] offset:6144
    ds_write_b128 v12, a[28:31] offset:7168
    global_load_dwordx4 v[16:19], v3, s[12:13]
    s_lshl_b32 s44, s24, 11
    v_lshl_add_u32 v13, v1, 5, s44
    ds_write_b128 v13, a[112:115]
    ds_write_b128 v13, a[116:119] offset:16
    v_add_u32 v13, s26, v3
    ds_write_b128 v13, a[120:123] offset:16384
    v_bfe_u32 v13, v1, 2, 2
    v_and_b32 v14, 3, v1
    v_lshl_add_u32 v12, v7, 2, v13
    v_lshlrev_b32 v12, 7, v12
    v_lshl_add_u32 v12, v14, 3, v12
    v_bfe_u32 v15, v1, 4, 1
    v_lshl_add_u32 v12, v15, 5, v12
    s_lshl_b32 s45, s35, 5
    v_xor_b32 v12, s45, v12
    s_lshl_b32 s45, s35, 14
    s_add_u32 s45, s45, 0x10000
    v_add_u32 v12, s45, v12
    v_xor_b32 v15, 64, v12
    s_waitcnt lgkmcnt(0)
    s_barrier
    ds_read_b64_tr_b16 a[0:1], v12 offset:0
    ds_read_b64_tr_b16 a[2:3], v12 offset:1024
    ds_read_b64_tr_b16 a[4:5], v15 offset:0
    ds_read_b64_tr_b16 a[6:7], v15 offset:1024
    ds_read_b64_tr_b16 a[8:9], v12 offset:2048
    ds_read_b64_tr_b16 a[10:11], v12 offset:3072
    ds_read_b64_tr_b16 a[12:13], v15 offset:2048
    ds_read_b64_tr_b16 a[14:15], v15 offset:3072
    s_waitcnt lgkmcnt(0)
    ds_read_b64_tr_b16 a[16:17], v12 offset:4096
    ds_read_b64_tr_b16 a[18:19], v12 offset:5120
    ds_read_b64_tr_b16 a[20:21], v15 offset:4096
    ds_read_b64_tr_b16 a[22:23], v15 offset:5120
    ds_read_b64_tr_b16 a[24:25], v12 offset:6144
    ds_read_b64_tr_b16 a[26:27], v12 offset:7168
    ds_read_b64_tr_b16 a[28:29], v15 offset:6144
    ds_read_b64_tr_b16 a[30:31], v15 offset:7168
    s_waitcnt lgkmcnt(0)
    ds_read_b64_tr_b16 a[32:33], v12 offset:8192
    ds_read_b64_tr_b16 a[34:35], v12 offset:9216
    ds_read_b64_tr_b16 a[36:37], v15 offset:8192
    ds_read_b64_tr_b16 a[38:39], v15 offset:9216
    ds_read_b64_tr_b16 a[40:41], v12 offset:10240
    ds_read_b64_tr_b16 a[42:43], v12 offset:11264
    ds_read_b64_tr_b16 a[44:45], v15 offset:10240
    ds_read_b64_tr_b16 a[46:47], v15 offset:11264
    s_waitcnt lgkmcnt(0)
    ds_read_b64_tr_b16 a[48:49], v12 offset:12288
    ds_read_b64_tr_b16 a[50:51], v12 offset:13312
    ds_read_b64_tr_b16 a[52:53], v15 offset:12288
    ds_read_b64_tr_b16 a[54:55], v15 offset:13312
    ds_read_b64_tr_b16 a[56:57], v12 offset:14336
    ds_read_b64_tr_b16 a[58:59], v12 offset:15360
    ds_read_b64_tr_b16 a[60:61], v15 offset:14336
    ds_read_b64_tr_b16 a[62:63], v15 offset:15360
    s_waitcnt lgkmcnt(0)
    v_lshrrev_b32 v15, 4, v1
    v_lshl_add_u32 v13, v15, 3, v13
    v_lshlrev_b32 v13, 5, v13
    v_lshl_add_u32 v13, v14, 3, v13
    v_add_u32 v13, s44, v13
    ds_read_b64_tr_b16 a[112:113], v13 offset:0
    ds_read_b64_tr_b16 a[114:115], v13 offset:128
    ds_read_b64_tr_b16 a[116:117], v13 offset:1024
    ds_read_b64_tr_b16 a[118:119], v13 offset:1152
    v_lshlrev_b32 v13, 1, v0
    ds_read_u16 a120, v13 offset:16384
    ds_read_u16 a121, v13 offset:17408
    ds_read_u16 a122, v13 offset:18432
    ds_read_u16 a123, v13 offset:19456
    ds_read_u16 a124, v13 offset:20480
    ds_read_u16 a125, v13 offset:21504
    ds_read_u16 a126, v13 offset:22528
    ds_read_u16 a127, v13 offset:23552
    v_mov_b32 v20, 0
    s_waitcnt vmcnt(0)
    v_dot2_f32_bf16 v20, v16, s63, v20
    v_dot2_f32_bf16 v20, v17, s63, v20
    v_dot2_f32_bf16 v20, v18, s63, v20
    v_dot2_f32_bf16 v20, v19, s63, v20
    s_nop 0
    s_nop 1
    v_add_f32_dpp v20, v20, v20 quad_perm:[1,0,3,2] row_mask:0xf bank_mask:0xf
    s_nop 1
    v_add_f32_dpp v20, v20, v20 quad_perm:[2,3,0,1] row_mask:0xf bank_mask:0xf
    s_nop 1
    v_add_f32_dpp v20, v20, v20 row_half_mirror row_mask:0xf bank_mask:0xf
    s_nop 1
    v_add_f32_dpp v20, v20, v20 row_mirror row_mask:0xf bank_mask:0xf
    v_mov_b32 v21, v20
    s_nop 1
    v_permlane16_swap_b32 v20, v21
    v_add_f32 v20, v20, v21
    v_mov_b32 v21, v20
    s_nop 1
    v_permlane32_swap_b32 v20, v21
    v_add_f32 v20, v20, v21
    s_nop 0
    v_readfirstlane_b32 s39, v20
    s_lshl_b32 s44, s34, 15
    s_xor_b32 s45, s35, 0
    s_lshl_b32 s45, s45, 13
    s_add_u32 s45, s45, s44
    v_add_u32 v27, s45, v3
    s_xor_b32 s45, s35, 1
    s_lshl_b32 s45, s45, 13
    s_add_u32 s45, s45, s44
    v_add_u32 v28, s45, v3
    s_xor_b32 s45, s35, 2
    s_lshl_b32 s45, s45, 13
    s_add_u32 s45, s45, s44
    v_add_u32 v29, s45, v3
    s_xor_b32 s45, s35, 3
    s_lshl_b32 s45, s45, 13
    s_add_u32 s45, s45, s44
    v_add_u32 v30, s45, v3
    v_lshlrev_b32 v96, 16, v116
    v_and_b32 v97, 0xffff0000, v116
    v_lshlrev_b32 v98, 16, v117
    v_and_b32 v99, 0xffff0000, v117
    v_lshlrev_b32 v100, 16, v118
    v_and_b32 v101, 0xffff0000, v118
    v_lshlrev_b32 v102, 16, v119
    v_and_b32 v103, 0xffff0000, v119
    s_cmp_lg_u32 s24, 0
    s_cbranch_scc1 L_l0_owait
    s_mov_b32 exec_lo, -1
    s_mov_b32 exec_hi, 0
    s_mov_b32 s29, 65536
L_l0_po:
L_l0_po_l:
    global_load_dword v14, v31, s[10:11] sc0 sc1
L_l0_po_w:
    s_waitcnt vmcnt(0)
    v_cmp_ne_u32 vcc, s31, v14
    s_sub_u32 s29, s29, 1
    s_cbranch_vccz L_l0_po_ok
    s_cbranch_scc0 L_l0_po
L_l0_po_ok:
    s_mov_b64 exec, -1
L_l0_owait:
    s_waitcnt lgkmcnt(0)
    s_barrier
    global_load_dwordx4 v[64:67], v10, s[56:57] sc1
    v_add_u32 v10, 0x10000, v10
    global_load_dwordx4 v[68:71], v10, s[56:57] sc1
    v_add_u32 v10, 0x10000, v10
    global_load_dwordx4 v[72:75], v10, s[56:57] sc1
    v_add_u32 v10, 0x10000, v10
    global_load_dwordx4 v[76:79], v10, s[56:57] sc1
    v_add_u32 v10, 0x10000, v10
    global_load_dwordx4 v[80:83], v10, s[56:57] sc1
    v_add_u32 v10, 0x10000, v10
    global_load_dwordx4 v[84:87], v10, s[56:57] sc1
    v_add_u32 v10, 0x10000, v10
    global_load_dwordx4 v[88:91], v10, s[56:57] sc1
    v_add_u32 v10, 0x10000, v10
    global_load_dwordx4 v[92:95], v10, s[56:57] sc1
    s_waitcnt vmcnt(7)
    v_mfma_f32_32x32x16_bf16 v[32:47], a[0:3], v[64:67], 0
    v_mfma_f32_32x32x16_bf16 v[48:63], a[4:7], v[64:67], 0
    s_waitcnt vmcnt(6)
    v_mfma_f32_32x32x16_bf16 v[32:47], a[8:11], v[68:71], v[32:47]
    v_mfma_f32_32x32x16_bf16 v[48:63], a[12:15], v[68:71], v[48:63]
    s_waitcnt vmcnt(5)
    v_mfma_f32_32x32x16_bf16 v[32:47], a[16:19], v[72:75], v[32:47]
    v_mfma_f32_32x32x16_bf16 v[48:63], a[20:23], v[72:75], v[48:63]
    s_waitcnt vmcnt(4)
    v_mfma_f32_32x32x16_bf16 v[32:47], a[24:27], v[76:79], v[32:47]
    v_mfma_f32_32x32x16_bf16 v[48:63], a[28:31], v[76:79], v[48:63]
    s_waitcnt vmcnt(3)
    v_mfma_f32_32x32x16_bf16 v[32:47], a[32:35], v[80:83], v[32:47]
    v_mfma_f32_32x32x16_bf16 v[48:63], a[36:39], v[80:83], v[48:63]
    s_waitcnt vmcnt(2)
    v_mfma_f32_32x32x16_bf16 v[32:47], a[40:43], v[84:87], v[32:47]
    v_mfma_f32_32x32x16_bf16 v[48:63], a[44:47], v[84:87], v[48:63]
    s_waitcnt vmcnt(1)
    v_mfma_f32_32x32x16_bf16 v[32:47], a[48:51], v[88:91], v[32:47]
    v_mfma_f32_32x32x16_bf16 v[48:63], a[52:55], v[88:91], v[48:63]
    s_waitcnt vmcnt(0)
    v_mfma_f32_32x32x16_bf16 v[32:47], a[56:59], v[92:95], v[32:47]
    v_mfma_f32_32x32x16_bf16 v[48:63], a[60:63], v[92:95], v[48:63]
    s_lshl_b32 s44, s34, 12
    s_lshl_b32 s45, s35, 10
    s_add_u32 s44, s44, s45
    s_add_u32 s44, s44, 141312
    v_add_u32 v13, s44, v3
    s_add_u32 s58, s10, 0x0
    s_addc_u32 s59, s11, 0
    s_nop 4
    ds_write_b128 v28, v[40:43] offset:2048
    ds_write_b128 v28, v[44:47] offset:3072
    ds_write_b128 v29, v[48:51] offset:4096
    ds_write_b128 v29, v[52:55] offset:5120
    ds_write_b128 v30, v[56:59] offset:6144
    ds_write_b128 v30, v[60:63] offset:7168
    v_add_f32 v32, v32, v96
    v_add_f32 v33, v33, v97
    v_add_f32 v34, v34, v98
    v_add_f32 v35, v35, v99
    v_add_f32 v36, v36, v100
    v_add_f32 v37, v37, v101
    v_add_f32 v38, v38, v102
    v_add_f32 v39, v39, v103
    s_waitcnt lgkmcnt(0)
    s_barrier
    ds_read_b128 v[40:43], v27 offset:2048
    ds_read_b128 v[44:47], v27 offset:3072
    ds_read_b128 v[48:51], v27 offset:4096
    ds_read_b128 v[52:55], v27 offset:5120
    ds_read_b128 v[56:59], v27 offset:6144
    ds_read_b128 v[60:63], v27 offset:7168
    s_waitcnt lgkmcnt(4)
    v_add_f32 v32, v32, v40
    v_add_f32 v33, v33, v41
    v_add_f32 v34, v34, v42
    v_add_f32 v35, v35, v43
    v_add_f32 v36, v36, v44
    v_add_f32 v37, v37, v45
    v_add_f32 v38, v38, v46
    v_add_f32 v39, v39, v47
    s_waitcnt lgkmcnt(0)
    v_add_f32 v48, v48, v56
    v_add_f32 v49, v49, v57
    v_add_f32 v50, v50, v58
    v_add_f32 v51, v51, v59
    v_add_f32 v52, v52, v60
    v_add_f32 v53, v53, v61
    v_add_f32 v54, v54, v62
    v_add_f32 v55, v55, v63
    v_add_f32 v32, v32, v48
    v_add_f32 v33, v33, v49
    v_add_f32 v34, v34, v50
    v_add_f32 v35, v35, v51
    v_add_f32 v36, v36, v52
    v_add_f32 v37, v37, v53
    v_add_f32 v38, v38, v54
    v_add_f32 v39, v39, v55
    v_cvt_pk_bf16_f32 v24, v32, v33
    v_cvt_pk_bf16_f32 v25, v34, v35
    v_cvt_pk_bf16_f32 v26, v36, v37
    v_cvt_pk_bf16_f32 v27, v38, v39
    v_mov_b32 v116, v24
    v_mov_b32 v117, v25
    v_mov_b32 v118, v26
    v_mov_b32 v119, v27
    v_permlane32_swap_b32 v24, v26
    v_permlane32_swap_b32 v25, v27
    global_store_dwordx4 v124, v[24:27], s[58:59] sc1
    v_dot2_f32_bf16 v16, v116, s63, 0
    v_dot2_f32_bf16 v17, v116, v116, 0
    v_dot2_f32_bf16 v18, v116, v120, 0
    v_dot2_f32_bf16 v16, v117, s63, v16
    v_dot2_f32_bf16 v17, v117, v117, v17
    v_dot2_f32_bf16 v18, v117, v121, v18
    v_dot2_f32_bf16 v16, v118, s63, v16
    v_dot2_f32_bf16 v17, v118, v118, v17
    v_dot2_f32_bf16 v18, v118, v122, v18
    v_dot2_f32_bf16 v16, v119, s63, v16
    v_dot2_f32_bf16 v17, v119, v119, v17
    v_dot2_f32_bf16 v18, v119, v123, v18
    s_nop 2
    ds_write_b96 v13, v[16:18]
    s_waitcnt vmcnt(0) lgkmcnt(0)
    s_waitcnt vmcnt(0) lgkmcnt(0)
    s_barrier
    s_cmp_lg_u32 s24, 0
    s_cbranch_scc1 L_l0_nost
    v_lshlrev_b32 v13, 4, v6
    v_lshl_add_u32 v13, v7, 12, v13
    v_add_u32 v13, 141312, v13
    ds_read_b96 v[32:34], v13 offset:0
    ds_read_b96 v[36:38], v13 offset:512
    ds_read_b96 v[40:42], v13 offset:1024
    ds_read_b96 v[44:46], v13 offset:1536
    ds_read_b96 v[48:50], v13 offset:2048
    ds_read_b96 v[52:54], v13 offset:2560
    ds_read_b96 v[56:58], v13 offset:3072
    ds_read_b96 v[60:62], v13 offset:3584
    s_lshl_b32 s44, s33, 3
    s_add_u32 s44, s44, s32
    s_lshl_b32 s44, s44, 10
    s_add_u32 s44, s44, 0x1000000
    v_add_u32 v13, s44, v3
    v_mov_b32 v35, s31
    s_waitcnt lgkmcnt(0)
    v_add_f32 v32, v32, v36
    v_add_f32 v33, v33, v37
    v_add_f32 v34, v34, v38
    v_add_f32 v32, v32, v40
    v_add_f32 v33, v33, v41
    v_add_f32 v34, v34, v42
    v_add_f32 v32, v32, v44
    v_add_f32 v33, v33, v45
    v_add_f32 v34, v34, v46
    v_add_f32 v32, v32, v48
    v_add_f32 v33, v33, v49
    v_add_f32 v34, v34, v50
    v_add_f32 v32, v32, v52
    v_add_f32 v33, v33, v53
    v_add_f32 v34, v34, v54
    v_add_f32 v32, v32, v56
    v_add_f32 v33, v33, v57
    v_add_f32 v34, v34, v58
    v_add_f32 v32, v32, v60
    v_add_f32 v33, v33, v61
    v_add_f32 v34, v34, v62
    global_store_dwordx4 v13, v[32:35], s[10:11] sc0 sc1
L_l0_nost:
    s_lshl_b32 s44, s25, 15
    v_add_u32 v8, s44, v3
    v_add_u32 v9, 0x4000, v8
    s_lshr_b32 s44, s25, 1
    s_lshl_b32 s44, s44, 13
    s_and_b32 s45, s25, 1
    s_lshl_b32 s45, s45, 9
    s_add_u32 s44, s44, s45
    s_add_u32 s44, s44, 0x1000000
    v_lshl_add_u32 v11, v6, 4, s44
    v_lshl_add_u32 v11, v7, 12, v11
    s_lshr_b32 s67, s22, 1
    s_mul_i32 s44, s24, 6144
    s_add_u32 s44, s44, 8192
    v_add_u32 v14, s44, v3
    ds_write_b128 v14, a[88:91] offset:0
    ds_write_b128 v14, a[92:95] offset:1024
    ds_write_b128 v14, a[96:99] offset:2048
    ds_write_b128 v14, a[100:103] offset:3072
    ds_write_b128 v14, a[104:107] offset:4096
    ds_write_b128 v14, a[108:111] offset:5120
    s_lshl_b32 s44, s33, 13
    s_add_u32 s44, s44, 0x1000000
    v_lshl_add_u32 v12, v0, 4, s44
    s_cmp_lg_u32 s24, 0
    s_cbranch_scc1 L_l0_a1
    s_waitcnt vmcnt(0)
L_l0_a1:
    s_barrier
    s_lshr_b32 s44, s25, 1
    s_lshl_b32 s44, s44, 13
    s_add_u32 s44, s44, 0x100000c
    v_and_b32 v13, 7, v1
    v_lshl_add_u32 v13, v13, 10, s44
    global_load_dwordx4 v[32:35], v12, s[10:11] sc0 sc1
    global_load_dword v36, v13, s[10:11] sc0 sc1
    v_bfe_u32 v15, v1, 2, 2
    v_lshl_add_u32 v15, v7, 4, v15
    v_bfe_u32 v14, v1, 4, 1
    v_lshl_add_u32 v15, v14, 2, v15
    v_and_b32 v14, 3, v1
    v_lshlrev_b32 v14, 3, v14
    v_lshl_add_u32 v10, v15, 5, v14
    v_add_u32 v10, 8192, v10
    s_mov_b32 s29, 65536
    s_branch L_l0_pa_w
L_l0_pa:
L_l0_pa_l:
    global_load_dwordx4 v[32:35], v12, s[10:11] sc0 sc1
    global_load_dword v36, v13, s[10:11] sc0 sc1
L_l0_pa_w:
    s_waitcnt vmcnt(0)
    v_cmp_ne_u32 vcc, s31, v35
    v_cmp_ne_u32 s[42:43], s31, v36
    s_or_b64 vcc, vcc, s[42:43]
    s_sub_u32 s29, s29, 1
    s_cbranch_vccz L_l0_pa_ok
    s_cbranch_scc0 L_l0_pa
L_l0_pa_ok:
    v_lshlrev_b32 v13, 4, v0
    ds_write_b96 v13, v[32:34]
    s_waitcnt lgkmcnt(0)
    s_barrier
    ds_read_b96 v[16:18], v3 offset:0
    ds_read_b96 v[20:22], v3 offset:1024
    ds_read_b96 v[24:26], v3 offset:2048
    ds_read_b96 v[28:30], v3 offset:3072
    ds_read_b96 v[32:34], v3 offset:4096
    ds_read_b96 v[36:38], v3 offset:5120
    ds_read_b96 v[40:42], v3 offset:6144
    ds_read_b96 v[44:46], v3 offset:7168
    s_waitcnt lgkmcnt(0)
    v_add_f32 v16, v16, v20
    v_add_f32 v17, v17, v21
    v_add_f32 v18, v18, v22
    v_add_f32 v24, v24, v28
    v_add_f32 v25, v25, v29
    v_add_f32 v26, v26, v30
    v_add_f32 v32, v32, v36
    v_add_f32 v33, v33, v37
    v_add_f32 v34, v34, v38
    v_add_f32 v40, v40, v44
    v_add_f32 v41, v41, v45
    v_add_f32 v42, v42, v46
    v_add_f32 v16, v16, v24
    v_add_f32 v17, v17, v25
    v_add_f32 v18, v18, v26
    v_add_f32 v32, v32, v40
    v_add_f32 v33, v33, v41
    v_add_f32 v34, v34, v42
    v_add_f32 v16, v16, v32
    v_add_f32 v17, v17, v33
    v_add_f32 v18, v18, v34
    v_mul_f32 v126, s64, v16
    v_mul_f32 v20, s64, v17
    v_fma_f32 v20, -v126, v126, v20
    v_max_f32 v20, 0, v20
    v_add_f32 v127, s65, v20
    v_rsq_f32 v127, v127
    s_or_b32 s44, s32, s24
    s_cmp_lg_u32 s44, 0
    s_cbranch_scc1 L_l0_nokey
    v_fma_f32 v18, -v126, s39, v18
    v_mul_f32 v18, v18, v127
    v_cvt_pk_bf16_f32 v18, v18, v18
    v_and_b32 v18, 0xffff0000, v18
    v_ashrrev_i32 v19, 31, v18
    v_or_b32 v19, 0x80000000, v19
    v_xor_b32 v19, v19, v18
    v_and_b32 v19, 0xffff0000, v19
    s_lshl_b32 s44, s33, 6
    s_sub_u32 s44, 2047, s44
    v_sub_u32 v20, s44, v1
    v_or_b32 v20, v19, v20
    v_mov_b32 v24, v20
    s_nop 1
    v_max_u32_dpp v24, v24, v24 quad_perm:[1,0,3,2] row_mask:0xf bank_mask:0xf
    s_nop 1
    v_max_u32_dpp v24, v24, v24 quad_perm:[2,3,0,1] row_mask:0xf bank_mask:0xf
    s_nop 1
    v_max_u32_dpp v24, v24, v24 row_half_mirror row_mask:0xf bank_mask:0xf
    s_nop 1
    v_max_u32_dpp v24, v24, v24 row_mirror row_mask:0xf bank_mask:0xf
    v_mov_b32 v25, v24
    s_nop 1
    v_permlane16_swap_b32 v24, v25
    v_max_u32 v24, v24, v25
    v_mov_b32 v25, v24
    s_nop 1
    v_permlane32_swap_b32 v24, v25
    v_max_u32 v24, v24, v25
    v_cmp_eq_u32 vcc, v24, v20
    s_lshl_b32 s44, s33, 7
    s_add_u32 s44, s44, 0x12c0000
    s_ff1_i32_b64 s45, vcc
    v_lshl_add_u32 v13, v1, 12, s44
    v_mov_b32 v27, s31
    v_readlane_b32 s46, v126, s45
    v_readlane_b32 s47, v127, s45
    s_mov_b64 exec, 0xff
    s_nop 0
    v_mov_b32 v25, s46
    v_mov_b32 v26, s47
    global_store_dwordx4 v13, v[24:27], s[10:11] sc0 sc1
    s_mov_b64 exec, -1
L_l0_nokey:
    v_mov_b32 v16, v126
    v_mov_b32 v17, v127
    s_cmp_eq_u32 s34, 1
    s_cselect_b64 vcc, -1, 0
    v_permlane32_swap_b32 v126, v16
    v_permlane32_swap_b32 v127, v17
    v_cndmask_b32 v126, v126, v16, vcc
    v_cndmask_b32 v127, v127, v17, vcc
    s_add_u32 s40, s67, 0
    s_and_b32 s40, s40, 15
    s_lshl_b32 s40, s40, 10
    s_add_u32 s40, s58, s40
    s_addc_u32 s41, s59, 0
    global_load_dwordx4 a[64:67], v8, s[40:41] sc1
    global_load_dwordx4 a[68:71], v9, s[40:41] sc1
    s_add_u32 s40, s67, 1
    s_and_b32 s40, s40, 15
    s_lshl_b32 s40, s40, 10
    s_add_u32 s40, s58, s40
    s_addc_u32 s41, s59, 0
    global_load_dwordx4 a[72:75], v8, s[40:41] sc1
    global_load_dwordx4 a[76:79], v9, s[40:41] sc1
    s_add_u32 s40, s67, 2
    s_and_b32 s40, s40, 15
    s_lshl_b32 s40, s40, 10
    s_add_u32 s40, s58, s40
    s_addc_u32 s41, s59, 0
    global_load_dwordx4 a[80:83], v8, s[40:41] sc1
    global_load_dwordx4 a[84:87], v9, s[40:41] sc1
    s_add_u32 s40, s67, 3
    s_and_b32 s40, s40, 15
    s_lshl_b32 s40, s40, 10
    s_add_u32 s40, s58, s40
    s_addc_u32 s41, s59, 0
    global_load_dwordx4 a[88:91], v8, s[40:41] sc1
    global_load_dwordx4 a[92:95], v9, s[40:41] sc1
    s_add_u32 s40, s67, 4
    s_and_b32 s40, s40, 15
    s_lshl_b32 s40, s40, 10
    s_add_u32 s40, s58, s40
    s_addc_u32 s41, s59, 0
    global_load_dwordx4 a[96:99], v8, s[40:41] sc1
    global_load_dwordx4 a[100:103], v9, s[40:41] sc1
    s_add_u32 s40, s67, 5
    s_and_b32 s40, s40, 15
    s_lshl_b32 s40, s40, 10
    s_add_u32 s40, s58, s40
    s_addc_u32 s41, s59, 0
    global_load_dwordx4 a[104:107], v8, s[40:41] sc1
    global_load_dwordx4 a[108:111], v9, s[40:41] sc1
    s_add_u32 s40, s67, 0
    s_and_b32 s40, s40, 15
    s_lshl_b32 s40, s40, 10
    v_add_u32 v12, s40, v10
    ds_read_b64_tr_b16 v[40:41], v12 offset:0
    ds_read_b64_tr_b16 v[42:43], v12 offset:256
    ds_read_b64_tr_b16 v[44:45], v12 offset:16384
    ds_read_b64_tr_b16 v[46:47], v12 offset:16640
    ds_read_b64_tr_b16 v[48:49], v12 offset:32768
    ds_read_b64_tr_b16 v[50:51], v12 offset:33024
    s_add_u32 s40, s67, 1
    s_and_b32 s40, s40, 15
    s_lshl_b32 s40, s40, 10
    v_add_u32 v12, s40, v10
    ds_read_b64_tr_b16 v[52:53], v12 offset:0
    ds_read_b64_tr_b16 v[54:55], v12 offset:256
    ds_read_b64_tr_b16 v[56:57], v12 offset:16384
    ds_read_b64_tr_b16 v[58:59], v12 offset:16640
    ds_read_b64_tr_b16 v[60:61], v12 offset:32768
    ds_read_b64_tr_b16 v[62:63], v12 offset:33024
    s_setprio 3
    s_add_u32 s40, s67, 2
    s_and_b32 s40, s40, 15
    s_lshl_b32 s40, s40, 10
    v_add_u32 v12, s40, v10
    ds_read_b64_tr_b16 v[64:65], v12 offset:0
    ds_read_b64_tr_b16 v[66:67], v12 offset:256
    ds_read_b64_tr_b16 v[68:69], v12 offset:16384
    ds_read_b64_tr_b16 v[70:71], v12 offset:16640
    ds_read_b64_tr_b16 v[72:73], v12 offset:32768
    ds_read_b64_tr_b16 v[74:75], v12 offset:33024
    s_waitcnt vmcnt(10) lgkmcnt(12)
    v_mfma_f32_16x16x32_bf16 v[16:19], v[40:43], a[64:67], 0
    v_mfma_f32_16x16x32_bf16 v[20:23], v[40:43], a[68:71], 0
    v_mfma_f32_16x16x32_bf16 v[24:27], v[44:47], a[64:67], 0
    v_mfma_f32_16x16x32_bf16 v[28:31], v[44:47], a[68:71], 0
    v_mfma_f32_16x16x32_bf16 v[32:35], a[64:67], v[48:51], 0
    v_mfma_f32_16x16x32_bf16 v[36:39], a[68:71], v[48:51], 0
    s_add_u32 s40, s67, 6
    s_and_b32 s40, s40, 15
    s_lshl_b32 s40, s40, 10
    s_add_u32 s40, s58, s40
    s_addc_u32 s41, s59, 0
    global_load_dwordx4 a[64:67], v8, s[40:41] sc1
    global_load_dwordx4 a[68:71], v9, s[40:41] sc1
    s_add_u32 s40, s67, 3
    s_and_b32 s40, s40, 15
    s_lshl_b32 s40, s40, 10
    v_add_u32 v12, s40, v10
    ds_read_b64_tr_b16 v[40:41], v12 offset:0
    ds_read_b64_tr_b16 v[42:43], v12 offset:256
    ds_read_b64_tr_b16 v[44:45], v12 offset:16384
    ds_read_b64_tr_b16 v[46:47], v12 offset:16640
    ds_read_b64_tr_b16 v[48:49], v12 offset:32768
    ds_read_b64_tr_b16 v[50:51], v12 offset:33024
    s_waitcnt vmcnt(10) lgkmcnt(12)
    v_mfma_f32_16x16x32_bf16 v[16:19], v[52:55], a[72:75], v[16:19]
    v_mfma_f32_16x16x32_bf16 v[20:23], v[52:55], a[76:79], v[20:23]
    v_mfma_f32_16x16x32_bf16 v[24:27], v[56:59], a[72:75], v[24:27]
    v_mfma_f32_16x16x32_bf16 v[28:31], v[56:59], a[76:79], v[28:31]
    v_mfma_f32_16x16x32_bf16 v[32:35], a[72:75], v[60:63], v[32:35]
    v_mfma_f32_16x16x32_bf16 v[36:39], a[76:79], v[60:63], v[36:39]
    s_add_u32 s40, s67, 7
    s_and_b32 s40, s40, 15
    s_lshl_b32 s40, s40, 10
    s_add_u32 s40, s58, s40
    s_addc_u32 s41, s59, 0
    global_load_dwordx4 a[72:75], v8, s[40:41] sc1
    global_load_dwordx4 a[76:79], v9, s[40:41] sc1
    s_add_u32 s40, s67, 4
    s_and_b32 s40, s40, 15
    s_lshl_b32 s40, s40, 10
    v_add_u32 v12, s40, v10
    ds_read_b64_tr_b16 v[52:53], v12 offset:0
    ds_read_b64_tr_b16 v[54:55], v12 offset:256
    ds_read_b64_tr_b16 v[56:57], v12 offset:16384
    ds_read_b64_tr_b16 v[58:59], v12 offset:16640
    ds_read_b64_tr_b16 v[60:61], v12 offset:32768
    ds_read_b64_tr_b16 v[62:63], v12 offset:33024
    s_waitcnt vmcnt(10) lgkmcnt(12)
    v_mfma_f32_16x16x32_bf16 v[16:19], v[64:67], a[80:83], v[16:19]
    v_mfma_f32_16x16x32_bf16 v[20:23], v[64:67], a[84:87], v[20:23]
    v_mfma_f32_16x16x32_bf16 v[24:27], v[68:71], a[80:83], v[24:27]
    v_mfma_f32_16x16x32_bf16 v[28:31], v[68:71], a[84:87], v[28:31]
    v_mfma_f32_16x16x32_bf16 v[32:35], a[80:83], v[72:75], v[32:35]
    v_mfma_f32_16x16x32_bf16 v[36:39], a[84:87], v[72:75], v[36:39]
    s_add_u32 s40, s67, 5
    s_and_b32 s40, s40, 15
    s_lshl_b32 s40, s40, 10
    v_add_u32 v12, s40, v10
    ds_read_b64_tr_b16 v[64:65], v12 offset:0
    ds_read_b64_tr_b16 v[66:67], v12 offset:256
    ds_read_b64_tr_b16 v[68:69], v12 offset:16384
    ds_read_b64_tr_b16 v[70:71], v12 offset:16640
    ds_read_b64_tr_b16 v[72:73], v12 offset:32768
    ds_read_b64_tr_b16 v[74:75], v12 offset:33024
    s_waitcnt vmcnt(8) lgkmcnt(12)
    v_mfma_f32_16x16x32_bf16 v[16:19], v[40:43], a[88:91], v[16:19]
    v_mfma_f32_16x16x32_bf16 v[20:23], v[40:43], a[92:95], v[20:23]
    v_mfma_f32_16x16x32_bf16 v[24:27], v[44:47], a[88:91], v[24:27]
    v_mfma_f32_16x16x32_bf16 v[28:31], v[44:47], a[92:95], v[28:31]
    v_mfma_f32_16x16x32_bf16 v[32:35], a[88:91], v[48:51], v[32:35]
    v_mfma_f32_16x16x32_bf16 v[36:39], a[92:95], v[48:51], v[36:39]
    s_add_u32 s40, s67, 6
    s_and_b32 s40, s40, 15
    s_lshl_b32 s40, s40, 10
    v_add_u32 v12, s40, v10
    ds_read_b64_tr_b16 v[40:41], v12 offset:0
    ds_read_b64_tr_b16 v[42:43], v12 offset:256
    ds_read_b64_tr_b16 v[44:45], v12 offset:16384
    ds_read_b64_tr_b16 v[46:47], v12 offset:16640
    ds_read_b64_tr_b16 v[48:49], v12 offset:32768
    ds_read_b64_tr_b16 v[50:51], v12 offset:33024
    s_waitcnt vmcnt(6) lgkmcnt(12)
    v_mfma_f32_16x16x32_bf16 v[16:19], v[52:55], a[96:99], v[16:19]
    v_mfma_f32_16x16x32_bf16 v[20:23], v[52:55], a[100:103], v[20:23]
    v_mfma_f32_16x16x32_bf16 v[24:27], v[56:59], a[96:99], v[24:27]
    v_mfma_f32_16x16x32_bf16 v[28:31], v[56:59], a[100:103], v[28:31]
    v_mfma_f32_16x16x32_bf16 v[32:35], a[96:99], v[60:63], v[32:35]
    v_mfma_f32_16x16x32_bf16 v[36:39], a[100:103], v[60:63], v[36:39]
    s_add_u32 s40, s67, 7
    s_and_b32 s40, s40, 15
    s_lshl_b32 s40, s40, 10
    v_add_u32 v12, s40, v10
    ds_read_b64_tr_b16 v[52:53], v12 offset:0
    ds_read_b64_tr_b16 v[54:55], v12 offset:256
    ds_read_b64_tr_b16 v[56:57], v12 offset:16384
    ds_read_b64_tr_b16 v[58:59], v12 offset:16640
    ds_read_b64_tr_b16 v[60:61], v12 offset:32768
    ds_read_b64_tr_b16 v[62:63], v12 offset:33024
    s_waitcnt vmcnt(4) lgkmcnt(12)
    v_mfma_f32_16x16x32_bf16 v[16:19], v[64:67], a[104:107], v[16:19]
    v_mfma_f32_16x16x32_bf16 v[20:23], v[64:67], a[108:111], v[20:23]
    v_mfma_f32_16x16x32_bf16 v[24:27], v[68:71], a[104:107], v[24:27]
    v_mfma_f32_16x16x32_bf16 v[28:31], v[68:71], a[108:111], v[28:31]
    v_mfma_f32_16x16x32_bf16 v[32:35], a[104:107], v[72:75], v[32:35]
    v_mfma_f32_16x16x32_bf16 v[36:39], a[108:111], v[72:75], v[36:39]
    s_setprio 2
    s_add_u32 s40, s67, 8
    s_and_b32 s40, s40, 15
    s_lshl_b32 s40, s40, 10
    v_add_u32 v12, s40, v10
    ds_read_b64_tr_b16 v[64:65], v12 offset:0
    ds_read_b64_tr_b16 v[66:67], v12 offset:256
    ds_read_b64_tr_b16 v[68:69], v12 offset:16384
    ds_read_b64_tr_b16 v[70:71], v12 offset:16640
    ds_read_b64_tr_b16 v[72:73], v12 offset:32768
    ds_read_b64_tr_b16 v[74:75], v12 offset:33024
    s_waitcnt vmcnt(2) lgkmcnt(12)
    v_mfma_f32_16x16x32_bf16 v[16:19], v[40:43], a[64:67], v[16:19]
    v_mfma_f32_16x16x32_bf16 v[20:23], v[40:43], a[68:71], v[20:23]
    v_mfma_f32_16x16x32_bf16 v[24:27], v[44:47], a[64:67], v[24:27]
    v_mfma_f32_16x16x32_bf16 v[28:31], v[44:47], a[68:71], v[28:31]
    v_mfma_f32_16x16x32_bf16 v[32:35], a[64:67], v[48:51], v[32:35]
    v_mfma_f32_16x16x32_bf16 v[36:39], a[68:71], v[48:51], v[36:39]
    s_add_u32 s40, s67, 9
    s_and_b32 s40, s40, 15
    s_lshl_b32 s40, s40, 10
    v_add_u32 v12, s40, v10
    ds_read_b64_tr_b16 v[40:41], v12 offset:0
    ds_read_b64_tr_b16 v[42:43], v12 offset:256
    ds_read_b64_tr_b16 v[44:45], v12 offset:16384
    ds_read_b64_tr_b16 v[46:47], v12 offset:16640
    ds_read_b64_tr_b16 v[48:49], v12 offset:32768
    ds_read_b64_tr_b16 v[50:51], v12 offset:33024
    s_waitcnt vmcnt(0) lgkmcnt(12)
    v_mfma_f32_16x16x32_bf16 v[16:19], v[52:55], a[72:75], v[16:19]
    v_mfma_f32_16x16x32_bf16 v[20:23], v[52:55], a[76:79], v[20:23]
    v_mfma_f32_16x16x32_bf16 v[24:27], v[56:59], a[72:75], v[24:27]
    v_mfma_f32_16x16x32_bf16 v[28:31], v[56:59], a[76:79], v[28:31]
    v_mfma_f32_16x16x32_bf16 v[32:35], a[72:75], v[60:63], v[32:35]
    v_mfma_f32_16x16x32_bf16 v[36:39], a[76:79], v[60:63], v[36:39]
    s_cmp_ge_u32 s2, 224
    s_cbranch_scc1 L_fin_a
    s_lshl_b32 s44, s23, 12
    s_add_u32 s44, s44, 0x12c0000
    v_lshl_add_u32 v80, v6, 7, s44
    s_cmp_lg_u32 s24, 0
    s_cbranch_scc1 L_l0_nki
    global_load_dwordx4 v[76:79], v80, s[10:11] sc0 sc1
L_l0_nki:
    v_mov_b32 v82, 156160
    s_cmp_lg_u32 s24, 0
    s_cbranch_scc1 L_l0s_kw
    s_mov_b32 s29, 65536
    s_branch L_l0s_pb_w
L_l0s_pb:
L_l0s_pb_l:
    global_load_dwordx4 v[76:79], v80, s[10:11] sc0 sc1
L_l0s_pb_w:
    s_waitcnt vmcnt(0)
    v_cmp_ne_u32 vcc, s31, v79
    s_sub_u32 s29, s29, 1
    s_cbranch_vccz L_l0s_pb_ok
    s_cbranch_scc0 L_l0s_pb
L_l0s_pb_ok:
    v_lshlrev_b32 v81, 2, v6
    v_add_u32 v81, 156288, v81
    ds_write_b32 v81, v76
    v_mov_b32 v81, v76
    s_nop 1
    v_max_u32_dpp v81, v81, v81 quad_perm:[1,0,3,2] row_mask:0xf bank_mask:0xf
    s_nop 1
    v_max_u32_dpp v81, v81, v81 quad_perm:[2,3,0,1] row_mask:0xf bank_mask:0xf
    s_nop 1
    v_max_u32_dpp v81, v81, v81 row_half_mirror row_mask:0xf bank_mask:0xf
    s_nop 1
    v_max_u32_dpp v81, v81, v81 row_mirror row_mask:0xf bank_mask:0xf
    v_mov_b32 v83, v81
    s_nop 1
    v_permlane16_swap_b32 v81, v83
    v_max_u32 v81, v81, v83
    v_cmp_eq_u32 vcc, v81, v76
    s_mov_b64 exec, vcc
    ds_write_b96 v82, v[76:78]
    s_mov_b64 exec, -1
L_l0s_kw:
    s_waitcnt lgkmcnt(0)
    s_barrier
    ds_read_b96 v[76:78], v82
    s_waitcnt lgkmcnt(0)
    v_readfirstlane_b32 s38, v76
    v_readfirstlane_b32 s60, v77
    v_readfirstlane_b32 s61, v78
    s_and_b32 s62, s38, 0xffff0000
    s_and_b32 s38, s38, 0x7ff
    s_sub_u32 s38, 2047, s38
    s_ashr_i32 s44, s62, 31
    s_not_b32 s44, s44
    s_or_b32 s44, s44, 0x80000000
    s_xor_b32 s62, s62, s44
    s_and_b32 s62, s62, 0xffff0000
    s_lshr_b32 s44, s38, 4
    s_lshl_b32 s44, s44, 14
    s_and_b32 s45, s38, 15
    s_lshl_b32 s45, s45, 4
    s_add_u32 s44, s44, s45
    s_cmp_ge_u32 s2, 224
    s_cbranch_scc1 L_l0s_frow
    s_lshl_b32 s45, s24, 11
    s_add_u32 s44, s44, s45
    v_and_b32 v80, 48, v1
    v_lshl_add_u32 v80, v80, 4, s44
    v_add_u32 v81, 0x400, v80
    s_branch L_l0s_rowld
L_l0s_frow:
    s_sub_u32 s45, s2, 224
    s_lshl_b32 s45, s45, 9
    s_add_u32 s44, s44, s45
    v_bfe_u32 v80, v1, 3, 1
    v_lshl_add_u32 v80, v80, 8, s44
    v_mov_b32 v81, v80
L_l0s_rowld:
    global_load_dwordx4 v[84:87], v80, s[58:59] sc1
    global_load_dwordx4 v[88:91], v81, s[58:59] sc1
    v_mov_b32 v78, s60
    v_mul_f32 v78, s61, v78
    v_and_b32 v80, 48, v1
    s_lshl_b32 s44, s24, 6
    s_add_u32 s44, s44, 156416
    v_add_u32 v80, s44, v80
    v_lshrrev_b32 v81, 4, v0
    v_mul_u32_u24 v81, 14336, v81
    v_and_b32 v82, 15, v0
    v_lshl_add_u32 v81, v82, 2, v81
    s_lshl_b32 s42, s3, 6
    s_add_u32 s42, s42, 0x1080000
    v_add_u32 v81, s42, v81
    v_and_b32 v82, 15, v1
    v_lshlrev_b32 v82, 2, v82
    v_add_u32 v82, 156416, v82
    v_accvgpr_read_b32 v96, a120
    v_accvgpr_read_b32 v97, a121
    v_accvgpr_read_b32 v98, a122
    v_accvgpr_read_b32 v99, a123
    v_accvgpr_read_b32 v100, a124
    v_accvgpr_read_b32 v101, a125
    v_accvgpr_read_b32 v102, a126
    v_accvgpr_read_b32 v103, a127
    v_lshlrev_b32 v96, 16, v96
    v_lshlrev_b32 v97, 16, v97
    v_lshlrev_b32 v98, 16, v98
    v_lshlrev_b32 v99, 16, v99
    v_lshlrev_b32 v100, 16, v100
    v_lshlrev_b32 v101, 16, v101
    v_lshlrev_b32 v102, 16, v102
    v_lshlrev_b32 v103, 16, v103
    s_waitcnt vmcnt(0)
    s_cmp_ge_u32 s2, 224
    s_cbranch_scc1 L_l0_s1skip
    v_lshlrev_b32 v92, 16, v84
    v_and_b32 v93, 0xffff0000, v84
    v_fma_f32 v92, v92, s61, -v78
    v_fma_f32 v93, v93, s61, -v78
    v_cvt_pk_bf16_f32 v84, v92, v93
    v_lshlrev_b32 v94, 16, v85
    v_and_b32 v95, 0xffff0000, v85
    v_fma_f32 v94, v94, s61, -v78
    v_fma_f32 v95, v95, s61, -v78
    v_cvt_pk_bf16_f32 v85, v94, v95
    v_lshlrev_b32 v92, 16, v86
    v_and_b32 v93, 0xffff0000, v86
    v_fma_f32 v92, v92, s61, -v78
    v_fma_f32 v93, v93, s61, -v78
    v_cvt_pk_bf16_f32 v86, v92, v93
    v_lshlrev_b32 v94, 16, v87
    v_and_b32 v95, 0xffff0000, v87
    v_fma_f32 v94, v94, s61, -v78
    v_fma_f32 v95, v95, s61, -v78
    v_cvt_pk_bf16_f32 v87, v94, v95
    v_lshlrev_b32 v92, 16, v88
    v_and_b32 v93, 0xffff0000, v88
    v_fma_f32 v92, v92, s61, -v78
    v_fma_f32 v93, v93, s61, -v78
    v_cvt_pk_bf16_f32 v88, v92, v93
    v_lshlrev_b32 v94, 16, v89
    v_and_b32 v95, 0xffff0000, v89
    v_fma_f32 v94, v94, s61, -v78
    v_fma_f32 v95, v95, s61, -v78
    v_cvt_pk_bf16_f32 v89, v94, v95
    v_lshlrev_b32 v92, 16, v90
    v_and_b32 v93, 0xffff0000, v90
    v_fma_f32 v92, v92, s61, -v78
    v_fma_f32 v93, v93, s61, -v78
    v_cvt_pk_bf16_f32 v90, v92, v93
    v_lshlrev_b32 v94, 16, v91
    v_and_b32 v95, 0xffff0000, v91
    v_fma_f32 v94, v94, s61, -v78
    v_fma_f32 v95, v95, s61, -v78
    v_cvt_pk_bf16_f32 v91, v94, v95
    s_nop 1
    v_mfma_f32_16x16x32_bf16 v[92:95], a[112:115], v[84:87], 0
    v_mfma_f32_16x16x32_bf16 v[92:95], a[116:119], v[88:91], v[92:95]
    s_mov_b32 exec_lo, 0x00010001
    s_mov_b32 exec_hi, 0x00010001
    s_nop 5
    ds_write_b128 v80, v[92:95]
    s_mov_b64 exec, -1
    s_waitcnt lgkmcnt(0)
    s_barrier
L_l0_s1skip:
    s_cmp_ge_u32 s2, 224
    s_cbranch_scc1 L_l0_s2skip
    ds_read_b32 v84, v82 offset:0
    ds_read_b32 v85, v82 offset:64
    ds_read_b32 v86, v82 offset:128
    ds_read_b32 v87, v82 offset:192
    ds_read_b32 v88, v82 offset:256
    ds_read_b32 v89, v82 offset:320
    ds_read_b32 v90, v82 offset:384
    ds_read_b32 v91, v82 offset:448
    s_waitcnt lgkmcnt(0)
    v_add_f32 v84, v84, v85
    v_add_f32 v86, v86, v87
    v_add_f32 v88, v88, v89
    v_add_f32 v90, v90, v91
    v_add_f32 v84, v84, v86
    v_add_f32 v88, v88, v90
    v_add_f32 v84, v84, v88
    v_cvt_pk_bf16_f32 v84, v84, v84
    v_and_b32 v84, 0xffff0000, v84
    v_mul_f32 v76, 0xbfb8aa3b, v84
    v_exp_f32 v76, v76
    s_nop 0
    v_add_f32 v76, 1.0, v76
    v_rcp_f32 v76, v76
    s_nop 0
    v_mul_f32 v76, v76, v84
    v_cvt_pk_bf16_f32 v76, v76, v76
    v_and_b32 v76, 0xffff0000, v76
    s_nop 1
    v_mul_f32_dpp v76, v84, v76 row_ror:8 row_mask:0xf bank_mask:0xf
    v_cvt_pk_bf16_f32 v76, v76, v76
    v_and_b32 v76, 0xffff0000, v76
    s_nop 0
    v_readlane_b32 s44, v76, 0
    v_readlane_b32 s45, v76, 1
    v_readlane_b32 s46, v76, 2
    v_readlane_b32 s47, v76, 3
    v_readlane_b32 s48, v76, 4
    v_readlane_b32 s49, v76, 5
    v_readlane_b32 s50, v76, 6
    v_readlane_b32 s51, v76, 7
    v_mul_f32 v78, s44, v96
    v_mul_f32 v79, s45, v97
    v_fmac_f32 v78, s46, v98
    v_fmac_f32 v79, s47, v99
    v_fmac_f32 v78, s48, v100
    v_fmac_f32 v79, s49, v101
    v_fmac_f32 v78, s50, v102
    v_fmac_f32 v79, s51, v103
    v_add_f32 v78, v78, v79
    v_min_u32 v84, 0xfffffffe, v78
    s_nop 0
    s_nop 0
    v_mov_b32_dpp v85, v84 quad_perm:[1,1,1,1] row_mask:0xf bank_mask:0xf
    v_mov_b32_dpp v86, v84 quad_perm:[2,2,2,2] row_mask:0xf bank_mask:0xf
    v_mov_b32_dpp v87, v84 quad_perm:[3,3,3,3] row_mask:0xf bank_mask:0xf
    s_mov_b32 exec_lo, 0x11111111
    s_mov_b32 exec_hi, 0x11111111
    global_store_dwordx4 v81, v[84:87], s[10:11] sc0 sc1
    s_mov_b64 exec, -1
L_l0_s2skip:
    s_add_u32 s40, s67, 8
    s_and_b32 s40, s40, 15
    s_lshl_b32 s40, s40, 10
    s_add_u32 s40, s58, s40
    s_addc_u32 s41, s59, 0
    global_load_dwordx4 a[80:83], v8, s[40:41] sc1
    global_load_dwordx4 a[84:87], v9, s[40:41] sc1
    s_add_u32 s40, s67, 9
    s_and_b32 s40, s40, 15
    s_lshl_b32 s40, s40, 10
    s_add_u32 s40, s58, s40
    s_addc_u32 s41, s59, 0
    global_load_dwordx4 a[88:91], v8, s[40:41] sc1
    global_load_dwordx4 a[92:95], v9, s[40:41] sc1
    s_add_u32 s40, s67, 10
    s_and_b32 s40, s40, 15
    s_lshl_b32 s40, s40, 10
    s_add_u32 s40, s58, s40
    s_addc_u32 s41, s59, 0
    global_load_dwordx4 a[96:99], v8, s[40:41] sc1
    global_load_dwordx4 a[100:103], v9, s[40:41] sc1
    s_add_u32 s40, s67, 11
    s_and_b32 s40, s40, 15
    s_lshl_b32 s40, s40, 10
    s_add_u32 s40, s58, s40
    s_addc_u32 s41, s59, 0
    global_load_dwordx4 a[104:107], v8, s[40:41] sc1
    global_load_dwordx4 a[108:111], v9, s[40:41] sc1
    global_load_dwordx4 v[96:99], v11, s[10:11] offset:0 sc0 sc1
    global_load_dwordx4 v[100:103], v11, s[10:11] offset:1024 sc0 sc1
    global_load_dwordx4 v[104:107], v11, s[10:11] offset:2048 sc0 sc1
    global_load_dwordx4 v[108:111], v11, s[10:11] offset:3072 sc0 sc1
    s_branch L_q1_go
L_fin_a:
    s_add_u32 s40, s67, 8
    s_and_b32 s40, s40, 15
    s_lshl_b32 s40, s40, 10
    s_add_u32 s40, s58, s40
    s_addc_u32 s41, s59, 0
    global_load_dwordx4 a[80:83], v8, s[40:41] sc1
    global_load_dwordx4 a[84:87], v9, s[40:41] sc1
    s_add_u32 s40, s67, 9
    s_and_b32 s40, s40, 15
    s_lshl_b32 s40, s40, 10
    s_add_u32 s40, s58, s40
    s_addc_u32 s41, s59, 0
    global_load_dwordx4 a[88:91], v8, s[40:41] sc1
    global_load_dwordx4 a[92:95], v9, s[40:41] sc1
    s_add_u32 s40, s67, 10
    s_and_b32 s40, s40, 15
    s_lshl_b32 s40, s40, 10
    s_add_u32 s40, s58, s40
    s_addc_u32 s41, s59, 0
    global_load_dwordx4 a[96:99], v8, s[40:41] sc1
    global_load_dwordx4 a[100:103], v9, s[40:41] sc1
    s_add_u32 s40, s67, 11
    s_and_b32 s40, s40, 15
    s_lshl_b32 s40, s40, 10
    s_add_u32 s40, s58, s40
    s_addc_u32 s41, s59, 0
    global_load_dwordx4 a[104:107], v8, s[40:41] sc1
    global_load_dwordx4 a[108:111], v9, s[40:41] sc1
    global_load_dwordx4 v[96:99], v11, s[10:11] offset:0 sc0 sc1
    global_load_dwordx4 v[100:103], v11, s[10:11] offset:1024 sc0 sc1
    global_load_dwordx4 v[104:107], v11, s[10:11] offset:2048 sc0 sc1
    global_load_dwordx4 v[108:111], v11, s[10:11] offset:3072 sc0 sc1
L_q1_go:
    s_add_u32 s40, s67, 12
    s_and_b32 s40, s40, 15
    s_lshl_b32 s40, s40, 10
    s_add_u32 s40, s58, s40
    s_addc_u32 s41, s59, 0
    global_load_dwordx4 a[64:67], v8, s[40:41] sc1
    global_load_dwordx4 a[68:71], v9, s[40:41] sc1
    s_add_u32 s40, s67, 10
    s_and_b32 s40, s40, 15
    s_lshl_b32 s40, s40, 10
    v_add_u32 v12, s40, v10
    ds_read_b64_tr_b16 v[52:53], v12 offset:0
    ds_read_b64_tr_b16 v[54:55], v12 offset:256
    ds_read_b64_tr_b16 v[56:57], v12 offset:16384
    ds_read_b64_tr_b16 v[58:59], v12 offset:16640
    ds_read_b64_tr_b16 v[60:61], v12 offset:32768
    ds_read_b64_tr_b16 v[62:63], v12 offset:33024
    s_waitcnt vmcnt(12) lgkmcnt(12)
    v_mfma_f32_16x16x32_bf16 v[16:19], v[64:67], a[80:83], v[16:19]
    v_mfma_f32_16x16x32_bf16 v[20:23], v[64:67], a[84:87], v[20:23]
    v_mfma_f32_16x16x32_bf16 v[24:27], v[68:71], a[80:83], v[24:27]
    v_mfma_f32_16x16x32_bf16 v[28:31], v[68:71], a[84:87], v[28:31]
    v_mfma_f32_16x16x32_bf16 v[32:35], a[80:83], v[72:75], v[32:35]
    v_mfma_f32_16x16x32_bf16 v[36:39], a[84:87], v[72:75], v[36:39]
    s_add_u32 s40, s67, 13
    s_and_b32 s40, s40, 15
    s_lshl_b32 s40, s40, 10
    s_add_u32 s40, s58, s40
    s_addc_u32 s41, s59, 0
    global_load_dwordx4 a[72:75], v8, s[40:41] sc1
    global_load_dwordx4 a[76:79], v9, s[40:41] sc1
    s_add_u32 s40, s67, 11
    s_and_b32 s40, s40, 15
    s_lshl_b32 s40, s40, 10
    v_add_u32 v12, s40, v10
    ds_read_b64_tr_b16 v[64:65], v12 offset:0
    ds_read_b64_tr_b16 v[66:67], v12 offset:256
    ds_read_b64_tr_b16 v[68:69], v12 offset:16384
    ds_read_b64_tr_b16 v[70:71], v12 offset:16640
    ds_read_b64_tr_b16 v[72:73], v12 offset:32768
    ds_read_b64_tr_b16 v[74:75], v12 offset:33024
    s_waitcnt vmcnt(12) lgkmcnt(12)
    v_mfma_f32_16x16x32_bf16 v[16:19], v[40:43], a[88:91], v[16:19]
    v_mfma_f32_16x16x32_bf16 v[20:23], v[40:43], a[92:95], v[20:23]
    v_mfma_f32_16x16x32_bf16 v[24:27], v[44:47], a[88:91], v[24:27]
    v_mfma_f32_16x16x32_bf16 v[28:31], v[44:47], a[92:95], v[28:31]
    v_mfma_f32_16x16x32_bf16 v[32:35], a[88:91], v[48:51], v[32:35]
    v_mfma_f32_16x16x32_bf16 v[36:39], a[92:95], v[48:51], v[36:39]
    s_add_u32 s40, s67, 14
    s_and_b32 s40, s40, 15
    s_lshl_b32 s40, s40, 10
    s_add_u32 s40, s58, s40
    s_addc_u32 s41, s59, 0
    global_load_dwordx4 a[80:83], v8, s[40:41] sc1
    global_load_dwordx4 a[84:87], v9, s[40:41] sc1
    s_add_u32 s40, s67, 12
    s_and_b32 s40, s40, 15
    s_lshl_b32 s40, s40, 10
    v_add_u32 v12, s40, v10
    ds_read_b64_tr_b16 v[40:41], v12 offset:0
    ds_read_b64_tr_b16 v[42:43], v12 offset:256
    ds_read_b64_tr_b16 v[44:45], v12 offset:16384
    ds_read_b64_tr_b16 v[46:47], v12 offset:16640
    ds_read_b64_tr_b16 v[48:49], v12 offset:32768
    ds_read_b64_tr_b16 v[50:51], v12 offset:33024
    s_waitcnt vmcnt(12) lgkmcnt(12)
    v_mfma_f32_16x16x32_bf16 v[16:19], v[52:55], a[96:99], v[16:19]
    v_mfma_f32_16x16x32_bf16 v[20:23], v[52:55], a[100:103], v[20:23]
    v_mfma_f32_16x16x32_bf16 v[24:27], v[56:59], a[96:99], v[24:27]
    v_mfma_f32_16x16x32_bf16 v[28:31], v[56:59], a[100:103], v[28:31]
    v_mfma_f32_16x16x32_bf16 v[32:35], a[96:99], v[60:63], v[32:35]
    v_mfma_f32_16x16x32_bf16 v[36:39], a[100:103], v[60:63], v[36:39]
    s_setprio 1
    s_add_u32 s40, s67, 15
    s_and_b32 s40, s40, 15
    s_lshl_b32 s40, s40, 10
    s_add_u32 s40, s58, s40
    s_addc_u32 s41, s59, 0
    global_load_dwordx4 a[88:91], v8, s[40:41] sc1
    global_load_dwordx4 a[92:95], v9, s[40:41] sc1
    s_add_u32 s40, s67, 13
    s_and_b32 s40, s40, 15
    s_lshl_b32 s40, s40, 10
    v_add_u32 v12, s40, v10
    ds_read_b64_tr_b16 v[52:53], v12 offset:0
    ds_read_b64_tr_b16 v[54:55], v12 offset:256
    ds_read_b64_tr_b16 v[56:57], v12 offset:16384
    ds_read_b64_tr_b16 v[58:59], v12 offset:16640
    ds_read_b64_tr_b16 v[60:61], v12 offset:32768
    ds_read_b64_tr_b16 v[62:63], v12 offset:33024
    s_waitcnt vmcnt(12) lgkmcnt(12)
    v_mfma_f32_16x16x32_bf16 v[16:19], v[64:67], a[104:107], v[16:19]
    v_mfma_f32_16x16x32_bf16 v[20:23], v[64:67], a[108:111], v[20:23]
    v_mfma_f32_16x16x32_bf16 v[24:27], v[68:71], a[104:107], v[24:27]
    v_mfma_f32_16x16x32_bf16 v[28:31], v[68:71], a[108:111], v[28:31]
    v_mfma_f32_16x16x32_bf16 v[32:35], a[104:107], v[72:75], v[32:35]
    v_mfma_f32_16x16x32_bf16 v[36:39], a[108:111], v[72:75], v[36:39]
    s_add_u32 s40, s67, 14
    s_and_b32 s40, s40, 15
    s_lshl_b32 s40, s40, 10
    v_add_u32 v12, s40, v10
    ds_read_b64_tr_b16 v[64:65], v12 offset:0
    ds_read_b64_tr_b16 v[66:67], v12 offset:256
    ds_read_b64_tr_b16 v[68:69], v12 offset:16384
    ds_read_b64_tr_b16 v[70:71], v12 offset:16640
    ds_read_b64_tr_b16 v[72:73], v12 offset:32768
    ds_read_b64_tr_b16 v[74:75], v12 offset:33024
    s_waitcnt vmcnt(6) lgkmcnt(12)
    v_mfma_f32_16x16x32_bf16 v[16:19], v[40:43], a[64:67], v[16:19]
    v_mfma_f32_16x16x32_bf16 v[20:23], v[40:43], a[68:71], v[20:23]
    v_mfma_f32_16x16x32_bf16 v[24:27], v[44:47], a[64:67], v[24:27]
    v_mfma_f32_16x16x32_bf16 v[28:31], v[44:47], a[68:71], v[28:31]
    v_mfma_f32_16x16x32_bf16 v[32:35], a[64:67], v[48:51], v[32:35]
    v_mfma_f32_16x16x32_bf16 v[36:39], a[68:71], v[48:51], v[36:39]
    s_waitcnt vmcnt(8)
    s_mov_b32 s29, 65536
    s_branch L_ps_c
L_ps:
L_ps_l:
    global_load_dwordx4 v[96:99], v11, s[10:11] offset:0 sc0 sc1
    global_load_dwordx4 v[100:103], v11, s[10:11] offset:1024 sc0 sc1
    global_load_dwordx4 v[104:107], v11, s[10:11] offset:2048 sc0 sc1
    global_load_dwordx4 v[108:111], v11, s[10:11] offset:3072 sc0 sc1
L_ps_w:
    s_waitcnt vmcnt(0)
L_ps_c:
    v_cmp_ne_u32 vcc, s31, v99
    v_cmp_ne_u32 s[42:43], s31, v103
    s_or_b64 vcc, vcc, s[42:43]
    v_cmp_ne_u32 s[42:43], s31, v107
    s_or_b64 vcc, vcc, s[42:43]
    v_cmp_ne_u32 s[42:43], s31, v111
    s_or_b64 vcc, vcc, s[42:43]
    s_sub_u32 s29, s29, 1
    s_cbranch_vccz L_ps_ok
    s_cbranch_scc0 L_ps
L_ps_ok:
    v_add_f32 v96, v96, v100
    v_add_f32 v97, v97, v101
    v_add_f32 v96, v96, v104
    v_add_f32 v97, v97, v105
    v_add_f32 v96, v96, v108
    v_add_f32 v97, v97, v109
    v_mov_b32 v98, v96
    s_nop 1
    v_permlane32_swap_b32 v96, v98
    v_add_f32 v96, v96, v98
    v_mov_b32 v98, v97
    s_nop 1
    v_permlane32_swap_b32 v97, v98
    v_add_f32 v97, v97, v98
    v_mul_f32 v112, s64, v96
    v_mul_f32 v98, s64, v97
    v_fma_f32 v98, -v112, v112, v98
    v_max_f32 v98, 0, v98
    v_add_f32 v99, s65, v98
    v_rsq_f32 v99, v99
    v_mov_b32 v113, s65
    v_add_f32 v99, 1.0, v99
    v_mul_f32 v98, v98, v99
    v_fmac_f32 v113, v98, v99
    v_rsq_f32 v113, v113
    v_mov_b32 v114, v112
    v_mul_f32 v113, v113, v99
    v_mov_b32 v115, v113
    v_permlane16_swap_b32 v112, v114
    s_nop 0
    v_permlane16_swap_b32 v113, v115
    s_lshl_b32 s44, s24, 8
    s_add_u32 s44, s44, 150016
    v_and_b32 v13, 15, v1
    v_lshl_add_u32 v12, v13, 2, s44
    ds_write_b32 v12, v112 offset:0
    ds_write_b32 v12, v113 offset:128
    ds_write_b32 v12, v114 offset:64
    ds_write_b32 v12, v115 offset:192
    v_and_b32 v14, 48, v1
    v_add_u32 v12, s44, v14
    ds_read_b128 v[76:79], v12 offset:0
    ds_read_b128 v[84:87], v12 offset:128
    ds_read_b128 v[80:83], v12 offset:64
    ds_read_b128 v[88:91], v12 offset:192
    v_add_u32 v12, 149504, v14
    ds_read_b128 v[96:99], v12 offset:0
    ds_read_b128 v[100:103], v12 offset:64
    v_lshlrev_b32 v12, 2, v13
    v_add_u32 v12, 149632, v12
    ds_read_b32 v108, v12
    s_add_u32 s40, s67, 15
    s_and_b32 s40, s40, 15
    s_lshl_b32 s40, s40, 10
    v_add_u32 v12, s40, v10
    ds_read_b64_tr_b16 v[40:41], v12 offset:0
    ds_read_b64_tr_b16 v[42:43], v12 offset:256
    ds_read_b64_tr_b16 v[44:45], v12 offset:16384
    ds_read_b64_tr_b16 v[46:47], v12 offset:16640
    ds_read_b64_tr_b16 v[48:49], v12 offset:32768
    ds_read_b64_tr_b16 v[50:51], v12 offset:33024
    s_waitcnt vmcnt(4) lgkmcnt(12)
    v_mfma_f32_16x16x32_bf16 v[16:19], v[52:55], a[72:75], v[16:19]
    v_mfma_f32_16x16x32_bf16 v[20:23], v[52:55], a[76:79], v[20:23]
    v_mfma_f32_16x16x32_bf16 v[24:27], v[56:59], a[72:75], v[24:27]
    v_mfma_f32_16x16x32_bf16 v[28:31], v[56:59], a[76:79], v[28:31]
    v_mfma_f32_16x16x32_bf16 v[32:35], a[72:75], v[60:63], v[32:35]
    v_mfma_f32_16x16x32_bf16 v[36:39], a[76:79], v[60:63], v[36:39]
    s_setprio 0
    s_cmp_ge_u32 s2, 224
    s_cbranch_scc1 L_px_e
    s_lshr_b32 s44, s38, 8
    s_cmp_lg_u32 s44, s23
    s_cbranch_scc1 L_px_e
    s_lshl_b32 s44, s24, 9
    s_add_u32 s44, s44, 0x12a0000
    v_lshl_add_u32 v2, v7, 7, s44
    v_bfe_u32 v4, v1, 4, 1
    v_lshl_add_u32 v2, v4, 5, v2
    global_load_dwordx3 v[76:78], v2, s[10:11] offset:0 sc0 sc1
    global_load_dwordx3 v[80:82], v2, s[10:11] offset:16 sc0 sc1
    global_load_dwordx3 v[84:86], v2, s[10:11] offset:256 sc0 sc1
    global_load_dwordx3 v[88:90], v2, s[10:11] offset:272 sc0 sc1
L_px_e:
    s_waitcnt vmcnt(2) lgkmcnt(6)
    v_mfma_f32_16x16x32_bf16 v[16:19], v[64:67], a[80:83], v[16:19]
    v_mfma_f32_16x16x32_bf16 v[20:23], v[64:67], a[84:87], v[20:23]
    v_mfma_f32_16x16x32_bf16 v[24:27], v[68:71], a[80:83], v[24:27]
    v_mfma_f32_16x16x32_bf16 v[28:31], v[68:71], a[84:87], v[28:31]
    v_mfma_f32_16x16x32_bf16 v[32:35], a[80:83], v[72:75], v[32:35]
    v_mfma_f32_16x16x32_bf16 v[36:39], a[84:87], v[72:75], v[36:39]
    s_waitcnt vmcnt(0) lgkmcnt(0)
    v_mfma_f32_16x16x32_bf16 v[16:19], v[40:43], a[88:91], v[16:19]
    v_mfma_f32_16x16x32_bf16 v[20:23], v[40:43], a[92:95], v[20:23]
    v_mfma_f32_16x16x32_bf16 v[24:27], v[44:47], a[88:91], v[24:27]
    v_mfma_f32_16x16x32_bf16 v[28:31], v[44:47], a[92:95], v[28:31]
    v_mfma_f32_16x16x32_bf16 v[32:35], a[88:91], v[48:51], v[32:35]
    v_mfma_f32_16x16x32_bf16 v[36:39], a[92:95], v[48:51], v[36:39]
    s_cmp_lt_u32 s2, 224
    s_cbranch_scc1 L_fin_b
    s_lshl_b32 s44, s23, 12
    s_add_u32 s44, s44, 0x12c0000
    v_lshl_add_u32 v80, v6, 7, s44
    s_cmp_lg_u32 s24, 0
    s_cbranch_scc1 L_l0_nkif
    global_load_dwordx4 v[76:79], v80, s[10:11] sc0 sc1
L_l0_nkif:
    v_mov_b32 v82, 156160
    s_cmp_lg_u32 s24, 0
    s_cbranch_scc1 L_l0f_kw
    s_mov_b32 s29, 65536
    s_branch L_l0f_pb_w
L_l0f_pb:
L_l0f_pb_l:
    global_load_dwordx4 v[76:79], v80, s[10:11] sc0 sc1
L_l0f_pb_w:
    s_waitcnt vmcnt(0)
    v_cmp_ne_u32 vcc, s31, v79
    s_sub_u32 s29, s29, 1
    s_cbranch_vccz L_l0f_pb_ok
    s_cbranch_scc0 L_l0f_pb
L_l0f_pb_ok:
    v_lshlrev_b32 v81, 2, v6
    v_add_u32 v81, 156288, v81
    ds_write_b32 v81, v76
    v_mov_b32 v81, v76
    s_nop 1
    v_max_u32_dpp v81, v81, v81 quad_perm:[1,0,3,2] row_mask:0xf bank_mask:0xf
    s_nop 1
    v_max_u32_dpp v81, v81, v81 quad_perm:[2,3,0,1] row_mask:0xf bank_mask:0xf
    s_nop 1
    v_max_u32_dpp v81, v81, v81 row_half_mirror row_mask:0xf bank_mask:0xf
    s_nop 1
    v_max_u32_dpp v81, v81, v81 row_mirror row_mask:0xf bank_mask:0xf
    v_mov_b32 v83, v81
    s_nop 1
    v_permlane16_swap_b32 v81, v83
    v_max_u32 v81, v81, v83
    v_cmp_eq_u32 vcc, v81, v76
    s_mov_b64 exec, vcc
    ds_write_b96 v82, v[76:78]
    s_mov_b64 exec, -1
L_l0f_kw:
    s_waitcnt lgkmcnt(0)
    s_barrier
    ds_read_b96 v[76:78], v82
    s_waitcnt lgkmcnt(0)
    v_readfirstlane_b32 s38, v76
    v_readfirstlane_b32 s60, v77
    v_readfirstlane_b32 s61, v78
    s_and_b32 s62, s38, 0xffff0000
    s_and_b32 s38, s38, 0x7ff
    s_sub_u32 s38, 2047, s38
    s_ashr_i32 s44, s62, 31
    s_not_b32 s44, s44
    s_or_b32 s44, s44, 0x80000000
    s_xor_b32 s62, s62, s44
    s_and_b32 s62, s62, 0xffff0000
    s_lshr_b32 s44, s38, 4
    s_lshl_b32 s44, s44, 14
    s_and_b32 s45, s38, 15
    s_lshl_b32 s45, s45, 4
    s_add_u32 s44, s44, s45
    s_cmp_ge_u32 s2, 224
    s_cbranch_scc1 L_l0f_frow
    s_lshl_b32 s45, s24, 11
    s_add_u32 s44, s44, s45
    v_and_b32 v80, 48, v1
    v_lshl_add_u32 v80, v80, 4, s44
    v_add_u32 v81, 0x400, v80
    s_branch L_l0f_rowld
L_l0f_frow:
    s_sub_u32 s45, s2, 224
    s_lshl_b32 s45, s45, 9
    s_add_u32 s44, s44, s45
    v_bfe_u32 v80, v1, 3, 1
    v_lshl_add_u32 v80, v80, 8, s44
    v_mov_b32 v81, v80
L_l0f_rowld:
    global_load_dwordx4 v[84:87], v80, s[58:59] sc1
    global_load_dwordx4 v[88:91], v81, s[58:59] sc1
    s_waitcnt vmcnt(0)
    s_cmp_lt_u32 s2, 224
    s_cbranch_scc1 L_l0_fskip
    v_bfe_u32 v82, v1, 1, 1
    v_cmp_eq_u32 vcc, 1, v82
    v_bfe_u32 v82, v1, 2, 1
    s_nop 0
    v_cndmask_b32 v84, v84, v85, vcc
    v_cndmask_b32 v86, v86, v87, vcc
    v_cmp_eq_u32 vcc, 1, v82
    v_and_b32 v82, 1, v1
    s_nop 0
    v_cndmask_b32 v84, v84, v86, vcc
    v_cmp_eq_u32 vcc, 1, v82
    v_lshlrev_b32 v85, 16, v84
    v_and_b32 v86, 0xffff0000, v84
    v_cndmask_b32 v84, v85, v86, vcc
    s_sub_u32 s44, s2, 224
    s_mul_i32 s45, s44, 14336
    s_add_u32 s45, s45, 0x1080000
    v_min_u32 v88, 447, v0
    v_lshl_add_u32 v88, v88, 4, s45
    v_add_u32 v89, 7168, v88
    s_mov_b64 exec, 1
    s_mov_b32 s29, 65536
L_l0_pl:
L_l0_pl_l:
    global_load_dword v96, v89, s[10:11] sc0 sc1
L_l0_pl_w:
    s_waitcnt vmcnt(0)
    v_cmp_eq_u32 vcc, -1, v96
    s_sub_u32 s29, s29, 1
    s_cbranch_vccz L_l0_pl_ok
    s_cbranch_scc0 L_l0_pl
L_l0_pl_ok:
    s_mov_b64 exec, -1
    s_mov_b32 s29, 65536
L_l0_pf:
L_l0_pf_l:
    global_load_dwordx4 v[96:99], v88, s[10:11] sc0 sc1
    global_load_dwordx4 v[100:103], v89, s[10:11] sc0 sc1
L_l0_pf_w:
    s_waitcnt vmcnt(0)
    v_max3_u32 v92, v96, v97, v98
    v_max3_u32 v92, v92, v99, v100
    v_max3_u32 v92, v92, v101, v102
    v_max_u32 v92, v92, v103
    v_cmp_eq_u32 vcc, -1, v92
    s_sub_u32 s29, s29, 1
    s_cbranch_vccz L_l0_pf_ok
    s_cbranch_scc0 L_l0_pf
L_l0_pf_ok:
    v_add_f32 v96, v96, v100
    v_add_f32 v97, v97, v101
    v_add_f32 v98, v98, v102
    v_add_f32 v99, v99, v103
    s_nop 0
    v_add_f32_dpp v96, v96, v96 row_shr:4 row_mask:0xf bank_mask:0xf bound_ctrl:0
    v_add_f32_dpp v97, v97, v97 row_shr:4 row_mask:0xf bank_mask:0xf bound_ctrl:0
    v_add_f32_dpp v98, v98, v98 row_shr:4 row_mask:0xf bank_mask:0xf bound_ctrl:0
    v_add_f32_dpp v99, v99, v99 row_shr:4 row_mask:0xf bank_mask:0xf bound_ctrl:0
    s_nop 0
    v_add_f32_dpp v96, v96, v96 row_shr:8 row_mask:0xf bank_mask:0xf bound_ctrl:0
    v_add_f32_dpp v97, v97, v97 row_shr:8 row_mask:0xf bank_mask:0xf bound_ctrl:0
    v_add_f32_dpp v98, v98, v98 row_shr:8 row_mask:0xf bank_mask:0xf bound_ctrl:0
    v_add_f32_dpp v99, v99, v99 row_shr:8 row_mask:0xf bank_mask:0xf bound_ctrl:0
    v_mov_b32 v100, v96
    v_mov_b32 v101, v97
    v_mov_b32 v102, v98
    v_mov_b32 v103, v99
    s_nop 0
    v_permlane16_swap_b32 v96, v100
    v_permlane16_swap_b32 v97, v101
    v_permlane16_swap_b32 v98, v102
    v_permlane16_swap_b32 v99, v103
    v_add_f32 v96, v96, v100
    v_add_f32 v97, v97, v101
    v_add_f32 v98, v98, v102
    v_add_f32 v99, v99, v103
    v_mov_b32 v100, v96
    v_mov_b32 v101, v97
    v_mov_b32 v102, v98
    v_mov_b32 v103, v99
    s_nop 0
    v_permlane32_swap_b32 v96, v100
    v_permlane32_swap_b32 v97, v101
    v_permlane32_swap_b32 v98, v102
    v_permlane32_swap_b32 v99, v103
    v_add_f32 v96, v96, v100
    v_add_f32 v97, v97, v101
    v_add_f32 v98, v98, v102
    v_add_f32 v99, v99, v103
    v_and_b32 v92, 3, v1
    s_lshl_b32 s45, s24, 6
    s_add_u32 s45, s45, 156416
    v_lshl_add_u32 v92, v92, 4, s45
    s_mov_b32 exec_lo, 0xf000
    s_mov_b32 exec_hi, 0
    ds_write_b128 v92, v[96:99] offset:0
    s_mov_b64 exec, -1
    v_and_b32 v81, 15, v1
    v_lshlrev_b32 v81, 2, v81
    v_add_u32 v81, 156416, v81
    s_waitcnt lgkmcnt(0)
    s_barrier
    s_cmp_lg_u32 s24, 0
    s_cbranch_scc1 L_l0_fskip
    ds_read_b32 v92, v81 offset:0
    ds_read_b32 v93, v81 offset:64
    ds_read_b32 v94, v81 offset:128
    ds_read_b32 v95, v81 offset:192
    ds_read_b32 v96, v81 offset:256
    ds_read_b32 v97, v81 offset:320
    ds_read_b32 v98, v81 offset:384
    v_mov_b32 v76, 0xbfb8aa3b
    v_mul_f32 v76, s62, v76
    v_exp_f32 v76, v76
    v_subrev_f32 v77, s60, v84
    v_add_f32 v76, 1.0, v76
    v_rcp_f32 v76, v76
    v_mul_f32 v77, s61, v77
    v_cvt_pk_bf16_f32 v76, v76, v76
    v_and_b32 v76, 0xffff0000, v76
    v_cvt_pk_bf16_f32 v77, v77, v77
    v_and_b32 v77, 0xffff0000, v77
    s_waitcnt lgkmcnt(0)
    v_add_f32 v92, v92, v93
    v_add_f32 v94, v94, v95
    v_add_f32 v96, v96, v97
    v_add_f32 v92, v92, v94
    v_add_f32 v96, v96, v98
    v_add_f32 v92, v92, v96
    v_cvt_pk_bf16_f32 v92, v92, v92
    v_and_b32 v92, 0xffff0000, v92
    v_mul_f32 v92, v92, v76
    v_cvt_pk_bf16_f32 v92, v92, v92
    v_and_b32 v92, 0xffff0000, v92
    v_add_f32 v92, v92, v77
    v_cvt_pk_bf16_f32 v92, v92, v92
    v_and_b32 v92, 0xffff0000, v92
    v_add_f32 v92, v92, v84
    v_cvt_pk_bf16_f32 v92, v92, v92
    s_sub_u32 s44, s2, 224
    v_and_b32 v92, 0xffff, v92
    s_nop 1
    v_mov_b32_dpp v93, v92 quad_perm:[1,1,1,1] row_mask:0xf bank_mask:0xf
    v_mov_b32_dpp v94, v92 quad_perm:[2,2,2,2] row_mask:0xf bank_mask:0xf
    v_mov_b32_dpp v95, v92 quad_perm:[3,3,3,3] row_mask:0xf bank_mask:0xf
    v_lshl_or_b32 v92, v93, 16, v92
    v_lshl_or_b32 v93, v95, 16, v94
    v_mov_b32 v94, s31
    s_lshl_b32 s44, s44, 7
    s_add_u32 s44, s44, 0x12a0000
    v_lshl_add_u32 v80, v1, 2, s44
    s_mov_b32 exec_lo, 0x1111
    s_mov_b32 exec_hi, 0
    global_store_dwordx4 v80, v[92:95], s[10:11] sc0 sc1
    s_mov_b64 exec, -1
L_l0_fskip:
L_fin_b:
    s_lshr_b32 s44, s38, 8
    s_cmp_eq_u32 s44, s23
    s_cbranch_scc1 L_dofix
    s_cmp_lt_u32 s2, 224
    s_cbranch_scc1 L_nofix
    s_branch L_rebounce
L_dofix:
    s_lshl_b32 s44, s24, 11
    v_add_u32 v12, s44, v10
    ds_read_b64_tr_b16 v[40:41], v12 offset:0
    ds_read_b64_tr_b16 v[42:43], v12 offset:256
    ds_read_b64_tr_b16 v[44:45], v12 offset:16384
    ds_read_b64_tr_b16 v[46:47], v12 offset:16640
    ds_read_b64_tr_b16 v[48:49], v12 offset:32768
    ds_read_b64_tr_b16 v[50:51], v12 offset:33024
    ds_read_b64_tr_b16 v[52:53], v12 offset:1024
    ds_read_b64_tr_b16 v[54:55], v12 offset:1280
    ds_read_b64_tr_b16 v[56:57], v12 offset:17408
    ds_read_b64_tr_b16 v[58:59], v12 offset:17664
    ds_read_b64_tr_b16 v[60:61], v12 offset:33792
    ds_read_b64_tr_b16 v[62:63], v12 offset:34048
    v_mov_b32 v72, s63
    v_mov_b32 v73, s63
    v_mov_b32 v74, s63
    v_mov_b32 v75, s63
    s_lshl_b32 s44, s24, 8
    s_add_u32 s44, s44, 152064
    v_and_b32 v12, 48, v1
    v_add_u32 v12, s44, v12
    v_mov_b32 v13, s44
    s_cmp_lt_u32 s2, 224
    s_cbranch_scc1 L_px_go
    s_lshl_b32 s44, s24, 9
    s_add_u32 s44, s44, 0x12a0000
    v_lshl_add_u32 v2, v7, 7, s44
    v_bfe_u32 v4, v1, 4, 1
    v_lshl_add_u32 v2, v4, 5, v2
    global_load_dwordx3 v[76:78], v2, s[10:11] offset:0 sc0 sc1
    global_load_dwordx3 v[80:82], v2, s[10:11] offset:16 sc0 sc1
    global_load_dwordx3 v[84:86], v2, s[10:11] offset:256 sc0 sc1
    global_load_dwordx3 v[88:90], v2, s[10:11] offset:272 sc0 sc1
L_px_go:
    s_mov_b32 s29, 65536
    s_branch L_px_w
L_px:
L_px_l:
    global_load_dwordx3 v[76:78], v2, s[10:11] offset:0 sc0 sc1
    global_load_dwordx3 v[80:82], v2, s[10:11] offset:16 sc0 sc1
    global_load_dwordx3 v[84:86], v2, s[10:11] offset:256 sc0 sc1
    global_load_dwordx3 v[88:90], v2, s[10:11] offset:272 sc0 sc1
L_px_w:
    s_waitcnt vmcnt(0)
    v_cmp_ne_u32 vcc, s31, v78
    v_cmp_ne_u32 s[42:43], s31, v82
    s_or_b64 vcc, vcc, s[42:43]
    v_cmp_ne_u32 s[42:43], s31, v86
    s_or_b64 vcc, vcc, s[42:43]
    v_cmp_ne_u32 s[42:43], s31, v90
    s_or_b64 vcc, vcc, s[42:43]
    s_sub_u32 s29, s29, 1
    s_cbranch_vccz L_px_ok
    s_cbranch_scc0 L_px
L_px_ok:
    v_mov_b32 v64, v76
    v_mov_b32 v65, v77
    v_mov_b32 v66, v80
    v_mov_b32 v67, v81
    v_mov_b32 v68, v84
    v_mov_b32 v69, v85
    v_mov_b32 v70, v88
    v_mov_b32 v71, v89
    s_waitcnt lgkmcnt(0)
    v_mfma_f32_16x16x32_bf16 v[76:79], v[40:43], v[64:67], 0
    v_mfma_f32_16x16x32_bf16 v[80:83], v[44:47], v[64:67], 0
    v_mfma_f32_16x16x32_bf16 v[84:87], v[48:51], v[64:67], 0
    v_mfma_f32_16x16x32_bf16 v[88:91], v[72:75], v[64:67], 0
    v_mfma_f32_16x16x32_bf16 v[92:95], v[64:67], v[64:67], 0
    v_mfma_f32_16x16x32_bf16 v[76:79], v[52:55], v[68:71], v[76:79]
    v_mfma_f32_16x16x32_bf16 v[80:83], v[56:59], v[68:71], v[80:83]
    v_mfma_f32_16x16x32_bf16 v[84:87], v[60:63], v[68:71], v[84:87]
    v_mfma_f32_16x16x32_bf16 v[88:91], v[72:75], v[68:71], v[88:91]
    v_mfma_f32_16x16x32_bf16 v[92:95], v[68:71], v[68:71], v[92:95]
    s_mov_b32 exec_lo, 0x00010001
    s_mov_b32 exec_hi, 0x00010001
    s_nop 5
    ds_write_b128 v12, v[76:79] offset:0
    ds_write_b128 v12, v[80:83] offset:64
    ds_write_b128 v12, v[84:87] offset:128
    ds_write_b32 v13, v88 offset:192
    ds_write_b32 v13, v92 offset:196
    s_mov_b64 exec, -1
    s_and_b32 s44, s38, 31
    v_and_b32 v15, 15, v1
    v_lshrrev_b32 v14, 4, v1
    v_lshlrev_b32 v14, 2, v14
    v_sub_u32 v66, s44, v14
    v_sub_u32 v67, s44, v15
    v_lshlrev_b32 v15, 2, v15
    v_add_u32 v15, 149888, v15
    v_and_b32 v12, 48, v1
    v_add_u32 v12, 149760, v12
    s_waitcnt lgkmcnt(0)
    s_barrier
    s_lshr_b32 s44, s38, 5
    s_cmp_lg_u32 s44, s36
    s_cbranch_scc1 L_nores
    s_lshl_b32 s44, s37, 7
    s_add_u32 s44, s44, 0x12a0000
    v_lshl_add_u32 v14, v7, 4, s44
    v_cmp_eq_u32 vcc, s38, v125
    s_and_saveexec_b64 s[42:43], vcc
    global_load_dwordx2 v[116:117], v14, s[10:11] sc0 sc1
    global_load_dwordx2 v[118:119], v14, s[10:11] offset:32 sc0 sc1
    v_mov_b32 v127, 0
    s_mov_b64 exec, -1
L_nores:
    s_lshr_b32 s44, s38, 5
    s_cmp_lg_u32 s44, s25
    s_cbranch_scc1 L_rebounce
    v_lshlrev_b32 v13, 2, v1
    v_add_u32 v14, 152064, v13
    ds_read_b32 v104, v14 offset:0
    ds_read_b32 v105, v14 offset:256
    ds_read_b32 v106, v14 offset:512
    ds_read_b32 v107, v14 offset:768
    ds_read_b32 v108, v14 offset:1024
    ds_read_b32 v109, v14 offset:1280
    ds_read_b32 v110, v14 offset:1536
    ds_read_b32 v111, v14 offset:1792
    v_add_u32 v13, 149760, v13
    s_waitcnt lgkmcnt(0)
    v_add_f32 v104, v104, v105
    v_add_f32 v106, v106, v107
    v_add_f32 v108, v108, v109
    v_add_f32 v110, v110, v111
    v_add_f32 v104, v104, v106
    v_add_f32 v108, v108, v110
    v_add_f32 v104, v104, v108
    ds_write_b32 v13, v104
    v_mov_b32 v13, 149952
    ds_read_b128 v[76:79], v12 offset:0
    ds_read_b128 v[80:83], v12 offset:64
    ds_read_b64 v[64:65], v13
    ds_read_b32 v68, v15
    v_cmp_eq_u32 s[40:41], 0, v67
    v_cmp_eq_u32 s[42:43], 0, v66
    v_cmp_eq_u32 s[44:45], 1, v66
    v_cmp_eq_u32 s[46:47], 2, v66
    v_cmp_eq_u32 s[48:49], 3, v66
    s_waitcnt lgkmcnt(0)
    v_mul_f32 v69, s64, v64
    v_mul_f32 v70, s64, v65
    v_fma_f32 v70, -v69, v69, v70
    v_max_f32 v70, 0, v70
    v_add_f32 v71, s65, v70
    v_rsq_f32 v71, v71
    v_cndmask_b32 v16, v16, v76, s[40:41]
    v_cndmask_b32 v17, v17, v77, s[40:41]
    v_cndmask_b32 v18, v18, v78, s[40:41]
    v_cndmask_b32 v19, v19, v79, s[40:41]
    v_cndmask_b32 v24, v24, v80, s[40:41]
    v_cndmask_b32 v25, v25, v81, s[40:41]
    v_cndmask_b32 v26, v26, v82, s[40:41]
    v_cndmask_b32 v27, v27, v83, s[40:41]
    v_cndmask_b32 v112, v112, v69, s[40:41]
    v_cndmask_b32 v113, v113, v71, s[40:41]
    v_cndmask_b32 v32, v32, v68, s[42:43]
    v_cndmask_b32 v33, v33, v68, s[44:45]
    v_cndmask_b32 v34, v34, v68, s[46:47]
    v_cndmask_b32 v35, v35, v68, s[48:49]
    v_cmp_eq_u32 s[40:41], 16, v67
    v_cmp_eq_u32 s[42:43], 16, v66
    v_cmp_eq_u32 s[44:45], 17, v66
    v_cmp_eq_u32 s[46:47], 18, v66
    v_cmp_eq_u32 s[48:49], 19, v66
    s_nop 0
    v_cndmask_b32 v20, v20, v76, s[40:41]
    v_cndmask_b32 v21, v21, v77, s[40:41]
    v_cndmask_b32 v22, v22, v78, s[40:41]
    v_cndmask_b32 v23, v23, v79, s[40:41]
    v_cndmask_b32 v28, v28, v80, s[40:41]
    v_cndmask_b32 v29, v29, v81, s[40:41]
    v_cndmask_b32 v30, v30, v82, s[40:41]
    v_cndmask_b32 v31, v31, v83, s[40:41]
    v_cndmask_b32 v114, v114, v69, s[40:41]
    v_cndmask_b32 v115, v115, v71, s[40:41]
    v_cndmask_b32 v36, v36, v68, s[42:43]
    v_cndmask_b32 v37, v37, v68, s[44:45]
    v_cndmask_b32 v38, v38, v68, s[46:47]
    v_cndmask_b32 v39, v39, v68, s[48:49]
L_rebounce:
    s_lshl_b32 s44, s24, 8
    s_add_u32 s44, s44, 150016
    v_and_b32 v13, 15, v1
    v_lshl_add_u32 v12, v13, 2, s44
    ds_write_b32 v12, v112 offset:0
    ds_write_b32 v12, v113 offset:128
    ds_write_b32 v12, v114 offset:64
    ds_write_b32 v12, v115 offset:192
    v_and_b32 v14, 48, v1
    v_add_u32 v12, s44, v14
    ds_read_b128 v[76:79], v12 offset:0
    ds_read_b128 v[84:87], v12 offset:128
    ds_read_b128 v[80:83], v12 offset:64
    ds_read_b128 v[88:91], v12 offset:192
    v_add_u32 v12, 149504, v14
    ds_read_b128 v[96:99], v12 offset:0
    ds_read_b128 v[100:103], v12 offset:64
    v_lshlrev_b32 v12, 2, v13
    v_add_u32 v12, 149632, v12
    ds_read_b32 v108, v12
L_nofix:
    s_waitcnt vmcnt(0)
    s_add_u32 s52, s10, 0x800000
    s_addc_u32 s53, s11, 0
    s_add_u32 s54, s10, 0xa00000
    s_addc_u32 s55, s11, 0
    s_add_u32 s56, s10, 0xe00000
    s_addc_u32 s57, s11, 0
    v_mul_f32 v13, 0x3eb8aa3b, v113
    v_mul_f32 v14, 0x3eb8aa3b, v115
    s_lshl_b32 s44, s22, 16
    s_lshl_b32 s45, s25, 10
    s_add_u32 s44, s44, s45
    v_add_u32 v4, s44, v3
    v_add_u32 v15, s26, v3
    v_add_u32 v5, 0x10000, v15
    s_waitcnt lgkmcnt(0)
    v_fma_f32 v24, -v112, v100, v24
    v_fma_f32 v25, -v112, v101, v25
    v_fma_f32 v26, -v112, v102, v26
    v_fma_f32 v27, -v112, v103, v27
    v_fma_f32 v28, -v114, v100, v28
    v_fma_f32 v29, -v114, v101, v29
    v_fma_f32 v30, -v114, v102, v30
    v_fma_f32 v31, -v114, v103, v31
    v_mul_f32 v24, v113, v24
    v_mul_f32 v25, v113, v25
    v_mul_f32 v26, v113, v26
    v_mul_f32 v27, v113, v27
    v_mul_f32 v28, v115, v28
    v_mul_f32 v29, v115, v29
    v_mul_f32 v30, v115, v30
    v_mul_f32 v31, v115, v31
    v_cvt_pk_bf16_f32 v64, v24, v25
    v_cvt_pk_bf16_f32 v65, v26, v27
    v_cvt_pk_bf16_f32 v66, v28, v29
    v_cvt_pk_bf16_f32 v67, v30, v31
    v_fma_f32 v16, -v112, v96, v16
    v_fma_f32 v17, -v112, v97, v17
    v_fma_f32 v18, -v112, v98, v18
    v_fma_f32 v19, -v112, v99, v19
    v_fma_f32 v20, -v114, v96, v20
    v_fma_f32 v21, -v114, v97, v21
    v_fma_f32 v22, -v114, v98, v22
    v_fma_f32 v23, -v114, v99, v23
    v_mul_f32 v16, v13, v16
    v_mul_f32 v17, v13, v17
    v_mul_f32 v18, v13, v18
    v_mul_f32 v19, v13, v19
    v_mul_f32 v20, v14, v20
    v_mul_f32 v21, v14, v21
    v_mul_f32 v22, v14, v22
    v_mul_f32 v23, v14, v23
    v_cvt_pk_bf16_f32 v104, v16, v17
    v_cvt_pk_bf16_f32 v105, v18, v19
    v_cvt_pk_bf16_f32 v106, v20, v21
    v_cvt_pk_bf16_f32 v107, v22, v23
    v_fma_f32 v32, -v76, v108, v32
    v_permlane16_swap_b32 v64, v66
    v_permlane16_swap_b32 v65, v67
    v_permlane16_swap_b32 v104, v106
    v_permlane16_swap_b32 v105, v107
    global_store_dwordx4 v4, v[64:67], s[52:53] sc1
    ds_write_b128 v15, v[64:67]
    v_mfma_f32_32x32x16_bf16 v[16:31], v[64:67], v[104:107], 0
    v_fma_f32 v33, -v77, v108, v33
    v_fma_f32 v34, -v78, v108, v34
    v_fma_f32 v35, -v79, v108, v35
    v_fma_f32 v36, -v80, v108, v36
    v_fma_f32 v37, -v81, v108, v37
    v_fma_f32 v38, -v82, v108, v38
    v_fma_f32 v39, -v83, v108, v39
    v_mul_f32 v32, v84, v32
    v_mul_f32 v33, v85, v33
    v_mul_f32 v34, v86, v34
    v_mul_f32 v35, v87, v35
    v_mul_f32 v36, v88, v36
    v_mul_f32 v37, v89, v37
    v_mul_f32 v38, v90, v38
    v_mul_f32 v39, v91, v39
    v_cvt_pk_bf16_f32 v68, v32, v33
    v_cvt_pk_bf16_f32 v69, v34, v35
    v_cvt_pk_bf16_f32 v70, v36, v37
    v_cvt_pk_bf16_f32 v71, v38, v39
    v_max3_f32 v2, v16, v17, v18
    v_max3_f32 v13, v19, v20, v21
    v_permlane32_swap_b32 v68, v70
    v_permlane32_swap_b32 v69, v71
    global_store_dwordx4 v4, v[68:71], s[54:55] sc1
    ds_write_b128 v5, v[68:71]
    v_max3_f32 v2, v2, v22, v23
    v_max3_f32 v2, v2, v26, v27
    v_max3_f32 v2, v2, v30, v31
    v_max3_f32 v13, v13, v24, v25
    v_max3_f32 v13, v13, v28, v29
    v_max_f32 v2, v2, v13
    v_mov_b32 v13, v2
    s_nop 1
    v_permlane32_swap_b32 v2, v13
    v_max_f32 v2, v2, v13
    v_sub_f32 v72, 0, v2
    v_sub_f32 v73, 0, v2
    v_sub_f32 v74, 0, v2
    v_sub_f32 v75, 0, v2
    v_sub_f32 v76, 0, v2
    v_sub_f32 v77, 0, v2
    v_sub_f32 v78, 0, v2
    v_sub_f32 v79, 0, v2
    v_sub_f32 v80, 0, v2
    v_sub_f32 v81, 0, v2
    v_sub_f32 v82, 0, v2
    v_sub_f32 v83, 0, v2
    v_sub_f32 v84, 0, v2
    v_sub_f32 v85, 0, v2
    v_sub_f32 v86, 0, v2
    v_sub_f32 v87, 0, v2
    v_and_b32 v8, 15, v1
    v_bfe_u32 v9, v1, 4, 1
    v_lshlrev_b32 v10, 4, v8
    v_lshl_add_u32 v10, v7, 8, v10
    v_lshl_add_u32 v115, v9, 16, v10
    v_add_u32 v115, 0x10000, v115
    v_xor_b32 v9, 1, v9
    v_lshlrev_b32 v114, 13, v9
    v_mov_b32 v112, v3
    v_mov_b32 v113, v115
    s_mov_b32 s30, 0
    s_lshl_b32 s44, s22, 10
    s_add_u32 s44, s44, 0x1288000
    v_lshl_add_u32 v8, v1, 7, s44
    s_lshl_b32 s45, s23, 7
    s_add_u32 s44, s44, s45
    v_mov_b32 v9, s44
    s_waitcnt lgkmcnt(0)
    s_barrier
    ds_read_b128 v[108:111], v112
    ds_read_b128 v[56:59], v113
    ds_read_b128 v[60:63], v113 offset:512
    s_waitcnt lgkmcnt(0)
    v_mfma_f32_32x32x16_bf16 v[16:31], v[108:111], v[104:107], v[72:87]
    ds_read_b128 v[108:111], v112 offset:1024
    s_nop 10
    s_setprio 3
    v_exp_f32 v16, v16
    v_exp_f32 v17, v17
    v_exp_f32 v18, v18
    v_exp_f32 v19, v19
    v_exp_f32 v20, v20
    s_waitcnt lgkmcnt(0)
    v_exp_f32 v21, v21
    v_mfma_f32_32x32x16_bf16 v[32:47], v[108:111], v[104:107], v[72:87]
    v_exp_f32 v22, v22
    ds_read_b128 v[108:111], v112 offset:2048
    v_exp_f32 v23, v23
    ds_read_b128 v[64:67], v113 offset:1024
    v_cvt_pk_bf16_f32 v48, v16, v17
    v_cvt_pk_bf16_f32 v49, v18, v19
    v_cvt_pk_bf16_f32 v50, v20, v21
    v_cvt_pk_bf16_f32 v51, v22, v23
    v_exp_f32 v24, v24
    ds_read_b128 v[68:71], v113 offset:1536
    v_exp_f32 v25, v25
    v_mfma_f32_32x32x16_bf16 v[88:103], v[56:59], v[48:51], 0
    v_exp_f32 v26, v26
    v_exp_f32 v27, v27
    v_exp_f32 v28, v28
    v_exp_f32 v29, v29
    v_exp_f32 v30, v30
    v_exp_f32 v31, v31
    v_cvt_pk_bf16_f32 v52, v24, v25
    v_cvt_pk_bf16_f32 v53, v26, v27
    v_cvt_pk_bf16_f32 v54, v28, v29
    v_cvt_pk_bf16_f32 v55, v30, v31
    v_exp_f32 v32, v32
    v_exp_f32 v33, v33
    v_mfma_f32_32x32x16_bf16 v[88:103], v[60:63], v[52:55], v[88:103]
    s_waitcnt vmcnt(0)
    s_barrier
    s_cmp_lg_u32 s24, 0
    s_cbranch_scc1 L_l1_noflag
    v_mov_b32 v14, s31
    s_mov_b64 exec, 1
    global_store_dword v9, v14, s[10:11] sc0 sc1
    s_mov_b64 exec, -1
L_l1_noflag:
    v_exp_f32 v34, v34
    v_exp_f32 v35, v35
    v_exp_f32 v36, v36
    s_waitcnt lgkmcnt(0)
    v_exp_f32 v37, v37
    v_mfma_f32_32x32x16_bf16 v[16:31], v[108:111], v[104:107], v[72:87]
    v_exp_f32 v38, v38
    ds_read_b128 v[108:111], v112 offset:3072
    v_exp_f32 v39, v39
    ds_read_b128 v[56:59], v113 offset:2048
    v_cvt_pk_bf16_f32 v48, v32, v33
    v_cvt_pk_bf16_f32 v49, v34, v35
    v_cvt_pk_bf16_f32 v50, v36, v37
    v_cvt_pk_bf16_f32 v51, v38, v39
    v_exp_f32 v40, v40
    ds_read_b128 v[60:63], v113 offset:2560
    v_exp_f32 v41, v41
    v_mfma_f32_32x32x16_bf16 v[88:103], v[64:67], v[48:51], v[88:103]
    v_exp_f32 v42, v42
    v_exp_f32 v43, v43
    v_exp_f32 v44, v44
    v_exp_f32 v45, v45
    v_exp_f32 v46, v46
    v_exp_f32 v47, v47
    v_cvt_pk_bf16_f32 v52, v40, v41
    v_cvt_pk_bf16_f32 v53, v42, v43
    v_cvt_pk_bf16_f32 v54, v44, v45
    v_cvt_pk_bf16_f32 v55, v46, v47
    v_exp_f32 v16, v16
    v_exp_f32 v17, v17
    v_mfma_f32_32x32x16_bf16 v[88:103], v[68:71], v[52:55], v[88:103]
    v_exp_f32 v18, v18
    v_exp_f32 v19, v19
    v_exp_f32 v20, v20
    s_waitcnt lgkmcnt(0)
    v_exp_f32 v21, v21
    v_mfma_f32_32x32x16_bf16 v[32:47], v[108:111], v[104:107], v[72:87]
    v_exp_f32 v22, v22
    ds_read_b128 v[108:111], v112 offset:4096
    v_exp_f32 v23, v23
    ds_read_b128 v[64:67], v113 offset:3072
    v_cvt_pk_bf16_f32 v48, v16, v17
    v_cvt_pk_bf16_f32 v49, v18, v19
    v_cvt_pk_bf16_f32 v50, v20, v21
    v_cvt_pk_bf16_f32 v51, v22, v23
    v_exp_f32 v24, v24
    ds_read_b128 v[68:71], v113 offset:3584
    v_exp_f32 v25, v25
    v_mfma_f32_32x32x16_bf16 v[88:103], v[56:59], v[48:51], v[88:103]
    v_exp_f32 v26, v26
    v_exp_f32 v27, v27
    v_exp_f32 v28, v28
    v_exp_f32 v29, v29
    v_exp_f32 v30, v30
    v_exp_f32 v31, v31
    v_cvt_pk_bf16_f32 v52, v24, v25
    v_cvt_pk_bf16_f32 v53, v26, v27
    v_cvt_pk_bf16_f32 v54, v28, v29
    v_cvt_pk_bf16_f32 v55, v30, v31
    v_exp_f32 v32, v32
    v_exp_f32 v33, v33
    v_mfma_f32_32x32x16_bf16 v[88:103], v[60:63], v[52:55], v[88:103]
    v_exp_f32 v34, v34
    v_exp_f32 v35, v35
    v_exp_f32 v36, v36
    s_waitcnt lgkmcnt(0)
    v_exp_f32 v37, v37
    v_mfma_f32_32x32x16_bf16 v[16:31], v[108:111], v[104:107], v[72:87]
    v_exp_f32 v38, v38
    ds_read_b128 v[108:111], v112 offset:5120
    v_exp_f32 v39, v39
    ds_read_b128 v[56:59], v113 offset:4096
    v_cvt_pk_bf16_f32 v48, v32, v33
    v_cvt_pk_bf16_f32 v49, v34, v35
    v_cvt_pk_bf16_f32 v50, v36, v37
    v_cvt_pk_bf16_f32 v51, v38, v39
    v_exp_f32 v40, v40
    ds_read_b128 v[60:63], v113 offset:4608
    v_exp_f32 v41, v41
    v_mfma_f32_32x32x16_bf16 v[88:103], v[64:67], v[48:51], v[88:103]
    v_exp_f32 v42, v42
    v_exp_f32 v43, v43
    v_exp_f32 v44, v44
    v_exp_f32 v45, v45
    v_exp_f32 v46, v46
    v_exp_f32 v47, v47
    v_cvt_pk_bf16_f32 v52, v40, v41
    v_cvt_pk_bf16_f32 v53, v42, v43
    v_cvt_pk_bf16_f32 v54, v44, v45
    v_cvt_pk_bf16_f32 v55, v46, v47
    s_setprio 2
    v_exp_f32 v16, v16
    v_exp_f32 v17, v17
    v_mfma_f32_32x32x16_bf16 v[88:103], v[68:71], v[52:55], v[88:103]
    s_mov_b64 exec, 0xff
    global_load_dword v14, v8, s[10:11] sc0 sc1
    s_mov_b64 exec, -1
    v_exp_f32 v18, v18
    v_exp_f32 v19, v19
    v_exp_f32 v20, v20
    s_waitcnt lgkmcnt(0)
    v_exp_f32 v21, v21
    v_mfma_f32_32x32x16_bf16 v[32:47], v[108:111], v[104:107], v[72:87]
    v_exp_f32 v22, v22
    ds_read_b128 v[108:111], v112 offset:6144
    v_exp_f32 v23, v23
    ds_read_b128 v[64:67], v113 offset:5120
    v_cvt_pk_bf16_f32 v48, v16, v17
    v_cvt_pk_bf16_f32 v49, v18, v19
    v_cvt_pk_bf16_f32 v50, v20, v21
    v_cvt_pk_bf16_f32 v51, v22, v23
    v_exp_f32 v24, v24
    ds_read_b128 v[68:71], v113 offset:5632
    v_exp_f32 v25, v25
    v_mfma_f32_32x32x16_bf16 v[88:103], v[56:59], v[48:51], v[88:103]
    v_exp_f32 v26, v26
    v_exp_f32 v27, v27
    v_exp_f32 v28, v28
    v_exp_f32 v29, v29
    v_exp_f32 v30, v30
    v_exp_f32 v31, v31
    v_cvt_pk_bf16_f32 v52, v24, v25
    v_cvt_pk_bf16_f32 v53, v26, v27
    v_cvt_pk_bf16_f32 v54, v28, v29
    v_cvt_pk_bf16_f32 v55, v30, v31
    v_exp_f32 v32, v32
    v_exp_f32 v33, v33
    v_mfma_f32_32x32x16_bf16 v[88:103], v[60:63], v[52:55], v[88:103]
    s_mov_b64 exec, 0xff
    s_lshr_b32 s44, s38, 8
    s_bitset0_b32 exec_lo, s44
    s_mov_b32 s29, 65536
    s_branch L_l1_pk_w
L_l1_pk:
L_l1_pk_l:
    global_load_dword v14, v8, s[10:11] sc0 sc1
L_l1_pk_w:
    s_waitcnt vmcnt(0)
    v_cmp_ne_u32 vcc, s31, v14
    s_sub_u32 s29, s29, 1
    s_cbranch_vccz L_l1_pk_ok
    s_cbranch_scc0 L_l1_pk
L_l1_pk_ok:
    s_mov_b64 exec, -1
    s_lshr_b32 s45, s38, 8
    s_sub_u32 s45, s45, s23
    s_and_b32 s45, s45, 7
    s_sub_u32 s45, s45, 1
    s_cmp_lt_u32 s45, 1
    s_cselect_b32 s44, 2, 1
    s_add_u32 s44, s23, s44
    s_and_b32 s44, s44, 7
    s_sub_u32 s44, s44, s23
    s_lshl_b32 s44, s44, 13
    v_add_u32 v13, s44, v4
    global_load_dwordx4 a[64:67], v13, s[52:53] sc1
    global_load_dwordx4 a[68:71], v13, s[54:55] sc1
    s_lshr_b32 s45, s38, 8
    s_sub_u32 s45, s45, s23
    s_and_b32 s45, s45, 7
    s_sub_u32 s45, s45, 1
    s_cmp_lt_u32 s45, 2
    s_cselect_b32 s44, 3, 2
    s_add_u32 s44, s23, s44
    s_and_b32 s44, s44, 7
    s_sub_u32 s44, s44, s23
    s_lshl_b32 s44, s44, 13
    v_add_u32 v13, s44, v4
    global_load_dwordx4 a[72:75], v13, s[52:53] sc1
    global_load_dwordx4 a[76:79], v13, s[54:55] sc1
    v_exp_f32 v34, v34
    v_exp_f32 v35, v35
    v_exp_f32 v36, v36
    s_waitcnt lgkmcnt(0)
    v_exp_f32 v37, v37
    v_mfma_f32_32x32x16_bf16 v[16:31], v[108:111], v[104:107], v[72:87]
    v_exp_f32 v38, v38
    ds_read_b128 v[108:111], v112 offset:7168
    v_exp_f32 v39, v39
    ds_read_b128 v[56:59], v113 offset:6144
    v_cvt_pk_bf16_f32 v48, v32, v33
    v_cvt_pk_bf16_f32 v49, v34, v35
    v_cvt_pk_bf16_f32 v50, v36, v37
    v_cvt_pk_bf16_f32 v51, v38, v39
    v_exp_f32 v40, v40
    ds_read_b128 v[60:63], v113 offset:6656
    v_exp_f32 v41, v41
    v_mfma_f32_32x32x16_bf16 v[88:103], v[64:67], v[48:51], v[88:103]
    v_exp_f32 v42, v42
    v_exp_f32 v43, v43
    v_exp_f32 v44, v44
    v_exp_f32 v45, v45
    v_exp_f32 v46, v46
    v_exp_f32 v47, v47
    v_cvt_pk_bf16_f32 v52, v40, v41
    v_cvt_pk_bf16_f32 v53, v42, v43
    v_cvt_pk_bf16_f32 v54, v44, v45
    v_cvt_pk_bf16_f32 v55, v46, v47
    s_setprio 1
    v_exp_f32 v16, v16
    v_exp_f32 v17, v17
    v_mfma_f32_32x32x16_bf16 v[88:103], v[68:71], v[52:55], v[88:103]
    v_exp_f32 v18, v18
    v_exp_f32 v19, v19
    v_exp_f32 v20, v20
    s_waitcnt lgkmcnt(0)
    v_exp_f32 v21, v21
    v_mfma_f32_32x32x16_bf16 v[32:47], v[108:111], v[104:107], v[72:87]
    v_exp_f32 v22, v22
    v_exp_f32 v23, v23
    ds_read_b128 v[64:67], v113 offset:7168
    v_cvt_pk_bf16_f32 v48, v16, v17
    v_cvt_pk_bf16_f32 v49, v18, v19
    v_cvt_pk_bf16_f32 v50, v20, v21
    v_cvt_pk_bf16_f32 v51, v22, v23
    v_exp_f32 v24, v24
    ds_read_b128 v[68:71], v113 offset:7680
    v_exp_f32 v25, v25
    v_mfma_f32_32x32x16_bf16 v[88:103], v[56:59], v[48:51], v[88:103]
    v_exp_f32 v26, v26
    v_exp_f32 v27, v27
    v_exp_f32 v28, v28
    v_exp_f32 v29, v29
    v_exp_f32 v30, v30
    v_exp_f32 v31, v31
    v_cvt_pk_bf16_f32 v52, v24, v25
    v_cvt_pk_bf16_f32 v53, v26, v27
    v_cvt_pk_bf16_f32 v54, v28, v29
    v_cvt_pk_bf16_f32 v55, v30, v31
    s_setprio 0
    v_exp_f32 v32, v32
    v_exp_f32 v33, v33
    v_mfma_f32_32x32x16_bf16 v[88:103], v[60:63], v[52:55], v[88:103]
    v_exp_f32 v34, v34
    v_exp_f32 v35, v35
    v_exp_f32 v36, v36
    s_waitcnt lgkmcnt(0)
    v_exp_f32 v37, v37
    v_exp_f32 v38, v38
    v_exp_f32 v39, v39
    v_cvt_pk_bf16_f32 v48, v32, v33
    v_cvt_pk_bf16_f32 v49, v34, v35
    v_cvt_pk_bf16_f32 v50, v36, v37
    v_cvt_pk_bf16_f32 v51, v38, v39
    v_exp_f32 v40, v40
    v_exp_f32 v41, v41
    v_mfma_f32_32x32x16_bf16 v[88:103], v[64:67], v[48:51], v[88:103]
    v_exp_f32 v42, v42
    v_exp_f32 v43, v43
    v_exp_f32 v44, v44
    v_exp_f32 v45, v45
    v_exp_f32 v46, v46
    v_exp_f32 v47, v47
    v_cvt_pk_bf16_f32 v52, v40, v41
    v_cvt_pk_bf16_f32 v53, v42, v43
    v_cvt_pk_bf16_f32 v54, v44, v45
    v_cvt_pk_bf16_f32 v55, v46, v47
    v_add_u32 v112, 0x2000, v112
    v_add_u32 v113, v114, v113
    s_waitcnt vmcnt(2)
    ds_write_b128 v15, a[64:67] offset:8192
    ds_write_b128 v5, a[68:71] offset:8192
    s_waitcnt lgkmcnt(0)
    s_barrier
    ds_read_b128 v[108:111], v112
    ds_read_b128 v[56:59], v113
    ds_read_b128 v[60:63], v113 offset:512
    s_waitcnt lgkmcnt(0)
    v_mfma_f32_32x32x16_bf16 v[16:31], v[108:111], v[104:107], v[72:87]
    ds_read_b128 v[108:111], v112 offset:1024
    s_nop 10
    s_setprio 3
    v_exp_f32 v16, v16
    v_exp_f32 v17, v17
    v_mfma_f32_32x32x16_bf16 v[88:103], v[68:71], v[52:55], v[88:103]
    s_lshr_b32 s45, s38, 8
    s_sub_u32 s45, s45, s23
    s_and_b32 s45, s45, 7
    s_sub_u32 s45, s45, 1
    s_cmp_lt_u32 s45, 3
    s_cselect_b32 s44, 4, 3
    s_add_u32 s44, s23, s44
    s_and_b32 s44, s44, 7
    s_sub_u32 s44, s44, s23
    s_lshl_b32 s44, s44, 13
    v_add_u32 v13, s44, v4
    global_load_dwordx4 a[80:83], v13, s[52:53] sc1
    global_load_dwordx4 a[84:87], v13, s[54:55] sc1
    v_exp_f32 v18, v18
    v_exp_f32 v19, v19
    v_exp_f32 v20, v20
    s_waitcnt lgkmcnt(0)
    v_exp_f32 v21, v21
    v_mfma_f32_32x32x16_bf16 v[32:47], v[108:111], v[104:107], v[72:87]
    v_exp_f32 v22, v22
    ds_read_b128 v[108:111], v112 offset:2048
    v_exp_f32 v23, v23
    ds_read_b128 v[64:67], v113 offset:1024
    v_cvt_pk_bf16_f32 v48, v16, v17
    v_cvt_pk_bf16_f32 v49, v18, v19
    v_cvt_pk_bf16_f32 v50, v20, v21
    v_cvt_pk_bf16_f32 v51, v22, v23
    v_exp_f32 v24, v24
    ds_read_b128 v[68:71], v113 offset:1536
    v_exp_f32 v25, v25
    v_mfma_f32_32x32x16_bf16 v[88:103], v[56:59], v[48:51], v[88:103]
    v_exp_f32 v26, v26
    v_exp_f32 v27, v27
    v_exp_f32 v28, v28
    v_exp_f32 v29, v29
    v_exp_f32 v30, v30
    v_exp_f32 v31, v31
    v_cvt_pk_bf16_f32 v52, v24, v25
    v_cvt_pk_bf16_f32 v53, v26, v27
    v_cvt_pk_bf16_f32 v54, v28, v29
    v_cvt_pk_bf16_f32 v55, v30, v31
    v_exp_f32 v32, v32
    v_exp_f32 v33, v33
    v_mfma_f32_32x32x16_bf16 v[88:103], v[60:63], v[52:55], v[88:103]
    v_exp_f32 v34, v34
    v_exp_f32 v35, v35
    v_exp_f32 v36, v36
    s_waitcnt lgkmcnt(0)
    v_exp_f32 v37, v37
    v_mfma_f32_32x32x16_bf16 v[16:31], v[108:111], v[104:107], v[72:87]
    v_exp_f32 v38, v38
    ds_read_b128 v[108:111], v112 offset:3072
    v_exp_f32 v39, v39
    ds_read_b128 v[56:59], v113 offset:2048
    v_cvt_pk_bf16_f32 v48, v32, v33
    v_cvt_pk_bf16_f32 v49, v34, v35
    v_cvt_pk_bf16_f32 v50, v36, v37
    v_cvt_pk_bf16_f32 v51, v38, v39
    v_exp_f32 v40, v40
    ds_read_b128 v[60:63], v113 offset:2560
    v_exp_f32 v41, v41
    v_mfma_f32_32x32x16_bf16 v[88:103], v[64:67], v[48:51], v[88:103]
    v_exp_f32 v42, v42
    v_exp_f32 v43, v43
    v_exp_f32 v44, v44
    v_exp_f32 v45, v45
    v_exp_f32 v46, v46
    v_exp_f32 v47, v47
    v_cvt_pk_bf16_f32 v52, v40, v41
    v_cvt_pk_bf16_f32 v53, v42, v43
    v_cvt_pk_bf16_f32 v54, v44, v45
    v_cvt_pk_bf16_f32 v55, v46, v47
    v_exp_f32 v16, v16
    v_exp_f32 v17, v17
    v_mfma_f32_32x32x16_bf16 v[88:103], v[68:71], v[52:55], v[88:103]
    v_exp_f32 v18, v18
    v_exp_f32 v19, v19
    v_exp_f32 v20, v20
    s_waitcnt lgkmcnt(0)
    v_exp_f32 v21, v21
    v_mfma_f32_32x32x16_bf16 v[32:47], v[108:111], v[104:107], v[72:87]
    v_exp_f32 v22, v22
    ds_read_b128 v[108:111], v112 offset:4096
    v_exp_f32 v23, v23
    ds_read_b128 v[64:67], v113 offset:3072
    v_cvt_pk_bf16_f32 v48, v16, v17
    v_cvt_pk_bf16_f32 v49, v18, v19
    v_cvt_pk_bf16_f32 v50, v20, v21
    v_cvt_pk_bf16_f32 v51, v22, v23
    v_exp_f32 v24, v24
    ds_read_b128 v[68:71], v113 offset:3584
    v_exp_f32 v25, v25
    v_mfma_f32_32x32x16_bf16 v[88:103], v[56:59], v[48:51], v[88:103]
    v_exp_f32 v26, v26
    v_exp_f32 v27, v27
    v_exp_f32 v28, v28
    v_exp_f32 v29, v29
    v_exp_f32 v30, v30
    v_exp_f32 v31, v31
    v_cvt_pk_bf16_f32 v52, v24, v25
    v_cvt_pk_bf16_f32 v53, v26, v27
    v_cvt_pk_bf16_f32 v54, v28, v29
    v_cvt_pk_bf16_f32 v55, v30, v31
    s_setprio 2
    v_exp_f32 v32, v32
    v_exp_f32 v33, v33
    v_mfma_f32_32x32x16_bf16 v[88:103], v[60:63], v[52:55], v[88:103]
    s_lshr_b32 s45, s38, 8
    s_sub_u32 s45, s45, s23
    s_and_b32 s45, s45, 7
    s_sub_u32 s45, s45, 1
    s_cmp_lt_u32 s45, 4
    s_cselect_b32 s44, 5, 4
    s_add_u32 s44, s23, s44
    s_and_b32 s44, s44, 7
    s_sub_u32 s44, s44, s23
    s_lshl_b32 s44, s44, 13
    v_add_u32 v13, s44, v4
    global_load_dwordx4 a[88:91], v13, s[52:53] sc1
    global_load_dwordx4 a[92:95], v13, s[54:55] sc1
    v_exp_f32 v34, v34
    v_exp_f32 v35, v35
    v_exp_f32 v36, v36
    s_waitcnt lgkmcnt(0)
    v_exp_f32 v37, v37
    v_mfma_f32_32x32x16_bf16 v[16:31], v[108:111], v[104:107], v[72:87]
    v_exp_f32 v38, v38
    ds_read_b128 v[108:111], v112 offset:5120
    v_exp_f32 v39, v39
    ds_read_b128 v[56:59], v113 offset:4096
    v_cvt_pk_bf16_f32 v48, v32, v33
    v_cvt_pk_bf16_f32 v49, v34, v35
    v_cvt_pk_bf16_f32 v50, v36, v37
    v_cvt_pk_bf16_f32 v51, v38, v39
    v_exp_f32 v40, v40
    ds_read_b128 v[60:63], v113 offset:4608
    v_exp_f32 v41, v41
    v_mfma_f32_32x32x16_bf16 v[88:103], v[64:67], v[48:51], v[88:103]
    v_exp_f32 v42, v42
    v_exp_f32 v43, v43
    v_exp_f32 v44, v44
    v_exp_f32 v45, v45
    v_exp_f32 v46, v46
    v_exp_f32 v47, v47
    v_cvt_pk_bf16_f32 v52, v40, v41
    v_cvt_pk_bf16_f32 v53, v42, v43
    v_cvt_pk_bf16_f32 v54, v44, v45
    v_cvt_pk_bf16_f32 v55, v46, v47
    s_setprio 1
    v_exp_f32 v16, v16
    v_exp_f32 v17, v17
    v_mfma_f32_32x32x16_bf16 v[88:103], v[68:71], v[52:55], v[88:103]
    s_waitcnt vmcnt(4)
    ds_write_b128 v15, a[72:75] offset:16384
    ds_write_b128 v5, a[76:79] offset:16384
    v_exp_f32 v18, v18
    v_exp_f32 v19, v19
    v_exp_f32 v20, v20
    s_waitcnt lgkmcnt(0)
    v_exp_f32 v21, v21
    v_mfma_f32_32x32x16_bf16 v[32:47], v[108:111], v[104:107], v[72:87]
    v_exp_f32 v22, v22
    ds_read_b128 v[108:111], v112 offset:6144
    v_exp_f32 v23, v23
    ds_read_b128 v[64:67], v113 offset:5120
    v_cvt_pk_bf16_f32 v48, v16, v17
    v_cvt_pk_bf16_f32 v49, v18, v19
    v_cvt_pk_bf16_f32 v50, v20, v21
    v_cvt_pk_bf16_f32 v51, v22, v23
    v_exp_f32 v24, v24
    ds_read_b128 v[68:71], v113 offset:5632
    v_exp_f32 v25, v25
    v_mfma_f32_32x32x16_bf16 v[88:103], v[56:59], v[48:51], v[88:103]
    v_exp_f32 v26, v26
    v_exp_f32 v27, v27
    v_exp_f32 v28, v28
    v_exp_f32 v29, v29
    v_exp_f32 v30, v30
    v_exp_f32 v31, v31
    v_cvt_pk_bf16_f32 v52, v24, v25
    v_cvt_pk_bf16_f32 v53, v26, v27
    v_cvt_pk_bf16_f32 v54, v28, v29
    v_cvt_pk_bf16_f32 v55, v30, v31
    s_setprio 0
    v_exp_f32 v32, v32
    v_exp_f32 v33, v33
    v_mfma_f32_32x32x16_bf16 v[88:103], v[60:63], v[52:55], v[88:103]
    v_exp_f32 v34, v34
    v_exp_f32 v35, v35
    v_exp_f32 v36, v36
    s_waitcnt lgkmcnt(0)
    v_exp_f32 v37, v37
    v_mfma_f32_32x32x16_bf16 v[16:31], v[108:111], v[104:107], v[72:87]
    v_exp_f32 v38, v38
    ds_read_b128 v[108:111], v112 offset:7168
    v_exp_f32 v39, v39
    ds_read_b128 v[56:59], v113 offset:6144
    v_cvt_pk_bf16_f32 v48, v32, v33
    v_cvt_pk_bf16_f32 v49, v34, v35
    v_cvt_pk_bf16_f32 v50, v36, v37
    v_cvt_pk_bf16_f32 v51, v38, v39
    v_exp_f32 v40, v40
    ds_read_b128 v[60:63], v113 offset:6656
    v_exp_f32 v41, v41
    v_mfma_f32_32x32x16_bf16 v[88:103], v[64:67], v[48:51], v[88:103]
    v_exp_f32 v42, v42
    v_exp_f32 v43, v43
    v_exp_f32 v44, v44
    v_exp_f32 v45, v45
    v_exp_f32 v46, v46
    v_exp_f32 v47, v47
    v_cvt_pk_bf16_f32 v52, v40, v41
    v_cvt_pk_bf16_f32 v53, v42, v43
    v_cvt_pk_bf16_f32 v54, v44, v45
    v_cvt_pk_bf16_f32 v55, v46, v47
    s_setprio 3
    v_exp_f32 v16, v16
    v_exp_f32 v17, v17
    v_mfma_f32_32x32x16_bf16 v[88:103], v[68:71], v[52:55], v[88:103]
    s_waitcnt lgkmcnt(0)
    s_barrier
    v_exp_f32 v18, v18
    v_exp_f32 v19, v19
    v_exp_f32 v20, v20
    s_waitcnt lgkmcnt(0)
    v_exp_f32 v21, v21
    v_mfma_f32_32x32x16_bf16 v[32:47], v[108:111], v[104:107], v[72:87]
    v_exp_f32 v22, v22
    ds_read_b128 v[108:111], v112 offset:8192
    v_exp_f32 v23, v23
    ds_read_b128 v[64:67], v113 offset:7168
    v_cvt_pk_bf16_f32 v48, v16, v17
    v_cvt_pk_bf16_f32 v49, v18, v19
    v_cvt_pk_bf16_f32 v50, v20, v21
    v_cvt_pk_bf16_f32 v51, v22, v23
    v_exp_f32 v24, v24
    ds_read_b128 v[68:71], v113 offset:7680
    v_exp_f32 v25, v25
    v_mfma_f32_32x32x16_bf16 v[88:103], v[56:59], v[48:51], v[88:103]
    v_exp_f32 v26, v26
    v_exp_f32 v27, v27
    v_exp_f32 v28, v28
    v_exp_f32 v29, v29
    v_exp_f32 v30, v30
    v_exp_f32 v31, v31
    v_cvt_pk_bf16_f32 v52, v24, v25
    v_cvt_pk_bf16_f32 v53, v26, v27
    v_cvt_pk_bf16_f32 v54, v28, v29
    v_cvt_pk_bf16_f32 v55, v30, v31
    v_exp_f32 v32, v32
    v_exp_f32 v33, v33
    v_mfma_f32_32x32x16_bf16 v[88:103], v[60:63], v[52:55], v[88:103]
    v_exp_f32 v34, v34
    v_exp_f32 v35, v35
    v_exp_f32 v36, v36
    s_waitcnt lgkmcnt(0)
    v_exp_f32 v37, v37
    v_mfma_f32_32x32x16_bf16 v[16:31], v[108:111], v[104:107], v[72:87]
    v_exp_f32 v38, v38
    ds_read_b128 v[108:111], v112 offset:9216
    v_exp_f32 v39, v39
    ds_read_b128 v[56:59], v113 offset:8192
    v_cvt_pk_bf16_f32 v48, v32, v33
    v_cvt_pk_bf16_f32 v49, v34, v35
    v_cvt_pk_bf16_f32 v50, v36, v37
    v_cvt_pk_bf16_f32 v51, v38, v39
    v_exp_f32 v40, v40
    ds_read_b128 v[60:63], v113 offset:8704
    v_exp_f32 v41, v41
    v_mfma_f32_32x32x16_bf16 v[88:103], v[64:67], v[48:51], v[88:103]
    v_exp_f32 v42, v42
    v_exp_f32 v43, v43
    v_exp_f32 v44, v44
    v_exp_f32 v45, v45
    v_exp_f32 v46, v46
    v_exp_f32 v47, v47
    v_cvt_pk_bf16_f32 v52, v40, v41
    v_cvt_pk_bf16_f32 v53, v42, v43
    v_cvt_pk_bf16_f32 v54, v44, v45
    v_cvt_pk_bf16_f32 v55, v46, v47
    v_add_u32 v112, 0x2000, v112
    v_add_u32 v113, v114, v113
    v_exp_f32 v16, v16
    v_exp_f32 v17, v17
    v_mfma_f32_32x32x16_bf16 v[88:103], v[68:71], v[52:55], v[88:103]
    s_lshr_b32 s45, s38, 8
    s_sub_u32 s45, s45, s23
    s_and_b32 s45, s45, 7
    s_sub_u32 s45, s45, 1
    s_cmp_lt_u32 s45, 5
    s_cselect_b32 s44, 6, 5
    s_add_u32 s44, s23, s44
    s_and_b32 s44, s44, 7
    s_sub_u32 s44, s44, s23
    s_lshl_b32 s44, s44, 13
    v_add_u32 v13, s44, v4
    global_load_dwordx4 a[96:99], v13, s[52:53] sc1
    global_load_dwordx4 a[100:103], v13, s[54:55] sc1
    v_exp_f32 v18, v18
    v_exp_f32 v19, v19
    v_exp_f32 v20, v20
    s_waitcnt lgkmcnt(0)
    v_exp_f32 v21, v21
    v_mfma_f32_32x32x16_bf16 v[32:47], v[108:111], v[104:107], v[72:87]
    v_exp_f32 v22, v22
    ds_read_b128 v[108:111], v112 offset:2048
    v_exp_f32 v23, v23
    ds_read_b128 v[64:67], v113 offset:1024
    v_cvt_pk_bf16_f32 v48, v16, v17
    v_cvt_pk_bf16_f32 v49, v18, v19
    v_cvt_pk_bf16_f32 v50, v20, v21
    v_cvt_pk_bf16_f32 v51, v22, v23
    v_exp_f32 v24, v24
    ds_read_b128 v[68:71], v113 offset:1536
    v_exp_f32 v25, v25
    v_mfma_f32_32x32x16_bf16 v[88:103], v[56:59], v[48:51], v[88:103]
    v_exp_f32 v26, v26
    v_exp_f32 v27, v27
    v_exp_f32 v28, v28
    v_exp_f32 v29, v29
    v_exp_f32 v30, v30
    v_exp_f32 v31, v31
    v_cvt_pk_bf16_f32 v52, v24, v25
    v_cvt_pk_bf16_f32 v53, v26, v27
    v_cvt_pk_bf16_f32 v54, v28, v29
    v_cvt_pk_bf16_f32 v55, v30, v31
    v_exp_f32 v32, v32
    v_exp_f32 v33, v33
    v_mfma_f32_32x32x16_bf16 v[88:103], v[60:63], v[52:55], v[88:103]
    v_exp_f32 v34, v34
    v_exp_f32 v35, v35
    v_exp_f32 v36, v36
    s_waitcnt lgkmcnt(0)
    v_exp_f32 v37, v37
    v_mfma_f32_32x32x16_bf16 v[16:31], v[108:111], v[104:107], v[72:87]
    v_exp_f32 v38, v38
    ds_read_b128 v[108:111], v112 offset:3072
    v_exp_f32 v39, v39
    ds_read_b128 v[56:59], v113 offset:2048
    v_cvt_pk_bf16_f32 v48, v32, v33
    v_cvt_pk_bf16_f32 v49, v34, v35
    v_cvt_pk_bf16_f32 v50, v36, v37
    v_cvt_pk_bf16_f32 v51, v38, v39
    v_exp_f32 v40, v40
    ds_read_b128 v[60:63], v113 offset:2560
    v_exp_f32 v41, v41
    v_mfma_f32_32x32x16_bf16 v[88:103], v[64:67], v[48:51], v[88:103]
    v_exp_f32 v42, v42
    v_exp_f32 v43, v43
    v_exp_f32 v44, v44
    v_exp_f32 v45, v45
    v_exp_f32 v46, v46
    v_exp_f32 v47, v47
    v_cvt_pk_bf16_f32 v52, v40, v41
    v_cvt_pk_bf16_f32 v53, v42, v43
    v_cvt_pk_bf16_f32 v54, v44, v45
    v_cvt_pk_bf16_f32 v55, v46, v47
    s_setprio 2
    v_exp_f32 v16, v16
    v_exp_f32 v17, v17
    v_mfma_f32_32x32x16_bf16 v[88:103], v[68:71], v[52:55], v[88:103]
    v_exp_f32 v18, v18
    v_exp_f32 v19, v19
    v_exp_f32 v20, v20
    s_waitcnt lgkmcnt(0)
    v_exp_f32 v21, v21
    v_mfma_f32_32x32x16_bf16 v[32:47], v[108:111], v[104:107], v[72:87]
    v_exp_f32 v22, v22
    ds_read_b128 v[108:111], v112 offset:4096
    v_exp_f32 v23, v23
    ds_read_b128 v[64:67], v113 offset:3072
    v_cvt_pk_bf16_f32 v48, v16, v17
    v_cvt_pk_bf16_f32 v49, v18, v19
    v_cvt_pk_bf16_f32 v50, v20, v21
    v_cvt_pk_bf16_f32 v51, v22, v23
    v_exp_f32 v24, v24
    ds_read_b128 v[68:71], v113 offset:3584
    v_exp_f32 v25, v25
    v_mfma_f32_32x32x16_bf16 v[88:103], v[56:59], v[48:51], v[88:103]
    v_exp_f32 v26, v26
    v_exp_f32 v27, v27
    v_exp_f32 v28, v28
    v_exp_f32 v29, v29
    v_exp_f32 v30, v30
    v_exp_f32 v31, v31
    v_cvt_pk_bf16_f32 v52, v24, v25
    v_cvt_pk_bf16_f32 v53, v26, v27
    v_cvt_pk_bf16_f32 v54, v28, v29
    v_cvt_pk_bf16_f32 v55, v30, v31
    v_exp_f32 v32, v32
    v_exp_f32 v33, v33
    v_mfma_f32_32x32x16_bf16 v[88:103], v[60:63], v[52:55], v[88:103]
    s_lshr_b32 s45, s38, 8
    s_sub_u32 s45, s45, s23
    s_and_b32 s45, s45, 7
    s_sub_u32 s45, s45, 1
    s_cmp_lt_u32 s45, 6
    s_cselect_b32 s44, 7, 6
    s_add_u32 s44, s23, s44
    s_and_b32 s44, s44, 7
    s_sub_u32 s44, s44, s23
    s_lshl_b32 s44, s44, 13
    v_add_u32 v13, s44, v4
    global_load_dwordx4 a[104:107], v13, s[52:53] sc1
    global_load_dwordx4 a[108:111], v13, s[54:55] sc1
    v_exp_f32 v34, v34
    v_exp_f32 v35, v35
    v_exp_f32 v36, v36
    s_waitcnt lgkmcnt(0)
    v_exp_f32 v37, v37
    v_mfma_f32_32x32x16_bf16 v[16:31], v[108:111], v[104:107], v[72:87]
    v_exp_f32 v38, v38
    ds_read_b128 v[108:111], v112 offset:5120
    v_exp_f32 v39, v39
    ds_read_b128 v[56:59], v113 offset:4096
    v_cvt_pk_bf16_f32 v48, v32, v33
    v_cvt_pk_bf16_f32 v49, v34, v35
    v_cvt_pk_bf16_f32 v50, v36, v37
    v_cvt_pk_bf16_f32 v51, v38, v39
    v_exp_f32 v40, v40
    ds_read_b128 v[60:63], v113 offset:4608
    v_exp_f32 v41, v41
    v_mfma_f32_32x32x16_bf16 v[88:103], v[64:67], v[48:51], v[88:103]
    v_exp_f32 v42, v42
    v_exp_f32 v43, v43
    v_exp_f32 v44, v44
    v_exp_f32 v45, v45
    v_exp_f32 v46, v46
    v_exp_f32 v47, v47
    v_cvt_pk_bf16_f32 v52, v40, v41
    v_cvt_pk_bf16_f32 v53, v42, v43
    v_cvt_pk_bf16_f32 v54, v44, v45
    v_cvt_pk_bf16_f32 v55, v46, v47
    s_setprio 1
    v_exp_f32 v16, v16
    v_exp_f32 v17, v17
    v_mfma_f32_32x32x16_bf16 v[88:103], v[68:71], v[52:55], v[88:103]
    s_waitcnt vmcnt(6)
    ds_write_b128 v15, a[80:83] offset:24576
    ds_write_b128 v5, a[84:87] offset:24576
    v_exp_f32 v18, v18
    v_exp_f32 v19, v19
    v_exp_f32 v20, v20
    s_waitcnt lgkmcnt(0)
    v_exp_f32 v21, v21
    v_mfma_f32_32x32x16_bf16 v[32:47], v[108:111], v[104:107], v[72:87]
    v_exp_f32 v22, v22
    ds_read_b128 v[108:111], v112 offset:6144
    v_exp_f32 v23, v23
    ds_read_b128 v[64:67], v113 offset:5120
    v_cvt_pk_bf16_f32 v48, v16, v17
    v_cvt_pk_bf16_f32 v49, v18, v19
    v_cvt_pk_bf16_f32 v50, v20, v21
    v_cvt_pk_bf16_f32 v51, v22, v23
    v_exp_f32 v24, v24
    ds_read_b128 v[68:71], v113 offset:5632
    v_exp_f32 v25, v25
    v_mfma_f32_32x32x16_bf16 v[88:103], v[56:59], v[48:51], v[88:103]
    v_exp_f32 v26, v26
    v_exp_f32 v27, v27
    v_exp_f32 v28, v28
    v_exp_f32 v29, v29
    v_exp_f32 v30, v30
    v_exp_f32 v31, v31
    v_cvt_pk_bf16_f32 v52, v24, v25
    v_cvt_pk_bf16_f32 v53, v26, v27
    v_cvt_pk_bf16_f32 v54, v28, v29
    v_cvt_pk_bf16_f32 v55, v30, v31
    s_setprio 0
    v_exp_f32 v32, v32
    v_exp_f32 v33, v33
    v_mfma_f32_32x32x16_bf16 v[88:103], v[60:63], v[52:55], v[88:103]
    s_waitcnt vmcnt(4)
    ds_write_b128 v15, a[88:91] offset:32768
    ds_write_b128 v5, a[92:95] offset:32768
    v_exp_f32 v34, v34
    v_exp_f32 v35, v35
    v_exp_f32 v36, v36
    s_waitcnt lgkmcnt(0)
    v_exp_f32 v37, v37
    v_mfma_f32_32x32x16_bf16 v[16:31], v[108:111], v[104:107], v[72:87]
    v_exp_f32 v38, v38
    ds_read_b128 v[108:111], v112 offset:7168
    v_exp_f32 v39, v39
    ds_read_b128 v[56:59], v113 offset:6144
    v_cvt_pk_bf16_f32 v48, v32, v33
    v_cvt_pk_bf16_f32 v49, v34, v35
    v_cvt_pk_bf16_f32 v50, v36, v37
    v_cvt_pk_bf16_f32 v51, v38, v39
    v_exp_f32 v40, v40
    ds_read_b128 v[60:63], v113 offset:6656
    v_exp_f32 v41, v41
    v_mfma_f32_32x32x16_bf16 v[88:103], v[64:67], v[48:51], v[88:103]
    v_exp_f32 v42, v42
    v_exp_f32 v43, v43
    v_exp_f32 v44, v44
    v_exp_f32 v45, v45
    v_exp_f32 v46, v46
    v_exp_f32 v47, v47
    v_cvt_pk_bf16_f32 v52, v40, v41
    v_cvt_pk_bf16_f32 v53, v42, v43
    v_cvt_pk_bf16_f32 v54, v44, v45
    v_cvt_pk_bf16_f32 v55, v46, v47
    s_setprio 3
    v_exp_f32 v16, v16
    v_exp_f32 v17, v17
    v_mfma_f32_32x32x16_bf16 v[88:103], v[68:71], v[52:55], v[88:103]
    s_waitcnt lgkmcnt(0)
    s_barrier
    v_exp_f32 v18, v18
    v_exp_f32 v19, v19
    v_exp_f32 v20, v20
    s_waitcnt lgkmcnt(0)
    v_exp_f32 v21, v21
    v_mfma_f32_32x32x16_bf16 v[32:47], v[108:111], v[104:107], v[72:87]
    v_exp_f32 v22, v22
    ds_read_b128 v[108:111], v112 offset:8192
    v_exp_f32 v23, v23
    ds_read_b128 v[64:67], v113 offset:7168
    v_cvt_pk_bf16_f32 v48, v16, v17
    v_cvt_pk_bf16_f32 v49, v18, v19
    v_cvt_pk_bf16_f32 v50, v20, v21
    v_cvt_pk_bf16_f32 v51, v22, v23
    v_exp_f32 v24, v24
    ds_read_b128 v[68:71], v113 offset:7680
    v_exp_f32 v25, v25
    v_mfma_f32_32x32x16_bf16 v[88:103], v[56:59], v[48:51], v[88:103]
    v_exp_f32 v26, v26
    v_exp_f32 v27, v27
    v_exp_f32 v28, v28
    v_exp_f32 v29, v29
    v_exp_f32 v30, v30
    v_exp_f32 v31, v31
    v_cvt_pk_bf16_f32 v52, v24, v25
    v_cvt_pk_bf16_f32 v53, v26, v27
    v_cvt_pk_bf16_f32 v54, v28, v29
    v_cvt_pk_bf16_f32 v55, v30, v31
    v_exp_f32 v32, v32
    v_exp_f32 v33, v33
    v_mfma_f32_32x32x16_bf16 v[88:103], v[60:63], v[52:55], v[88:103]
    s_mov_b64 exec, 0xff
    global_load_dword v14, v8, s[10:11] sc0 sc1
    s_mov_b64 exec, -1
    v_exp_f32 v34, v34
    v_exp_f32 v35, v35
    v_exp_f32 v36, v36
    s_waitcnt lgkmcnt(0)
    v_exp_f32 v37, v37
    v_mfma_f32_32x32x16_bf16 v[16:31], v[108:111], v[104:107], v[72:87]
    v_exp_f32 v38, v38
    ds_read_b128 v[108:111], v112 offset:9216
    v_exp_f32 v39, v39
    ds_read_b128 v[56:59], v113 offset:8192
    v_cvt_pk_bf16_f32 v48, v32, v33
    v_cvt_pk_bf16_f32 v49, v34, v35
    v_cvt_pk_bf16_f32 v50, v36, v37
    v_cvt_pk_bf16_f32 v51, v38, v39
    v_exp_f32 v40, v40
    ds_read_b128 v[60:63], v113 offset:8704
    v_exp_f32 v41, v41
    v_mfma_f32_32x32x16_bf16 v[88:103], v[64:67], v[48:51], v[88:103]
    v_exp_f32 v42, v42
    v_exp_f32 v43, v43
    v_exp_f32 v44, v44
    v_exp_f32 v45, v45
    v_exp_f32 v46, v46
    v_exp_f32 v47, v47
    v_cvt_pk_bf16_f32 v52, v40, v41
    v_cvt_pk_bf16_f32 v53, v42, v43
    v_cvt_pk_bf16_f32 v54, v44, v45
    v_cvt_pk_bf16_f32 v55, v46, v47
    v_add_u32 v112, 0x2000, v112
    v_add_u32 v113, v114, v113
    v_exp_f32 v16, v16
    v_exp_f32 v17, v17
    v_mfma_f32_32x32x16_bf16 v[88:103], v[68:71], v[52:55], v[88:103]
    s_lshr_b32 s45, s38, 8
    s_sub_u32 s45, s45, s23
    s_and_b32 s45, s45, 7
    s_cmp_eq_u32 s45, 0
    s_cselect_b32 s44, 7, s45
    s_mov_b64 exec, 0xff
    s_mov_b32 s29, 65536
    s_branch L_l1_pk7_w
L_l1_pk7:
L_l1_pk7_l:
    global_load_dword v14, v8, s[10:11] sc0 sc1
L_l1_pk7_w:
    s_waitcnt vmcnt(0)
    v_cmp_ne_u32 vcc, s31, v14
    s_sub_u32 s29, s29, 1
    s_cbranch_vccz L_l1_pk7_ok
    s_cbranch_scc0 L_l1_pk7
L_l1_pk7_ok:
    s_mov_b64 exec, -1
    s_add_u32 s44, s23, s44
    s_and_b32 s44, s44, 7
    s_sub_u32 s44, s44, s23
    s_lshl_b32 s44, s44, 13
    v_add_u32 v13, s44, v4
    global_load_dwordx4 a[64:67], v13, s[52:53] sc1
    global_load_dwordx4 a[68:71], v13, s[54:55] sc1
    v_exp_f32 v18, v18
    v_exp_f32 v19, v19
    v_exp_f32 v20, v20
    s_waitcnt lgkmcnt(0)
    v_exp_f32 v21, v21
    v_mfma_f32_32x32x16_bf16 v[32:47], v[108:111], v[104:107], v[72:87]
    v_exp_f32 v22, v22
    ds_read_b128 v[108:111], v112 offset:2048
    v_exp_f32 v23, v23
    ds_read_b128 v[64:67], v113 offset:1024
    v_cvt_pk_bf16_f32 v48, v16, v17
    v_cvt_pk_bf16_f32 v49, v18, v19
    v_cvt_pk_bf16_f32 v50, v20, v21
    v_cvt_pk_bf16_f32 v51, v22, v23
    v_exp_f32 v24, v24
    ds_read_b128 v[68:71], v113 offset:1536
    v_exp_f32 v25, v25
    v_mfma_f32_32x32x16_bf16 v[88:103], v[56:59], v[48:51], v[88:103]
    v_exp_f32 v26, v26
    v_exp_f32 v27, v27
    v_exp_f32 v28, v28
    v_exp_f32 v29, v29
    v_exp_f32 v30, v30
    v_exp_f32 v31, v31
    v_cvt_pk_bf16_f32 v52, v24, v25
    v_cvt_pk_bf16_f32 v53, v26, v27
    v_cvt_pk_bf16_f32 v54, v28, v29
    v_cvt_pk_bf16_f32 v55, v30, v31
    v_exp_f32 v32, v32
    v_exp_f32 v33, v33
    v_mfma_f32_32x32x16_bf16 v[88:103], v[60:63], v[52:55], v[88:103]
    v_exp_f32 v34, v34
    v_exp_f32 v35, v35
    v_exp_f32 v36, v36
    s_waitcnt lgkmcnt(0)
    v_exp_f32 v37, v37
    v_mfma_f32_32x32x16_bf16 v[16:31], v[108:111], v[104:107], v[72:87]
    v_exp_f32 v38, v38
    ds_read_b128 v[108:111], v112 offset:3072
    v_exp_f32 v39, v39
    ds_read_b128 v[56:59], v113 offset:2048
    v_cvt_pk_bf16_f32 v48, v32, v33
    v_cvt_pk_bf16_f32 v49, v34, v35
    v_cvt_pk_bf16_f32 v50, v36, v37
    v_cvt_pk_bf16_f32 v51, v38, v39
    v_exp_f32 v40, v40
    ds_read_b128 v[60:63], v113 offset:2560
    v_exp_f32 v41, v41
    v_mfma_f32_32x32x16_bf16 v[88:103], v[64:67], v[48:51], v[88:103]
    v_exp_f32 v42, v42
    v_exp_f32 v43, v43
    v_exp_f32 v44, v44
    v_exp_f32 v45, v45
    v_exp_f32 v46, v46
    v_exp_f32 v47, v47
    v_cvt_pk_bf16_f32 v52, v40, v41
    v_cvt_pk_bf16_f32 v53, v42, v43
    v_cvt_pk_bf16_f32 v54, v44, v45
    v_cvt_pk_bf16_f32 v55, v46, v47
    v_exp_f32 v16, v16
    v_exp_f32 v17, v17
    v_mfma_f32_32x32x16_bf16 v[88:103], v[68:71], v[52:55], v[88:103]
    v_exp_f32 v18, v18
    v_exp_f32 v19, v19
    v_exp_f32 v20, v20
    s_waitcnt lgkmcnt(0)
    v_exp_f32 v21, v21
    v_mfma_f32_32x32x16_bf16 v[32:47], v[108:111], v[104:107], v[72:87]
    v_exp_f32 v22, v22
    ds_read_b128 v[108:111], v112 offset:4096
    v_exp_f32 v23, v23
    ds_read_b128 v[64:67], v113 offset:3072
    v_cvt_pk_bf16_f32 v48, v16, v17
    v_cvt_pk_bf16_f32 v49, v18, v19
    v_cvt_pk_bf16_f32 v50, v20, v21
    v_cvt_pk_bf16_f32 v51, v22, v23
    v_exp_f32 v24, v24
    ds_read_b128 v[68:71], v113 offset:3584
    v_exp_f32 v25, v25
    v_mfma_f32_32x32x16_bf16 v[88:103], v[56:59], v[48:51], v[88:103]
    v_exp_f32 v26, v26
    v_exp_f32 v27, v27
    v_exp_f32 v28, v28
    v_exp_f32 v29, v29
    v_exp_f32 v30, v30
    v_exp_f32 v31, v31
    v_cvt_pk_bf16_f32 v52, v24, v25
    v_cvt_pk_bf16_f32 v53, v26, v27
    v_cvt_pk_bf16_f32 v54, v28, v29
    v_cvt_pk_bf16_f32 v55, v30, v31
    v_exp_f32 v32, v32
    v_exp_f32 v33, v33
    v_mfma_f32_32x32x16_bf16 v[88:103], v[60:63], v[52:55], v[88:103]
    v_exp_f32 v34, v34
    v_exp_f32 v35, v35
    v_exp_f32 v36, v36
    s_waitcnt lgkmcnt(0)
    v_exp_f32 v37, v37
    v_mfma_f32_32x32x16_bf16 v[16:31], v[108:111], v[104:107], v[72:87]
    v_exp_f32 v38, v38
    ds_read_b128 v[108:111], v112 offset:5120
    v_exp_f32 v39, v39
    ds_read_b128 v[56:59], v113 offset:4096
    v_cvt_pk_bf16_f32 v48, v32, v33
    v_cvt_pk_bf16_f32 v49, v34, v35
    v_cvt_pk_bf16_f32 v50, v36, v37
    v_cvt_pk_bf16_f32 v51, v38, v39
    v_exp_f32 v40, v40
    ds_read_b128 v[60:63], v113 offset:4608
    v_exp_f32 v41, v41
    v_mfma_f32_32x32x16_bf16 v[88:103], v[64:67], v[48:51], v[88:103]
    v_exp_f32 v42, v42
    v_exp_f32 v43, v43
    v_exp_f32 v44, v44
    v_exp_f32 v45, v45
    v_exp_f32 v46, v46
    v_exp_f32 v47, v47
    v_cvt_pk_bf16_f32 v52, v40, v41
    v_cvt_pk_bf16_f32 v53, v42, v43
    v_cvt_pk_bf16_f32 v54, v44, v45
    v_cvt_pk_bf16_f32 v55, v46, v47
    v_exp_f32 v16, v16
    v_exp_f32 v17, v17
    v_mfma_f32_32x32x16_bf16 v[88:103], v[68:71], v[52:55], v[88:103]
    v_exp_f32 v18, v18
    v_exp_f32 v19, v19
    v_exp_f32 v20, v20
    s_waitcnt lgkmcnt(0)
    v_exp_f32 v21, v21
    v_mfma_f32_32x32x16_bf16 v[32:47], v[108:111], v[104:107], v[72:87]
    v_exp_f32 v22, v22
    ds_read_b128 v[108:111], v112 offset:6144
    v_exp_f32 v23, v23
    ds_read_b128 v[64:67], v113 offset:5120
    v_cvt_pk_bf16_f32 v48, v16, v17
    v_cvt_pk_bf16_f32 v49, v18, v19
    v_cvt_pk_bf16_f32 v50, v20, v21
    v_cvt_pk_bf16_f32 v51, v22, v23
    v_exp_f32 v24, v24
    ds_read_b128 v[68:71], v113 offset:5632
    v_exp_f32 v25, v25
    v_mfma_f32_32x32x16_bf16 v[88:103], v[56:59], v[48:51], v[88:103]
    v_exp_f32 v26, v26
    v_exp_f32 v27, v27
    v_exp_f32 v28, v28
    v_exp_f32 v29, v29
    v_exp_f32 v30, v30
    v_exp_f32 v31, v31
    v_cvt_pk_bf16_f32 v52, v24, v25
    v_cvt_pk_bf16_f32 v53, v26, v27
    v_cvt_pk_bf16_f32 v54, v28, v29
    v_cvt_pk_bf16_f32 v55, v30, v31
    v_exp_f32 v32, v32
    v_exp_f32 v33, v33
    v_mfma_f32_32x32x16_bf16 v[88:103], v[60:63], v[52:55], v[88:103]
    v_exp_f32 v34, v34
    v_exp_f32 v35, v35
    v_exp_f32 v36, v36
    s_waitcnt lgkmcnt(0)
    v_exp_f32 v37, v37
    v_mfma_f32_32x32x16_bf16 v[16:31], v[108:111], v[104:107], v[72:87]
    v_exp_f32 v38, v38
    ds_read_b128 v[108:111], v112 offset:7168
    v_exp_f32 v39, v39
    ds_read_b128 v[56:59], v113 offset:6144
    v_cvt_pk_bf16_f32 v48, v32, v33
    v_cvt_pk_bf16_f32 v49, v34, v35
    v_cvt_pk_bf16_f32 v50, v36, v37
    v_cvt_pk_bf16_f32 v51, v38, v39
    v_exp_f32 v40, v40
    ds_read_b128 v[60:63], v113 offset:6656
    v_exp_f32 v41, v41
    v_mfma_f32_32x32x16_bf16 v[88:103], v[64:67], v[48:51], v[88:103]
    v_exp_f32 v42, v42
    v_exp_f32 v43, v43
    v_exp_f32 v44, v44
    v_exp_f32 v45, v45
    v_exp_f32 v46, v46
    v_exp_f32 v47, v47
    v_cvt_pk_bf16_f32 v52, v40, v41
    v_cvt_pk_bf16_f32 v53, v42, v43
    v_cvt_pk_bf16_f32 v54, v44, v45
    v_cvt_pk_bf16_f32 v55, v46, v47
    s_setprio 2
    v_exp_f32 v16, v16
    v_exp_f32 v17, v17
    v_mfma_f32_32x32x16_bf16 v[88:103], v[68:71], v[52:55], v[88:103]
    v_exp_f32 v18, v18
    v_exp_f32 v19, v19
    v_exp_f32 v20, v20
    s_waitcnt lgkmcnt(0)
    v_exp_f32 v21, v21
    v_mfma_f32_32x32x16_bf16 v[32:47], v[108:111], v[104:107], v[72:87]
    v_exp_f32 v22, v22
    ds_read_b128 v[108:111], v112 offset:8192
    v_exp_f32 v23, v23
    ds_read_b128 v[64:67], v113 offset:7168
    v_cvt_pk_bf16_f32 v48, v16, v17
    v_cvt_pk_bf16_f32 v49, v18, v19
    v_cvt_pk_bf16_f32 v50, v20, v21
    v_cvt_pk_bf16_f32 v51, v22, v23
    v_exp_f32 v24, v24
    ds_read_b128 v[68:71], v113 offset:7680
    v_exp_f32 v25, v25
    v_mfma_f32_32x32x16_bf16 v[88:103], v[56:59], v[48:51], v[88:103]
    v_exp_f32 v26, v26
    v_exp_f32 v27, v27
    v_exp_f32 v28, v28
    v_exp_f32 v29, v29
    v_exp_f32 v30, v30
    v_exp_f32 v31, v31
    v_cvt_pk_bf16_f32 v52, v24, v25
    v_cvt_pk_bf16_f32 v53, v26, v27
    v_cvt_pk_bf16_f32 v54, v28, v29
    v_cvt_pk_bf16_f32 v55, v30, v31
    v_exp_f32 v32, v32
    v_exp_f32 v33, v33
    v_mfma_f32_32x32x16_bf16 v[88:103], v[60:63], v[52:55], v[88:103]
    v_exp_f32 v34, v34
    v_exp_f32 v35, v35
    v_exp_f32 v36, v36
    s_waitcnt lgkmcnt(0)
    v_exp_f32 v37, v37
    v_mfma_f32_32x32x16_bf16 v[16:31], v[108:111], v[104:107], v[72:87]
    v_exp_f32 v38, v38
    ds_read_b128 v[108:111], v112 offset:9216
    v_exp_f32 v39, v39
    ds_read_b128 v[56:59], v113 offset:8192
    v_cvt_pk_bf16_f32 v48, v32, v33
    v_cvt_pk_bf16_f32 v49, v34, v35
    v_cvt_pk_bf16_f32 v50, v36, v37
    v_cvt_pk_bf16_f32 v51, v38, v39
    v_exp_f32 v40, v40
    ds_read_b128 v[60:63], v113 offset:8704
    v_exp_f32 v41, v41
    v_mfma_f32_32x32x16_bf16 v[88:103], v[64:67], v[48:51], v[88:103]
    v_exp_f32 v42, v42
    v_exp_f32 v43, v43
    v_exp_f32 v44, v44
    v_exp_f32 v45, v45
    v_exp_f32 v46, v46
    v_exp_f32 v47, v47
    v_cvt_pk_bf16_f32 v52, v40, v41
    v_cvt_pk_bf16_f32 v53, v42, v43
    v_cvt_pk_bf16_f32 v54, v44, v45
    v_cvt_pk_bf16_f32 v55, v46, v47
    v_add_u32 v112, 0x2000, v112
    v_add_u32 v113, v114, v113
    v_exp_f32 v16, v16
    v_exp_f32 v17, v17
    v_mfma_f32_32x32x16_bf16 v[88:103], v[68:71], v[52:55], v[88:103]
    ds_write_b128 v15, a[96:99] offset:40960
    ds_write_b128 v5, a[100:103] offset:40960
    v_exp_f32 v18, v18
    v_exp_f32 v19, v19
    v_exp_f32 v20, v20
    s_waitcnt lgkmcnt(0)
    v_exp_f32 v21, v21
    v_mfma_f32_32x32x16_bf16 v[32:47], v[108:111], v[104:107], v[72:87]
    v_exp_f32 v22, v22
    ds_read_b128 v[108:111], v112 offset:2048
    v_exp_f32 v23, v23
    ds_read_b128 v[64:67], v113 offset:1024
    v_cvt_pk_bf16_f32 v48, v16, v17
    v_cvt_pk_bf16_f32 v49, v18, v19
    v_cvt_pk_bf16_f32 v50, v20, v21
    v_cvt_pk_bf16_f32 v51, v22, v23
    v_exp_f32 v24, v24
    ds_read_b128 v[68:71], v113 offset:1536
    v_exp_f32 v25, v25
    v_mfma_f32_32x32x16_bf16 v[88:103], v[56:59], v[48:51], v[88:103]
    v_exp_f32 v26, v26
    v_exp_f32 v27, v27
    v_exp_f32 v28, v28
    v_exp_f32 v29, v29
    v_exp_f32 v30, v30
    v_exp_f32 v31, v31
    v_cvt_pk_bf16_f32 v52, v24, v25
    v_cvt_pk_bf16_f32 v53, v26, v27
    v_cvt_pk_bf16_f32 v54, v28, v29
    v_cvt_pk_bf16_f32 v55, v30, v31
    v_exp_f32 v32, v32
    v_exp_f32 v33, v33
    v_mfma_f32_32x32x16_bf16 v[88:103], v[60:63], v[52:55], v[88:103]
    ds_write_b128 v15, a[104:107] offset:49152
    ds_write_b128 v5, a[108:111] offset:49152
    v_exp_f32 v34, v34
    v_exp_f32 v35, v35
    v_exp_f32 v36, v36
    s_waitcnt lgkmcnt(0)
    v_exp_f32 v37, v37
    v_mfma_f32_32x32x16_bf16 v[16:31], v[108:111], v[104:107], v[72:87]
    v_exp_f32 v38, v38
    ds_read_b128 v[108:111], v112 offset:3072
    v_exp_f32 v39, v39
    ds_read_b128 v[56:59], v113 offset:2048
    v_cvt_pk_bf16_f32 v48, v32, v33
    v_cvt_pk_bf16_f32 v49, v34, v35
    v_cvt_pk_bf16_f32 v50, v36, v37
    v_cvt_pk_bf16_f32 v51, v38, v39
    v_exp_f32 v40, v40
    ds_read_b128 v[60:63], v113 offset:2560
    v_exp_f32 v41, v41
    v_mfma_f32_32x32x16_bf16 v[88:103], v[64:67], v[48:51], v[88:103]
    v_exp_f32 v42, v42
    v_exp_f32 v43, v43
    v_exp_f32 v44, v44
    v_exp_f32 v45, v45
    v_exp_f32 v46, v46
    v_exp_f32 v47, v47
    v_cvt_pk_bf16_f32 v52, v40, v41
    v_cvt_pk_bf16_f32 v53, v42, v43
    v_cvt_pk_bf16_f32 v54, v44, v45
    v_cvt_pk_bf16_f32 v55, v46, v47
    s_setprio 1
    v_exp_f32 v16, v16
    v_exp_f32 v17, v17
    v_mfma_f32_32x32x16_bf16 v[88:103], v[68:71], v[52:55], v[88:103]
    s_waitcnt vmcnt(0)
    ds_write_b128 v15, a[64:67] offset:57344
    ds_write_b128 v5, a[68:71] offset:57344
    v_exp_f32 v18, v18
    v_exp_f32 v19, v19
    v_exp_f32 v20, v20
    s_waitcnt lgkmcnt(0)
    v_exp_f32 v21, v21
    v_mfma_f32_32x32x16_bf16 v[32:47], v[108:111], v[104:107], v[72:87]
    v_exp_f32 v22, v22
    ds_read_b128 v[108:111], v112 offset:4096
    v_exp_f32 v23, v23
    ds_read_b128 v[64:67], v113 offset:3072
    v_cvt_pk_bf16_f32 v48, v16, v17
    v_cvt_pk_bf16_f32 v49, v18, v19
    v_cvt_pk_bf16_f32 v50, v20, v21
    v_cvt_pk_bf16_f32 v51, v22, v23
    v_exp_f32 v24, v24
    ds_read_b128 v[68:71], v113 offset:3584
    v_exp_f32 v25, v25
    v_mfma_f32_32x32x16_bf16 v[88:103], v[56:59], v[48:51], v[88:103]
    v_exp_f32 v26, v26
    v_exp_f32 v27, v27
    v_exp_f32 v28, v28
    v_exp_f32 v29, v29
    v_exp_f32 v30, v30
    v_exp_f32 v31, v31
    v_cvt_pk_bf16_f32 v52, v24, v25
    v_cvt_pk_bf16_f32 v53, v26, v27
    v_cvt_pk_bf16_f32 v54, v28, v29
    v_cvt_pk_bf16_f32 v55, v30, v31
    v_exp_f32 v32, v32
    v_exp_f32 v33, v33
    v_mfma_f32_32x32x16_bf16 v[88:103], v[60:63], v[52:55], v[88:103]
    v_exp_f32 v34, v34
    v_exp_f32 v35, v35
    v_exp_f32 v36, v36
    s_waitcnt lgkmcnt(0)
    v_exp_f32 v37, v37
    v_mfma_f32_32x32x16_bf16 v[16:31], v[108:111], v[104:107], v[72:87]
    v_exp_f32 v38, v38
    ds_read_b128 v[108:111], v112 offset:5120
    v_exp_f32 v39, v39
    ds_read_b128 v[56:59], v113 offset:4096
    v_cvt_pk_bf16_f32 v48, v32, v33
    v_cvt_pk_bf16_f32 v49, v34, v35
    v_cvt_pk_bf16_f32 v50, v36, v37
    v_cvt_pk_bf16_f32 v51, v38, v39
    v_exp_f32 v40, v40
    ds_read_b128 v[60:63], v113 offset:4608
    v_exp_f32 v41, v41
    v_mfma_f32_32x32x16_bf16 v[88:103], v[64:67], v[48:51], v[88:103]
    v_exp_f32 v42, v42
    v_exp_f32 v43, v43
    v_exp_f32 v44, v44
    v_exp_f32 v45, v45
    v_exp_f32 v46, v46
    v_exp_f32 v47, v47
    v_cvt_pk_bf16_f32 v52, v40, v41
    v_cvt_pk_bf16_f32 v53, v42, v43
    v_cvt_pk_bf16_f32 v54, v44, v45
    v_cvt_pk_bf16_f32 v55, v46, v47
    s_setprio 0
    v_exp_f32 v16, v16
    v_exp_f32 v17, v17
    v_mfma_f32_32x32x16_bf16 v[88:103], v[68:71], v[52:55], v[88:103]
    v_exp_f32 v18, v18
    v_exp_f32 v19, v19
    v_exp_f32 v20, v20
    s_waitcnt lgkmcnt(0)
    v_exp_f32 v21, v21
    v_mfma_f32_32x32x16_bf16 v[32:47], v[108:111], v[104:107], v[72:87]
    v_exp_f32 v22, v22
    ds_read_b128 v[108:111], v112 offset:6144
    v_exp_f32 v23, v23
    ds_read_b128 v[64:67], v113 offset:5120
    v_cvt_pk_bf16_f32 v48, v16, v17
    v_cvt_pk_bf16_f32 v49, v18, v19
    v_cvt_pk_bf16_f32 v50, v20, v21
    v_cvt_pk_bf16_f32 v51, v22, v23
    v_exp_f32 v24, v24
    ds_read_b128 v[68:71], v113 offset:5632
    v_exp_f32 v25, v25
    v_mfma_f32_32x32x16_bf16 v[88:103], v[56:59], v[48:51], v[88:103]
    v_exp_f32 v26, v26
    v_exp_f32 v27, v27
    v_exp_f32 v28, v28
    v_exp_f32 v29, v29
    v_exp_f32 v30, v30
    v_exp_f32 v31, v31
    v_cvt_pk_bf16_f32 v52, v24, v25
    v_cvt_pk_bf16_f32 v53, v26, v27
    v_cvt_pk_bf16_f32 v54, v28, v29
    v_cvt_pk_bf16_f32 v55, v30, v31
    v_exp_f32 v32, v32
    v_exp_f32 v33, v33
    v_mfma_f32_32x32x16_bf16 v[88:103], v[60:63], v[52:55], v[88:103]
    v_exp_f32 v34, v34
    v_exp_f32 v35, v35
    v_exp_f32 v36, v36
    s_waitcnt lgkmcnt(0)
    v_exp_f32 v37, v37
    v_mfma_f32_32x32x16_bf16 v[16:31], v[108:111], v[104:107], v[72:87]
    v_exp_f32 v38, v38
    ds_read_b128 v[108:111], v112 offset:7168
    v_exp_f32 v39, v39
    ds_read_b128 v[56:59], v113 offset:6144
    v_cvt_pk_bf16_f32 v48, v32, v33
    v_cvt_pk_bf16_f32 v49, v34, v35
    v_cvt_pk_bf16_f32 v50, v36, v37
    v_cvt_pk_bf16_f32 v51, v38, v39
    v_exp_f32 v40, v40
    ds_read_b128 v[60:63], v113 offset:6656
    v_exp_f32 v41, v41
    v_mfma_f32_32x32x16_bf16 v[88:103], v[64:67], v[48:51], v[88:103]
    v_exp_f32 v42, v42
    v_exp_f32 v43, v43
    v_exp_f32 v44, v44
    v_exp_f32 v45, v45
    v_exp_f32 v46, v46
    v_exp_f32 v47, v47
    v_cvt_pk_bf16_f32 v52, v40, v41
    v_cvt_pk_bf16_f32 v53, v42, v43
    v_cvt_pk_bf16_f32 v54, v44, v45
    v_cvt_pk_bf16_f32 v55, v46, v47
    s_setprio 3
    v_exp_f32 v16, v16
    v_exp_f32 v17, v17
    v_mfma_f32_32x32x16_bf16 v[88:103], v[68:71], v[52:55], v[88:103]
    s_waitcnt lgkmcnt(0)
    s_barrier
    v_exp_f32 v18, v18
    v_exp_f32 v19, v19
    v_exp_f32 v20, v20
    s_waitcnt lgkmcnt(0)
    v_exp_f32 v21, v21
    v_mfma_f32_32x32x16_bf16 v[32:47], v[108:111], v[104:107], v[72:87]
    v_exp_f32 v22, v22
    ds_read_b128 v[108:111], v112 offset:8192
    v_exp_f32 v23, v23
    ds_read_b128 v[64:67], v113 offset:7168
    v_cvt_pk_bf16_f32 v48, v16, v17
    v_cvt_pk_bf16_f32 v49, v18, v19
    v_cvt_pk_bf16_f32 v50, v20, v21
    v_cvt_pk_bf16_f32 v51, v22, v23
    v_exp_f32 v24, v24
    ds_read_b128 v[68:71], v113 offset:7680
    v_exp_f32 v25, v25
    v_mfma_f32_32x32x16_bf16 v[88:103], v[56:59], v[48:51], v[88:103]
    v_exp_f32 v26, v26
    v_exp_f32 v27, v27
    v_exp_f32 v28, v28
    v_exp_f32 v29, v29
    v_exp_f32 v30, v30
    v_exp_f32 v31, v31
    v_cvt_pk_bf16_f32 v52, v24, v25
    v_cvt_pk_bf16_f32 v53, v26, v27
    v_cvt_pk_bf16_f32 v54, v28, v29
    v_cvt_pk_bf16_f32 v55, v30, v31
    v_exp_f32 v32, v32
    v_exp_f32 v33, v33
    v_mfma_f32_32x32x16_bf16 v[88:103], v[60:63], v[52:55], v[88:103]
    v_exp_f32 v34, v34
    v_exp_f32 v35, v35
    v_exp_f32 v36, v36
    s_waitcnt lgkmcnt(0)
    v_exp_f32 v37, v37
    v_mfma_f32_32x32x16_bf16 v[16:31], v[108:111], v[104:107], v[72:87]
    v_exp_f32 v38, v38
    ds_read_b128 v[108:111], v112 offset:9216
    v_exp_f32 v39, v39
    ds_read_b128 v[56:59], v113 offset:8192
    v_cvt_pk_bf16_f32 v48, v32, v33
    v_cvt_pk_bf16_f32 v49, v34, v35
    v_cvt_pk_bf16_f32 v50, v36, v37
    v_cvt_pk_bf16_f32 v51, v38, v39
    v_exp_f32 v40, v40
    ds_read_b128 v[60:63], v113 offset:8704
    v_exp_f32 v41, v41
    v_mfma_f32_32x32x16_bf16 v[88:103], v[64:67], v[48:51], v[88:103]
    v_exp_f32 v42, v42
    v_exp_f32 v43, v43
    v_exp_f32 v44, v44
    v_exp_f32 v45, v45
    v_exp_f32 v46, v46
    v_exp_f32 v47, v47
    v_cvt_pk_bf16_f32 v52, v40, v41
    v_cvt_pk_bf16_f32 v53, v42, v43
    v_cvt_pk_bf16_f32 v54, v44, v45
    v_cvt_pk_bf16_f32 v55, v46, v47
    v_add_u32 v112, 0x2000, v112
    v_add_u32 v113, v114, v113
    s_mov_b32 s28, 5
.p2align 6
L_l1_loop:
    s_cmp_lt_u32 s28, 6
    s_cbranch_scc1 L_l1_pd
    s_setprio 2
    s_cmp_lt_u32 s28, 7
    s_cbranch_scc1 L_l1_pd
    s_setprio 1
L_l1_pd:
    v_exp_f32 v16, v16
    v_exp_f32 v17, v17
    v_mfma_f32_32x32x16_bf16 v[88:103], v[68:71], v[52:55], v[88:103]
    v_exp_f32 v18, v18
    v_exp_f32 v19, v19
    v_exp_f32 v20, v20
    s_waitcnt lgkmcnt(0)
    v_exp_f32 v21, v21
    v_mfma_f32_32x32x16_bf16 v[32:47], v[108:111], v[104:107], v[72:87]
    v_exp_f32 v22, v22
    ds_read_b128 v[108:111], v112 offset:2048
    v_exp_f32 v23, v23
    ds_read_b128 v[64:67], v113 offset:1024
    v_cvt_pk_bf16_f32 v48, v16, v17
    v_cvt_pk_bf16_f32 v49, v18, v19
    v_cvt_pk_bf16_f32 v50, v20, v21
    v_cvt_pk_bf16_f32 v51, v22, v23
    v_exp_f32 v24, v24
    ds_read_b128 v[68:71], v113 offset:1536
    v_exp_f32 v25, v25
    v_mfma_f32_32x32x16_bf16 v[88:103], v[56:59], v[48:51], v[88:103]
    v_exp_f32 v26, v26
    v_exp_f32 v27, v27
    v_exp_f32 v28, v28
    v_exp_f32 v29, v29
    v_exp_f32 v30, v30
    v_exp_f32 v31, v31
    v_cvt_pk_bf16_f32 v52, v24, v25
    v_cvt_pk_bf16_f32 v53, v26, v27
    v_cvt_pk_bf16_f32 v54, v28, v29
    v_cvt_pk_bf16_f32 v55, v30, v31
    v_exp_f32 v32, v32
    v_exp_f32 v33, v33
    v_mfma_f32_32x32x16_bf16 v[88:103], v[60:63], v[52:55], v[88:103]
    v_exp_f32 v34, v34
    v_exp_f32 v35, v35
    v_exp_f32 v36, v36
    s_waitcnt lgkmcnt(0)
    v_exp_f32 v37, v37
    v_mfma_f32_32x32x16_bf16 v[16:31], v[108:111], v[104:107], v[72:87]
    v_exp_f32 v38, v38
    ds_read_b128 v[108:111], v112 offset:3072
    v_exp_f32 v39, v39
    ds_read_b128 v[56:59], v113 offset:2048
    v_cvt_pk_bf16_f32 v48, v32, v33
    v_cvt_pk_bf16_f32 v49, v34, v35
    v_cvt_pk_bf16_f32 v50, v36, v37
    v_cvt_pk_bf16_f32 v51, v38, v39
    v_exp_f32 v40, v40
    ds_read_b128 v[60:63], v113 offset:2560
    v_exp_f32 v41, v41
    v_mfma_f32_32x32x16_bf16 v[88:103], v[64:67], v[48:51], v[88:103]
    v_exp_f32 v42, v42
    v_exp_f32 v43, v43
    v_exp_f32 v44, v44
    v_exp_f32 v45, v45
    v_exp_f32 v46, v46
    v_exp_f32 v47, v47
    v_cvt_pk_bf16_f32 v52, v40, v41
    v_cvt_pk_bf16_f32 v53, v42, v43
    v_cvt_pk_bf16_f32 v54, v44, v45
    v_cvt_pk_bf16_f32 v55, v46, v47
    v_exp_f32 v16, v16
    v_exp_f32 v17, v17
    v_mfma_f32_32x32x16_bf16 v[88:103], v[68:71], v[52:55], v[88:103]
    v_exp_f32 v18, v18
    v_exp_f32 v19, v19
    v_exp_f32 v20, v20
    s_waitcnt lgkmcnt(0)
    v_exp_f32 v21, v21
    v_mfma_f32_32x32x16_bf16 v[32:47], v[108:111], v[104:107], v[72:87]
    v_exp_f32 v22, v22
    ds_read_b128 v[108:111], v112 offset:4096
    v_exp_f32 v23, v23
    ds_read_b128 v[64:67], v113 offset:3072
    v_cvt_pk_bf16_f32 v48, v16, v17
    v_cvt_pk_bf16_f32 v49, v18, v19
    v_cvt_pk_bf16_f32 v50, v20, v21
    v_cvt_pk_bf16_f32 v51, v22, v23
    v_exp_f32 v24, v24
    ds_read_b128 v[68:71], v113 offset:3584
    v_exp_f32 v25, v25
    v_mfma_f32_32x32x16_bf16 v[88:103], v[56:59], v[48:51], v[88:103]
    v_exp_f32 v26, v26
    v_exp_f32 v27, v27
    v_exp_f32 v28, v28
    v_exp_f32 v29, v29
    v_exp_f32 v30, v30
    v_exp_f32 v31, v31
    v_cvt_pk_bf16_f32 v52, v24, v25
    v_cvt_pk_bf16_f32 v53, v26, v27
    v_cvt_pk_bf16_f32 v54, v28, v29
    v_cvt_pk_bf16_f32 v55, v30, v31
    v_exp_f32 v32, v32
    v_exp_f32 v33, v33
    v_mfma_f32_32x32x16_bf16 v[88:103], v[60:63], v[52:55], v[88:103]
    v_exp_f32 v34, v34
    v_exp_f32 v35, v35
    v_exp_f32 v36, v36
    s_waitcnt lgkmcnt(0)
    v_exp_f32 v37, v37
    v_mfma_f32_32x32x16_bf16 v[16:31], v[108:111], v[104:107], v[72:87]
    v_exp_f32 v38, v38
    ds_read_b128 v[108:111], v112 offset:5120
    v_exp_f32 v39, v39
    ds_read_b128 v[56:59], v113 offset:4096
    v_cvt_pk_bf16_f32 v48, v32, v33
    v_cvt_pk_bf16_f32 v49, v34, v35
    v_cvt_pk_bf16_f32 v50, v36, v37
    v_cvt_pk_bf16_f32 v51, v38, v39
    v_exp_f32 v40, v40
    ds_read_b128 v[60:63], v113 offset:4608
    v_exp_f32 v41, v41
    v_mfma_f32_32x32x16_bf16 v[88:103], v[64:67], v[48:51], v[88:103]
    v_exp_f32 v42, v42
    v_exp_f32 v43, v43
    v_exp_f32 v44, v44
    v_exp_f32 v45, v45
    v_exp_f32 v46, v46
    v_exp_f32 v47, v47
    v_cvt_pk_bf16_f32 v52, v40, v41
    v_cvt_pk_bf16_f32 v53, v42, v43
    v_cvt_pk_bf16_f32 v54, v44, v45
    v_cvt_pk_bf16_f32 v55, v46, v47
    v_exp_f32 v16, v16
    v_exp_f32 v17, v17
    v_mfma_f32_32x32x16_bf16 v[88:103], v[68:71], v[52:55], v[88:103]
    v_exp_f32 v18, v18
    v_exp_f32 v19, v19
    v_exp_f32 v20, v20
    s_waitcnt lgkmcnt(0)
    v_exp_f32 v21, v21
    v_mfma_f32_32x32x16_bf16 v[32:47], v[108:111], v[104:107], v[72:87]
    v_exp_f32 v22, v22
    ds_read_b128 v[108:111], v112 offset:6144
    v_exp_f32 v23, v23
    ds_read_b128 v[64:67], v113 offset:5120
    v_cvt_pk_bf16_f32 v48, v16, v17
    v_cvt_pk_bf16_f32 v49, v18, v19
    v_cvt_pk_bf16_f32 v50, v20, v21
    v_cvt_pk_bf16_f32 v51, v22, v23
    v_exp_f32 v24, v24
    ds_read_b128 v[68:71], v113 offset:5632
    v_exp_f32 v25, v25
    v_mfma_f32_32x32x16_bf16 v[88:103], v[56:59], v[48:51], v[88:103]
    v_exp_f32 v26, v26
    v_exp_f32 v27, v27
    v_exp_f32 v28, v28
    v_exp_f32 v29, v29
    v_exp_f32 v30, v30
    v_exp_f32 v31, v31
    v_cvt_pk_bf16_f32 v52, v24, v25
    v_cvt_pk_bf16_f32 v53, v26, v27
    v_cvt_pk_bf16_f32 v54, v28, v29
    v_cvt_pk_bf16_f32 v55, v30, v31
    s_cmp_lt_u32 s28, 7
    s_cbranch_scc1 L_l1_pe
    s_setprio 0
L_l1_pe:
    v_exp_f32 v32, v32
    v_exp_f32 v33, v33
    v_mfma_f32_32x32x16_bf16 v[88:103], v[60:63], v[52:55], v[88:103]
    v_exp_f32 v34, v34
    v_exp_f32 v35, v35
    v_exp_f32 v36, v36
    s_waitcnt lgkmcnt(0)
    v_exp_f32 v37, v37
    v_mfma_f32_32x32x16_bf16 v[16:31], v[108:111], v[104:107], v[72:87]
    v_exp_f32 v38, v38
    ds_read_b128 v[108:111], v112 offset:7168
    v_exp_f32 v39, v39
    ds_read_b128 v[56:59], v113 offset:6144
    v_cvt_pk_bf16_f32 v48, v32, v33
    v_cvt_pk_bf16_f32 v49, v34, v35
    v_cvt_pk_bf16_f32 v50, v36, v37
    v_cvt_pk_bf16_f32 v51, v38, v39
    v_exp_f32 v40, v40
    ds_read_b128 v[60:63], v113 offset:6656
    v_exp_f32 v41, v41
    v_mfma_f32_32x32x16_bf16 v[88:103], v[64:67], v[48:51], v[88:103]
    v_exp_f32 v42, v42
    v_exp_f32 v43, v43
    v_exp_f32 v44, v44
    v_exp_f32 v45, v45
    v_exp_f32 v46, v46
    v_exp_f32 v47, v47
    v_cvt_pk_bf16_f32 v52, v40, v41
    v_cvt_pk_bf16_f32 v53, v42, v43
    v_cvt_pk_bf16_f32 v54, v44, v45
    v_cvt_pk_bf16_f32 v55, v46, v47
    v_exp_f32 v16, v16
    v_exp_f32 v17, v17
    v_mfma_f32_32x32x16_bf16 v[88:103], v[68:71], v[52:55], v[88:103]
    v_exp_f32 v18, v18
    v_exp_f32 v19, v19
    v_exp_f32 v20, v20
    s_waitcnt lgkmcnt(0)
    v_exp_f32 v21, v21
    v_mfma_f32_32x32x16_bf16 v[32:47], v[108:111], v[104:107], v[72:87]
    v_exp_f32 v22, v22
    ds_read_b128 v[108:111], v112 offset:8192
    v_exp_f32 v23, v23
    ds_read_b128 v[64:67], v113 offset:7168
    v_cvt_pk_bf16_f32 v48, v16, v17
    v_cvt_pk_bf16_f32 v49, v18, v19
    v_cvt_pk_bf16_f32 v50, v20, v21
    v_cvt_pk_bf16_f32 v51, v22, v23
    v_exp_f32 v24, v24
    ds_read_b128 v[68:71], v113 offset:7680
    v_exp_f32 v25, v25
    v_mfma_f32_32x32x16_bf16 v[88:103], v[56:59], v[48:51], v[88:103]
    v_exp_f32 v26, v26
    v_exp_f32 v27, v27
    v_exp_f32 v28, v28
    v_exp_f32 v29, v29
    v_exp_f32 v30, v30
    v_exp_f32 v31, v31
    v_cvt_pk_bf16_f32 v52, v24, v25
    v_cvt_pk_bf16_f32 v53, v26, v27
    v_cvt_pk_bf16_f32 v54, v28, v29
    v_cvt_pk_bf16_f32 v55, v30, v31
    v_exp_f32 v32, v32
    v_exp_f32 v33, v33
    v_mfma_f32_32x32x16_bf16 v[88:103], v[60:63], v[52:55], v[88:103]
    v_exp_f32 v34, v34
    v_exp_f32 v35, v35
    v_exp_f32 v36, v36
    s_waitcnt lgkmcnt(0)
    v_exp_f32 v37, v37
    v_mfma_f32_32x32x16_bf16 v[16:31], v[108:111], v[104:107], v[72:87]
    v_exp_f32 v38, v38
    ds_read_b128 v[108:111], v112 offset:9216
    v_exp_f32 v39, v39
    ds_read_b128 v[56:59], v113 offset:8192
    v_cvt_pk_bf16_f32 v48, v32, v33
    v_cvt_pk_bf16_f32 v49, v34, v35
    v_cvt_pk_bf16_f32 v50, v36, v37
    v_cvt_pk_bf16_f32 v51, v38, v39
    v_exp_f32 v40, v40
    ds_read_b128 v[60:63], v113 offset:8704
    v_exp_f32 v41, v41
    v_mfma_f32_32x32x16_bf16 v[88:103], v[64:67], v[48:51], v[88:103]
    v_exp_f32 v42, v42
    v_exp_f32 v43, v43
    v_exp_f32 v44, v44
    v_exp_f32 v45, v45
    v_exp_f32 v46, v46
    v_exp_f32 v47, v47
    v_cvt_pk_bf16_f32 v52, v40, v41
    v_cvt_pk_bf16_f32 v53, v42, v43
    v_cvt_pk_bf16_f32 v54, v44, v45
    v_cvt_pk_bf16_f32 v55, v46, v47
    v_add_u32 v112, 0x2000, v112
    v_add_u32 v113, v114, v113
    s_add_u32 s28, s28, 1
    s_cmp_lt_u32 s28, 8
    s_cbranch_scc1 L_l1_loop
    v_mfma_f32_32x32x16_bf16 v[88:103], v[68:71], v[52:55], v[88:103]
    s_waitcnt lgkmcnt(0)
    s_nop 11
    s_cmp_lg_u32 s30, 0
    s_cbranch_scc1 L_l1_fin
    v_cmp_nge_f32 vcc, s27, v96
    s_nop 1
    s_cbranch_vccz L_l1_fin
    s_mov_b32 s30, 1
    v_mov_b32 v112, v3
    v_mov_b32 v2, 0xff800000
    s_mov_b32 s28, 0
L_l1_maxloop:
    ds_read_b128 v[108:111], v112
    s_waitcnt lgkmcnt(0)
    v_mfma_f32_32x32x16_bf16 v[16:31], v[108:111], v[104:107], 0
    v_add_u32 v112, 0x400, v112
    s_nop 11
    v_max3_f32 v2, v2, v16, v17
    v_max3_f32 v2, v2, v18, v19
    v_max3_f32 v2, v2, v20, v21
    v_max3_f32 v2, v2, v22, v23
    v_max3_f32 v2, v2, v24, v25
    v_max3_f32 v2, v2, v26, v27
    v_max3_f32 v2, v2, v28, v29
    v_max3_f32 v2, v2, v30, v31
    s_add_u32 s28, s28, 1
    s_cmp_lt_u32 s28, 64
    s_cbranch_scc1 L_l1_maxloop
    v_mov_b32 v7, v2
    s_nop 1
    v_permlane32_swap_b32 v2, v7
    v_max_f32 v2, v2, v7
    v_sub_f32 v72, 0, v2
    v_sub_f32 v73, 0, v2
    v_sub_f32 v74, 0, v2
    v_sub_f32 v75, 0, v2
    v_sub_f32 v76, 0, v2
    v_sub_f32 v77, 0, v2
    v_sub_f32 v78, 0, v2
    v_sub_f32 v79, 0, v2
    v_sub_f32 v80, 0, v2
    v_sub_f32 v81, 0, v2
    v_sub_f32 v82, 0, v2
    v_sub_f32 v83, 0, v2
    v_sub_f32 v84, 0, v2
    v_sub_f32 v85, 0, v2
    v_sub_f32 v86, 0, v2
    v_sub_f32 v87, 0, v2
    v_mov_b32 v112, v3
    v_mov_b32 v113, v115
    v_mov_b32 v88, 0
    v_mov_b32 v89, 0
    v_mov_b32 v90, 0
    v_mov_b32 v91, 0
    v_mov_b32 v92, 0
    v_mov_b32 v93, 0
    v_mov_b32 v94, 0
    v_mov_b32 v95, 0
    v_mov_b32 v96, 0
    v_mov_b32 v97, 0
    v_mov_b32 v98, 0
    v_mov_b32 v99, 0
    v_mov_b32 v100, 0
    v_mov_b32 v101, 0
    v_mov_b32 v102, 0
    v_mov_b32 v103, 0
    v_mov_b32 v52, 0
    v_mov_b32 v53, 0
    v_mov_b32 v54, 0
    v_mov_b32 v55, 0
    v_mov_b32 v68, 0
    v_mov_b32 v69, 0
    v_mov_b32 v70, 0
    v_mov_b32 v71, 0
    ds_read_b128 v[108:111], v112
    ds_read_b128 v[56:59], v113
    ds_read_b128 v[60:63], v113 offset:512
    s_waitcnt lgkmcnt(0)
    v_mfma_f32_32x32x16_bf16 v[16:31], v[108:111], v[104:107], v[72:87]
    ds_read_b128 v[108:111], v112 offset:1024
    s_nop 10
    s_mov_b32 s28, 0
    s_branch L_l1_loop
L_l1_fin:
    v_rcp_f32 v2, v96
    s_nop 0
    v_mul_f32 v88, v88, v2
    v_mul_f32 v89, v89, v2
    v_mul_f32 v90, v90, v2
    v_mul_f32 v91, v91, v2
    v_mul_f32 v92, v92, v2
    v_mul_f32 v93, v93, v2
    v_mul_f32 v94, v94, v2
    v_mul_f32 v95, v95, v2
    v_cvt_pk_bf16_f32 v48, v88, v89
    v_cvt_pk_bf16_f32 v49, v90, v91
    v_cvt_pk_bf16_f32 v50, v92, v93
    v_cvt_pk_bf16_f32 v51, v94, v95
    global_store_dwordx4 v4, v[48:51], s[56:57] sc1
    v_and_b32 v6, 31, v1
    v_lshrrev_b32 v7, 5, v1
    s_lshl_b32 s44, s35, 19
    s_lshl_b32 s45, s36, 10
    s_add_u32 s44, s44, s45
    v_add_u32 v10, s44, v3
    s_lshl_b32 s44, s24, 13
    s_add_u32 s44, s44, 0x10000
    v_add_u32 v12, s44, v3
    s_lshl_b32 s44, s25, 12
    s_lshl_b32 s45, s22, 7
    s_add_u32 s44, s44, s45
    s_add_u32 s44, s44, 0x1340000
    v_mov_b32 v13, s44
    v_mov_b32 v14, s31
    s_lshl_b32 s44, s36, 12
    s_lshl_b32 s45, s35, 10
    s_add_u32 s44, s44, s45
    s_add_u32 s44, s44, 0x1340000
    v_lshl_add_u32 v31, v1, 7, s44
    s_lshl_b32 s44, s23, 15
    s_add_u32 s44, s44, 0x1340000
    v_lshl_add_u32 v31, v6, 7, s44
    s_waitcnt vmcnt(0)
    s_barrier
    s_cmp_lg_u32 s24, 0
    s_cbranch_scc1 L_l1_nof
    s_mov_b64 exec, 1
    global_store_dword v13, v14, s[10:11] sc0 sc1
    s_mov_b64 exec, -1
L_l1_nof:
    s_lshl_b32 s44, s34, 15
    s_xor_b32 s45, s35, 0
    s_lshl_b32 s45, s45, 13
    s_add_u32 s45, s45, s44
    v_add_u32 v27, s45, v3
    s_xor_b32 s45, s35, 1
    s_lshl_b32 s45, s45, 13
    s_add_u32 s45, s45, s44
    v_add_u32 v28, s45, v3
    s_xor_b32 s45, s35, 2
    s_lshl_b32 s45, s45, 13
    s_add_u32 s45, s45, s44
    v_add_u32 v29, s45, v3
    s_xor_b32 s45, s35, 3
    s_lshl_b32 s45, s45, 13
    s_add_u32 s45, s45, s44
    v_add_u32 v30, s45, v3
    v_lshlrev_b32 v96, 16, v116
    v_and_b32 v97, 0xffff0000, v116
    v_lshlrev_b32 v98, 16, v117
    v_and_b32 v99, 0xffff0000, v117
    v_lshlrev_b32 v100, 16, v118
    v_and_b32 v101, 0xffff0000, v118
    v_lshlrev_b32 v102, 16, v119
    v_and_b32 v103, 0xffff0000, v119
    v_sub_f32 v16, v96, v126
    v_sub_f32 v17, v97, v126
    v_sub_f32 v18, v98, v126
    v_sub_f32 v19, v99, v126
    v_sub_f32 v20, v100, v126
    v_sub_f32 v21, v101, v126
    v_sub_f32 v22, v102, v126
    v_sub_f32 v23, v103, v126
    v_mul_f32 v16, v16, v127
    v_mul_f32 v17, v17, v127
    v_mul_f32 v18, v18, v127
    v_mul_f32 v19, v19, v127
    v_mul_f32 v20, v20, v127
    v_mul_f32 v21, v21, v127
    v_mul_f32 v22, v22, v127
    v_mul_f32 v23, v23, v127
    v_cvt_pk_bf16_f32 v116, v16, v17
    v_cvt_pk_bf16_f32 v117, v18, v19
    v_cvt_pk_bf16_f32 v118, v20, v21
    v_cvt_pk_bf16_f32 v119, v22, v23
    v_lshlrev_b32 v16, 16, v116
    v_and_b32 v17, 0xffff0000, v116
    v_lshlrev_b32 v18, 16, v117
    v_and_b32 v19, 0xffff0000, v117
    v_lshlrev_b32 v20, 16, v118
    v_and_b32 v21, 0xffff0000, v118
    v_lshlrev_b32 v22, 16, v119
    v_and_b32 v23, 0xffff0000, v119
    v_add_f32 v96, v96, v16
    v_add_f32 v97, v97, v17
    v_add_f32 v98, v98, v18
    v_add_f32 v99, v99, v19
    v_add_f32 v100, v100, v20
    v_add_f32 v101, v101, v21
    v_add_f32 v102, v102, v22
    v_add_f32 v103, v103, v23
    v_cvt_pk_bf16_f32 v116, v96, v97
    v_cvt_pk_bf16_f32 v117, v98, v99
    v_cvt_pk_bf16_f32 v118, v100, v101
    v_cvt_pk_bf16_f32 v119, v102, v103
    v_lshlrev_b32 v96, 16, v116
    v_and_b32 v97, 0xffff0000, v116
    v_lshlrev_b32 v98, 16, v117
    v_and_b32 v99, 0xffff0000, v117
    v_lshlrev_b32 v100, 16, v118
    v_and_b32 v101, 0xffff0000, v118
    v_lshlrev_b32 v102, 16, v119
    v_and_b32 v103, 0xffff0000, v119
    v_lshlrev_b32 v13, 2, v6
    v_add_u32 v13, 156288, v13
    ds_read_b32 v16, v13
    s_waitcnt lgkmcnt(0)
    v_mov_b32 v17, v16
    s_nop 1
    v_max_u32_dpp v17, v17, v17 quad_perm:[1,0,3,2] row_mask:0xf bank_mask:0xf
    s_nop 1
    v_max_u32_dpp v17, v17, v17 quad_perm:[2,3,0,1] row_mask:0xf bank_mask:0xf
    s_nop 1
    v_max_u32_dpp v17, v17, v17 row_half_mirror row_mask:0xf bank_mask:0xf
    s_nop 1
    v_max_u32_dpp v17, v17, v17 row_mirror row_mask:0xf bank_mask:0xf
    v_mov_b32 v18, v17
    s_nop 1
    v_permlane16_swap_b32 v17, v18
    v_max_u32 v17, v17, v18
    v_cmp_ne_u32 vcc, v17, v16
    s_nop 0
    s_nop 0
    v_cndmask_b32 v16, 0, v16, vcc
    v_mov_b32 v17, v16
    s_nop 1
    v_max_u32_dpp v17, v17, v17 quad_perm:[1,0,3,2] row_mask:0xf bank_mask:0xf
    s_nop 1
    v_max_u32_dpp v17, v17, v17 quad_perm:[2,3,0,1] row_mask:0xf bank_mask:0xf
    s_nop 1
    v_max_u32_dpp v17, v17, v17 row_half_mirror row_mask:0xf bank_mask:0xf
    s_nop 1
    v_max_u32_dpp v17, v17, v17 row_mirror row_mask:0xf bank_mask:0xf
    v_mov_b32 v18, v17
    s_nop 1
    v_permlane16_swap_b32 v17, v18
    v_max_u32 v17, v17, v18
    v_cmp_ne_u32 vcc, v17, v16
    v_readfirstlane_b32 s100, v17
    s_nop 0
    v_cndmask_b32 v16, 0, v16, vcc
    v_mov_b32 v17, v16
    s_nop 1
    v_max_u32_dpp v17, v17, v17 quad_perm:[1,0,3,2] row_mask:0xf bank_mask:0xf
    s_nop 1
    v_max_u32_dpp v17, v17, v17 quad_perm:[2,3,0,1] row_mask:0xf bank_mask:0xf
    s_nop 1
    v_max_u32_dpp v17, v17, v17 row_half_mirror row_mask:0xf bank_mask:0xf
    s_nop 1
    v_max_u32_dpp v17, v17, v17 row_mirror row_mask:0xf bank_mask:0xf
    v_mov_b32 v18, v17
    s_nop 1
    v_permlane16_swap_b32 v17, v18
    v_max_u32 v17, v17, v18
    v_cmp_ne_u32 vcc, v17, v16
    v_readfirstlane_b32 s101, v17
    s_nop 0
    v_cndmask_b32 v16, 0, v16, vcc
    s_and_b32 s100, s100, 0x7ff
    s_sub_u32 s100, 2047, s100
    s_and_b32 s101, s101, 0x7ff
    s_sub_u32 s101, 2047, s101
    s_cmp_lg_u32 s24, 0
    s_cbranch_scc1 L_l1_owait
    s_mov_b32 exec_lo, -1
    s_mov_b32 exec_hi, 0
    s_mov_b32 s29, 65536
L_l1_po:
L_l1_po_l:
    global_load_dword v14, v31, s[10:11] sc0 sc1
L_l1_po_w:
    s_waitcnt vmcnt(0)
    v_cmp_ne_u32 vcc, s31, v14
    s_sub_u32 s29, s29, 1
    s_cbranch_vccz L_l1_po_ok
    s_cbranch_scc0 L_l1_po
L_l1_po_ok:
    s_mov_b64 exec, -1
L_l1_owait:
    s_waitcnt lgkmcnt(0)
    s_barrier
    global_load_dwordx4 v[64:67], v10, s[56:57] sc1
    v_add_u32 v10, 0x10000, v10
    global_load_dwordx4 v[68:71], v10, s[56:57] sc1
    v_add_u32 v10, 0x10000, v10
    global_load_dwordx4 v[72:75], v10, s[56:57] sc1
    v_add_u32 v10, 0x10000, v10
    global_load_dwordx4 v[76:79], v10, s[56:57] sc1
    v_add_u32 v10, 0x10000, v10
    global_load_dwordx4 v[80:83], v10, s[56:57] sc1
    v_add_u32 v10, 0x10000, v10
    global_load_dwordx4 v[84:87], v10, s[56:57] sc1
    v_add_u32 v10, 0x10000, v10
    global_load_dwordx4 v[88:91], v10, s[56:57] sc1
    v_add_u32 v10, 0x10000, v10
    global_load_dwordx4 v[92:95], v10, s[56:57] sc1
    s_waitcnt vmcnt(7)
    v_mfma_f32_32x32x16_bf16 v[32:47], a[0:3], v[64:67], 0
    v_mfma_f32_32x32x16_bf16 v[48:63], a[4:7], v[64:67], 0
    s_waitcnt vmcnt(6)
    v_mfma_f32_32x32x16_bf16 v[32:47], a[8:11], v[68:71], v[32:47]
    v_mfma_f32_32x32x16_bf16 v[48:63], a[12:15], v[68:71], v[48:63]
    s_waitcnt vmcnt(5)
    v_mfma_f32_32x32x16_bf16 v[32:47], a[16:19], v[72:75], v[32:47]
    v_mfma_f32_32x32x16_bf16 v[48:63], a[20:23], v[72:75], v[48:63]
    s_waitcnt vmcnt(4)
    v_mfma_f32_32x32x16_bf16 v[32:47], a[24:27], v[76:79], v[32:47]
    v_mfma_f32_32x32x16_bf16 v[48:63], a[28:31], v[76:79], v[48:63]
    s_waitcnt vmcnt(3)
    v_mfma_f32_32x32x16_bf16 v[32:47], a[32:35], v[80:83], v[32:47]
    v_mfma_f32_32x32x16_bf16 v[48:63], a[36:39], v[80:83], v[48:63]
    s_waitcnt vmcnt(2)
    v_mfma_f32_32x32x16_bf16 v[32:47], a[40:43], v[84:87], v[32:47]
    v_mfma_f32_32x32x16_bf16 v[48:63], a[44:47], v[84:87], v[48:63]
    s_waitcnt vmcnt(1)
    v_mfma_f32_32x32x16_bf16 v[32:47], a[48:51], v[88:91], v[32:47]
    v_mfma_f32_32x32x16_bf16 v[48:63], a[52:55], v[88:91], v[48:63]
    s_waitcnt vmcnt(0)
    v_mfma_f32_32x32x16_bf16 v[32:47], a[56:59], v[92:95], v[32:47]
    v_mfma_f32_32x32x16_bf16 v[48:63], a[60:63], v[92:95], v[48:63]
    s_lshl_b32 s44, s34, 12
    s_lshl_b32 s45, s35, 10
    s_add_u32 s44, s44, s45
    s_add_u32 s44, s44, 141312
    v_add_u32 v13, s44, v3
    s_add_u32 s58, s10, 0x200000
    s_addc_u32 s59, s11, 0
    s_nop 4
    ds_write_b128 v28, v[40:43] offset:2048
    ds_write_b128 v28, v[44:47] offset:3072
    ds_write_b128 v29, v[48:51] offset:4096
    ds_write_b128 v29, v[52:55] offset:5120
    ds_write_b128 v30, v[56:59] offset:6144
    ds_write_b128 v30, v[60:63] offset:7168
    v_add_f32 v32, v32, v96
    v_add_f32 v33, v33, v97
    v_add_f32 v34, v34, v98
    v_add_f32 v35, v35, v99
    v_add_f32 v36, v36, v100
    v_add_f32 v37, v37, v101
    v_add_f32 v38, v38, v102
    v_add_f32 v39, v39, v103
    s_waitcnt lgkmcnt(0)
    s_barrier
    ds_read_b128 v[40:43], v27 offset:2048
    ds_read_b128 v[44:47], v27 offset:3072
    ds_read_b128 v[48:51], v27 offset:4096
    ds_read_b128 v[52:55], v27 offset:5120
    ds_read_b128 v[56:59], v27 offset:6144
    ds_read_b128 v[60:63], v27 offset:7168
    s_waitcnt lgkmcnt(4)
    v_add_f32 v32, v32, v40
    v_add_f32 v33, v33, v41
    v_add_f32 v34, v34, v42
    v_add_f32 v35, v35, v43
    v_add_f32 v36, v36, v44
    v_add_f32 v37, v37, v45
    v_add_f32 v38, v38, v46
    v_add_f32 v39, v39, v47
    s_waitcnt lgkmcnt(0)
    v_add_f32 v48, v48, v56
    v_add_f32 v49, v49, v57
    v_add_f32 v50, v50, v58
    v_add_f32 v51, v51, v59
    v_add_f32 v52, v52, v60
    v_add_f32 v53, v53, v61
    v_add_f32 v54, v54, v62
    v_add_f32 v55, v55, v63
    v_add_f32 v32, v32, v48
    v_add_f32 v33, v33, v49
    v_add_f32 v34, v34, v50
    v_add_f32 v35, v35, v51
    v_add_f32 v36, v36, v52
    v_add_f32 v37, v37, v53
    v_add_f32 v38, v38, v54
    v_add_f32 v39, v39, v55
    v_cvt_pk_bf16_f32 v24, v32, v33
    v_cvt_pk_bf16_f32 v25, v34, v35
    v_cvt_pk_bf16_f32 v26, v36, v37
    v_cvt_pk_bf16_f32 v27, v38, v39
    v_mov_b32 v116, v24
    v_mov_b32 v117, v25
    v_mov_b32 v118, v26
    v_mov_b32 v119, v27
    v_permlane32_swap_b32 v24, v26
    v_permlane32_swap_b32 v25, v27
    global_store_dwordx4 v124, v[24:27], s[58:59] sc1
    v_dot2_f32_bf16 v16, v116, s63, 0
    v_dot2_f32_bf16 v17, v116, v116, 0
    v_dot2_f32_bf16 v18, v116, v120, 0
    v_dot2_f32_bf16 v16, v117, s63, v16
    v_dot2_f32_bf16 v17, v117, v117, v17
    v_dot2_f32_bf16 v18, v117, v121, v18
    v_dot2_f32_bf16 v16, v118, s63, v16
    v_dot2_f32_bf16 v17, v118, v118, v17
    v_dot2_f32_bf16 v18, v118, v122, v18
    v_dot2_f32_bf16 v16, v119, s63, v16
    v_dot2_f32_bf16 v17, v119, v119, v17
    v_dot2_f32_bf16 v18, v119, v123, v18
    s_nop 2
    ds_write_b96 v13, v[16:18]
    s_waitcnt vmcnt(0) lgkmcnt(0)
    s_waitcnt vmcnt(0) lgkmcnt(0)
    s_barrier
    s_cmp_lg_u32 s24, 0
    s_cbranch_scc1 L_l1_nost
    v_lshlrev_b32 v13, 4, v6
    v_lshl_add_u32 v13, v7, 12, v13
    v_add_u32 v13, 141312, v13
    ds_read_b96 v[32:34], v13 offset:0
    ds_read_b96 v[36:38], v13 offset:512
    ds_read_b96 v[40:42], v13 offset:1024
    ds_read_b96 v[44:46], v13 offset:1536
    ds_read_b96 v[48:50], v13 offset:2048
    ds_read_b96 v[52:54], v13 offset:2560
    ds_read_b96 v[56:58], v13 offset:3072
    ds_read_b96 v[60:62], v13 offset:3584
    s_lshl_b32 s44, s33, 3
    s_add_u32 s44, s44, s32
    s_lshl_b32 s44, s44, 10
    s_add_u32 s44, s44, 0x1040000
    v_add_u32 v13, s44, v3
    v_mov_b32 v35, s31
    s_waitcnt lgkmcnt(0)
    v_add_f32 v32, v32, v36
    v_add_f32 v33, v33, v37
    v_add_f32 v34, v34, v38
    v_add_f32 v32, v32, v40
    v_add_f32 v33, v33, v41
    v_add_f32 v34, v34, v42
    v_add_f32 v32, v32, v44
    v_add_f32 v33, v33, v45
    v_add_f32 v34, v34, v46
    v_add_f32 v32, v32, v48
    v_add_f32 v33, v33, v49
    v_add_f32 v34, v34, v50
    v_add_f32 v32, v32, v52
    v_add_f32 v33, v33, v53
    v_add_f32 v34, v34, v54
    v_add_f32 v32, v32, v56
    v_add_f32 v33, v33, v57
    v_add_f32 v34, v34, v58
    v_add_f32 v32, v32, v60
    v_add_f32 v33, v33, v61
    v_add_f32 v34, v34, v62
    global_store_dwordx4 v13, v[32:35], s[10:11] sc0 sc1
L_l1_nost:
    v_mov_b32 v50, s100
    v_mov_b32 v51, s101
    v_and_b32 v52, 1, v1
    v_cmp_eq_u32 vcc, 1, v52
    v_lshlrev_b32 v52, 3, v52
    v_add_u32 v52, 156928, v52
    v_cndmask_b32 v50, v50, v51, vcc
    v_lshrrev_b32 v51, 4, v50
    v_and_b32 v50, 15, v50
    v_lshlrev_b32 v50, 4, v50
    v_lshl_add_u32 v50, v51, 14, v50
    v_and_b32 v51, 48, v1
    v_lshl_add_u32 v50, v51, 4, v50
    s_lshl_b32 s44, s24, 11
    v_add_u32 v50, s44, v50
    s_cmp_lt_u32 s2, 224
    s_cbranch_scc1 L_ca_done
    v_mov_b32 v50, s100
    v_mov_b32 v51, s101
    v_and_b32 v53, 16, v1
    v_cmp_eq_u32 vcc, 16, v53
    s_sub_u32 s44, s2, 224
    s_lshl_b32 s44, s44, 9
    v_cndmask_b32 v50, v50, v51, vcc
    v_lshrrev_b32 v51, 4, v50
    v_and_b32 v50, 15, v50
    v_lshlrev_b32 v50, 4, v50
    v_lshl_add_u32 v50, v51, 14, v50
    v_bfe_u32 v51, v1, 3, 1
    v_lshl_add_u32 v50, v51, 8, v50
    v_add_u32 v50, s44, v50
L_ca_done:
    v_accvgpr_read_b32 v64, a120
    v_accvgpr_read_b32 v65, a121
    v_accvgpr_read_b32 v66, a122
    v_accvgpr_read_b32 v67, a123
    v_accvgpr_read_b32 v68, a124
    v_accvgpr_read_b32 v69, a125
    v_accvgpr_read_b32 v70, a126
    v_accvgpr_read_b32 v71, a127
    v_lshlrev_b32 v64, 16, v64
    v_lshlrev_b32 v65, 16, v65
    v_lshlrev_b32 v66, 16, v66
    v_lshlrev_b32 v67, 16, v67
    v_lshlrev_b32 v68, 16, v68
    v_lshlrev_b32 v69, 16, v69
    v_lshlrev_b32 v70, 16, v70
    v_lshlrev_b32 v71, 16, v71
    s_lshl_b32 s44, s33, 13
    s_add_u32 s44, s44, 0x1040000
    v_lshl_add_u32 v12, v0, 4, s44
    s_cmp_lg_u32 s24, 0
    s_cbranch_scc1 L_l1_a1
    s_waitcnt vmcnt(0)
L_l1_a1:
    s_barrier
    s_cmp_lg_u32 s24, 1
    s_cbranch_scc1 L_cs_skip0
    v_mov_b32 v40, s100
    v_mov_b32 v41, s101
    v_cmp_gt_u32 vcc, 8, v1
    v_and_b32 v42, 7, v1
    s_nop 0
    v_cndmask_b32 v40, v41, v40, vcc
    v_lshrrev_b32 v41, 6, v40
    v_lshl_add_u32 v41, v41, 3, v42
    v_and_b32 v40, 63, v40
    v_lshlrev_b32 v40, 4, v40
    v_lshl_add_u32 v40, v41, 10, v40
    v_add_u32 v40, 0x1040000, v40
    s_mov_b32 exec_lo, 0xffff
    s_mov_b32 exec_hi, 0
    global_load_dwordx4 v[44:47], v40, s[10:11] sc0 sc1
    s_mov_b64 exec, -1
L_cs_skip0:
    global_load_dwordx4 v[32:35], v12, s[10:11] sc0 sc1
    s_mov_b32 s29, 65536
    s_branch L_l1_pa_w
L_l1_pa:
L_l1_pa_l:
    global_load_dwordx4 v[32:35], v12, s[10:11] sc0 sc1
L_l1_pa_w:
    s_waitcnt vmcnt(0)
    v_cmp_ne_u32 vcc, s31, v35
    s_sub_u32 s29, s29, 1
    s_cbranch_vccz L_l1_pa_ok
    s_cbranch_scc0 L_l1_pa
L_l1_pa_ok:
    v_lshlrev_b32 v13, 4, v0
    ds_write_b96 v13, v[32:34]
    s_cmp_lg_u32 s24, 1
    s_cbranch_scc1 L_cs_skip
    s_mov_b32 exec_lo, 0xffff
    s_mov_b32 exec_hi, 0
    s_mov_b32 s29, 65536
    s_branch L_pc_w
L_pc:
L_pc_l:
    global_load_dwordx4 v[44:47], v40, s[10:11] sc0 sc1
L_pc_w:
    s_waitcnt vmcnt(0)
    v_cmp_ne_u32 vcc, s31, v47
    s_sub_u32 s29, s29, 1
    s_cbranch_vccz L_pc_ok
    s_cbranch_scc0 L_pc
L_pc_ok:
    s_nop 0
    v_add_f32_dpp v44, v44, v44 quad_perm:[1,0,3,2] row_mask:0xf bank_mask:0xf
    v_add_f32_dpp v45, v45, v45 quad_perm:[1,0,3,2] row_mask:0xf bank_mask:0xf
    s_nop 0
    v_add_f32_dpp v44, v44, v44 quad_perm:[2,3,0,1] row_mask:0xf bank_mask:0xf
    v_add_f32_dpp v45, v45, v45 quad_perm:[2,3,0,1] row_mask:0xf bank_mask:0xf
    s_nop 0
    v_add_f32_dpp v44, v44, v44 row_half_mirror row_mask:0xf bank_mask:0xf
    v_add_f32_dpp v45, v45, v45 row_half_mirror row_mask:0xf bank_mask:0xf
    v_mul_f32 v46, s64, v44
    v_mul_f32 v47, s64, v45
    v_fma_f32 v47, -v46, v46, v47
    v_max_f32 v47, 0, v47
    v_add_f32 v45, s65, v47
    v_rsq_f32 v45, v45
    v_and_b32 v40, 8, v1
    v_add_u32 v40, 156928, v40
    v_mul_f32 v44, v46, v45
    ds_write_b64 v40, v[44:45]
    s_mov_b64 exec, -1
L_cs_skip:
    s_waitcnt lgkmcnt(0)
    s_barrier
    global_load_dwordx4 v[56:59], v50, s[58:59] sc1
    global_load_dwordx4 v[60:63], v50, s[58:59] offset:1024 sc1
    ds_read_b64 v[54:55], v52
    ds_read_b96 v[16:18], v3 offset:0
    ds_read_b96 v[20:22], v3 offset:1024
    ds_read_b96 v[24:26], v3 offset:2048
    ds_read_b96 v[28:30], v3 offset:3072
    ds_read_b96 v[32:34], v3 offset:4096
    ds_read_b96 v[36:38], v3 offset:5120
    ds_read_b96 v[40:42], v3 offset:6144
    ds_read_b96 v[44:46], v3 offset:7168
    s_waitcnt lgkmcnt(0)
    v_add_f32 v16, v16, v20
    v_add_f32 v17, v17, v21
    v_add_f32 v18, v18, v22
    v_add_f32 v24, v24, v28
    v_add_f32 v25, v25, v29
    v_add_f32 v26, v26, v30
    v_add_f32 v32, v32, v36
    v_add_f32 v33, v33, v37
    v_add_f32 v34, v34, v38
    v_add_f32 v40, v40, v44
    v_add_f32 v41, v41, v45
    v_add_f32 v42, v42, v46
    v_add_f32 v16, v16, v24
    v_add_f32 v17, v17, v25
    v_add_f32 v18, v18, v26
    v_add_f32 v32, v32, v40
    v_add_f32 v33, v33, v41
    v_add_f32 v34, v34, v42
    v_add_f32 v16, v16, v32
    v_add_f32 v17, v17, v33
    v_add_f32 v18, v18, v34
    v_mul_f32 v126, s64, v16
    v_mul_f32 v20, s64, v17
    v_fma_f32 v20, -v126, v126, v20
    v_max_f32 v20, 0, v20
    v_add_f32 v127, s65, v20
    v_rsq_f32 v127, v127
    s_or_b32 s44, s32, s24
    s_cmp_lg_u32 s44, 0
    s_cbranch_scc1 L_l1_nokey
    v_fma_f32 v18, -v126, s39, v18
    v_mul_f32 v18, v18, v127
    v_cvt_pk_bf16_f32 v18, v18, v18
    v_and_b32 v18, 0xffff0000, v18
    v_ashrrev_i32 v19, 31, v18
    v_or_b32 v19, 0x80000000, v19
    v_xor_b32 v19, v19, v18
    v_and_b32 v19, 0xffff0000, v19
    s_lshl_b32 s44, s33, 6
    s_sub_u32 s44, 2047, s44
    v_sub_u32 v20, s44, v1
    v_or_b32 v20, v19, v20
    v_mov_b32 v24, v20
    s_nop 1
    v_max_u32_dpp v24, v24, v24 quad_perm:[1,0,3,2] row_mask:0xf bank_mask:0xf
    s_nop 1
    v_max_u32_dpp v24, v24, v24 quad_perm:[2,3,0,1] row_mask:0xf bank_mask:0xf
    s_nop 1
    v_max_u32_dpp v24, v24, v24 row_half_mirror row_mask:0xf bank_mask:0xf
    s_nop 1
    v_max_u32_dpp v24, v24, v24 row_mirror row_mask:0xf bank_mask:0xf
    v_mov_b32 v25, v24
    s_nop 1
    v_permlane16_swap_b32 v24, v25
    v_max_u32 v24, v24, v25
    v_mov_b32 v25, v24
    s_nop 1
    v_permlane32_swap_b32 v24, v25
    v_max_u32 v24, v24, v25
    v_cmp_eq_u32 vcc, v24, v20
    s_lshl_b32 s44, s33, 7
    s_add_u32 s44, s44, 0x12c8000
    s_ff1_i32_b64 s45, vcc
    v_lshl_add_u32 v13, v1, 12, s44
    v_mov_b32 v27, s31
    v_readlane_b32 s46, v126, s45
    v_readlane_b32 s47, v127, s45
    s_mov_b64 exec, 0xff
    s_nop 0
    v_mov_b32 v25, s46
    v_mov_b32 v26, s47
    global_store_dwordx4 v13, v[24:27], s[10:11] sc0 sc1
    s_mov_b64 exec, -1
L_l1_nokey:
    v_mov_b32 v16, v126
    v_mov_b32 v17, v127
    s_cmp_eq_u32 s34, 1
    s_cselect_b64 vcc, -1, 0
    v_permlane32_swap_b32 v126, v16
    v_permlane32_swap_b32 v127, v17
    v_cndmask_b32 v126, v126, v16, vcc
    v_cndmask_b32 v127, v127, v17, vcc
    s_cmp_ge_u32 s2, 224
    s_cbranch_scc1 L_sp_skip
    v_and_b32 v17, 48, v1
    s_lshl_b32 s44, s24, 7
    s_add_u32 s44, s44, 152064
    v_and_b32 v18, 1, v1
    v_lshl_add_u32 v17, v18, 6, v17
    v_add_u32 v17, s44, v17
    v_and_b32 v18, 31, v1
    v_lshlrev_b32 v18, 2, v18
    v_add_u32 v18, 152064, v18
    v_lshrrev_b32 v22, 4, v0
    v_mul_u32_u24 v22, 14336, v22
    v_and_b32 v23, 15, v0
    v_lshl_add_u32 v22, v23, 2, v22
    s_lshl_b32 s42, s3, 6
    s_add_u32 s42, s42, 0x1180000
    v_add_u32 v22, s42, v22
    v_add_u32 v23, 0x80000, v22
    s_or_b32 s44, s32, s24
    s_cmp_eq_u32 s44, 0
    s_waitcnt vmcnt(1)
    s_cbranch_scc1 L_sp_go
    s_waitcnt vmcnt(0)
L_sp_go:
    v_lshlrev_b32 v24, 16, v56
    v_and_b32 v25, 0xffff0000, v56
    v_fma_f32 v24, v24, v55, -v54
    v_fma_f32 v25, v25, v55, -v54
    v_cvt_pk_bf16_f32 v56, v24, v25
    v_lshlrev_b32 v26, 16, v57
    v_and_b32 v27, 0xffff0000, v57
    v_fma_f32 v26, v26, v55, -v54
    v_fma_f32 v27, v27, v55, -v54
    v_cvt_pk_bf16_f32 v57, v26, v27
    v_lshlrev_b32 v24, 16, v58
    v_and_b32 v25, 0xffff0000, v58
    v_fma_f32 v24, v24, v55, -v54
    v_fma_f32 v25, v25, v55, -v54
    v_cvt_pk_bf16_f32 v58, v24, v25
    v_lshlrev_b32 v26, 16, v59
    v_and_b32 v27, 0xffff0000, v59
    v_fma_f32 v26, v26, v55, -v54
    v_fma_f32 v27, v27, v55, -v54
    v_cvt_pk_bf16_f32 v59, v26, v27
    v_lshlrev_b32 v24, 16, v60
    v_and_b32 v25, 0xffff0000, v60
    v_fma_f32 v24, v24, v55, -v54
    v_fma_f32 v25, v25, v55, -v54
    v_cvt_pk_bf16_f32 v60, v24, v25
    v_lshlrev_b32 v26, 16, v61
    v_and_b32 v27, 0xffff0000, v61
    v_fma_f32 v26, v26, v55, -v54
    v_fma_f32 v27, v27, v55, -v54
    v_cvt_pk_bf16_f32 v61, v26, v27
    v_lshlrev_b32 v24, 16, v62
    v_and_b32 v25, 0xffff0000, v62
    v_fma_f32 v24, v24, v55, -v54
    v_fma_f32 v25, v25, v55, -v54
    v_cvt_pk_bf16_f32 v62, v24, v25
    v_lshlrev_b32 v26, 16, v63
    v_and_b32 v27, 0xffff0000, v63
    v_fma_f32 v26, v26, v55, -v54
    v_fma_f32 v27, v27, v55, -v54
    v_cvt_pk_bf16_f32 v63, v26, v27
    s_nop 1
    v_mfma_f32_16x16x32_bf16 v[24:27], a[112:115], v[56:59], 0
    v_mfma_f32_16x16x32_bf16 v[24:27], a[116:119], v[60:63], v[24:27]
    s_mov_b32 exec_lo, 0x00030003
    s_mov_b32 exec_hi, 0x00030003
    s_nop 5
    ds_write_b128 v17, v[24:27]
    s_mov_b64 exec, -1
    s_waitcnt lgkmcnt(0)
    s_barrier
    ds_read_b32 v56, v18 offset:0
    ds_read_b32 v57, v18 offset:128
    ds_read_b32 v58, v18 offset:256
    ds_read_b32 v59, v18 offset:384
    ds_read_b32 v60, v18 offset:512
    ds_read_b32 v61, v18 offset:640
    ds_read_b32 v62, v18 offset:768
    ds_read_b32 v63, v18 offset:896
    s_waitcnt lgkmcnt(0)
    v_add_f32 v56, v56, v57
    v_add_f32 v58, v58, v59
    v_add_f32 v60, v60, v61
    v_add_f32 v62, v62, v63
    v_add_f32 v56, v56, v58
    v_add_f32 v60, v60, v62
    v_add_f32 v56, v56, v60
    v_cvt_pk_bf16_f32 v56, v56, v56
    v_and_b32 v56, 0xffff0000, v56
    v_mul_f32 v16, 0xbfb8aa3b, v56
    v_exp_f32 v16, v16
    s_nop 0
    v_add_f32 v16, 1.0, v16
    v_rcp_f32 v16, v16
    s_nop 0
    v_mul_f32 v16, v16, v56
    v_cvt_pk_bf16_f32 v16, v16, v16
    v_and_b32 v16, 0xffff0000, v16
    s_nop 1
    v_mul_f32_dpp v16, v56, v16 row_ror:8 row_mask:0xf bank_mask:0xf
    v_cvt_pk_bf16_f32 v16, v16, v16
    v_and_b32 v16, 0xffff0000, v16
    s_nop 0
    v_readlane_b32 s44, v16, 0
    v_readlane_b32 s45, v16, 1
    v_readlane_b32 s46, v16, 2
    v_readlane_b32 s47, v16, 3
    v_readlane_b32 s48, v16, 4
    v_readlane_b32 s49, v16, 5
    v_readlane_b32 s50, v16, 6
    v_readlane_b32 s51, v16, 7
    v_mul_f32 v24, s44, v64
    v_mul_f32 v25, s45, v65
    v_fmac_f32 v24, s46, v66
    v_fmac_f32 v25, s47, v67
    v_fmac_f32 v24, s48, v68
    v_fmac_f32 v25, s49, v69
    v_fmac_f32 v24, s50, v70
    v_fmac_f32 v25, s51, v71
    v_add_f32 v24, v24, v25
    v_min_u32 v28, 0xfffffffe, v24
    s_nop 0
    s_nop 0
    v_mov_b32_dpp v29, v28 quad_perm:[1,1,1,1] row_mask:0xf bank_mask:0xf
    v_mov_b32_dpp v30, v28 quad_perm:[2,2,2,2] row_mask:0xf bank_mask:0xf
    v_mov_b32_dpp v31, v28 quad_perm:[3,3,3,3] row_mask:0xf bank_mask:0xf
    s_mov_b32 exec_lo, 0x11111111
    s_mov_b32 exec_hi, 0x11111111
    global_store_dwordx4 v22, v[28:31], s[10:11] sc0 sc1
    s_mov_b64 exec, -1
    v_readlane_b32 s44, v16, 16
    v_readlane_b32 s45, v16, 17
    v_readlane_b32 s46, v16, 18
    v_readlane_b32 s47, v16, 19
    v_readlane_b32 s48, v16, 20
    v_readlane_b32 s49, v16, 21
    v_readlane_b32 s50, v16, 22
    v_readlane_b32 s51, v16, 23
    v_mul_f32 v26, s44, v64
    v_mul_f32 v27, s45, v65
    v_fmac_f32 v26, s46, v66
    v_fmac_f32 v27, s47, v67
    v_fmac_f32 v26, s48, v68
    v_fmac_f32 v27, s49, v69
    v_fmac_f32 v26, s50, v70
    v_fmac_f32 v27, s51, v71
    v_add_f32 v26, v26, v27
    v_min_u32 v32, 0xfffffffe, v26
    s_nop 0
    s_nop 0
    v_mov_b32_dpp v33, v32 quad_perm:[1,1,1,1] row_mask:0xf bank_mask:0xf
    v_mov_b32_dpp v34, v32 quad_perm:[2,2,2,2] row_mask:0xf bank_mask:0xf
    v_mov_b32_dpp v35, v32 quad_perm:[3,3,3,3] row_mask:0xf bank_mask:0xf
    s_mov_b32 exec_lo, 0x11111111
    s_mov_b32 exec_hi, 0x11111111
    global_store_dwordx4 v23, v[32:35], s[10:11] sc0 sc1
    s_mov_b64 exec, -1
    s_branch L_sp_done
L_sp_skip:
    s_waitcnt vmcnt(0)
    v_bfe_u32 v16, v1, 1, 1
    v_cmp_eq_u32 vcc, 1, v16
    v_bfe_u32 v16, v1, 2, 1
    s_nop 0
    v_cndmask_b32 v56, v56, v57, vcc
    v_cndmask_b32 v58, v58, v59, vcc
    v_cmp_eq_u32 vcc, 1, v16
    v_and_b32 v16, 1, v1
    s_nop 0
    v_cndmask_b32 v56, v56, v58, vcc
    v_cmp_eq_u32 vcc, 1, v16
    v_lshlrev_b32 v57, 16, v56
    v_and_b32 v58, 0xffff0000, v56
    v_cndmask_b32 v56, v57, v58, vcc
L_sp_done:
    s_lshl_b32 s44, s23, 12
    s_add_u32 s44, s44, 0x12c8000
    v_lshl_add_u32 v80, v6, 7, s44
    s_cmp_lg_u32 s24, 0
    s_cbranch_scc1 L_l1_nki
    global_load_dwordx4 v[76:79], v80, s[10:11] sc0 sc1
L_l1_nki:
    v_lshlrev_b32 v96, 16, v116
    v_and_b32 v97, 0xffff0000, v116
    v_lshlrev_b32 v98, 16, v117
    v_and_b32 v99, 0xffff0000, v117
    v_lshlrev_b32 v100, 16, v118
    v_and_b32 v101, 0xffff0000, v118
    v_lshlrev_b32 v102, 16, v119
    v_and_b32 v103, 0xffff0000, v119
    v_sub_f32 v16, v96, v126
    v_sub_f32 v17, v97, v126
    v_sub_f32 v18, v98, v126
    v_sub_f32 v19, v99, v126
    v_sub_f32 v20, v100, v126
    v_sub_f32 v21, v101, v126
    v_sub_f32 v22, v102, v126
    v_sub_f32 v23, v103, v126
    v_mul_f32 v16, v16, v127
    v_mul_f32 v17, v17, v127
    v_mul_f32 v18, v18, v127
    v_mul_f32 v19, v19, v127
    v_mul_f32 v20, v20, v127
    v_mul_f32 v21, v21, v127
    v_mul_f32 v22, v22, v127
    v_mul_f32 v23, v23, v127
    v_cvt_pk_bf16_f32 v116, v16, v17
    v_cvt_pk_bf16_f32 v117, v18, v19
    v_cvt_pk_bf16_f32 v118, v20, v21
    v_cvt_pk_bf16_f32 v119, v22, v23
    v_lshlrev_b32 v16, 16, v116
    v_and_b32 v17, 0xffff0000, v116
    v_lshlrev_b32 v18, 16, v117
    v_and_b32 v19, 0xffff0000, v117
    v_lshlrev_b32 v20, 16, v118
    v_and_b32 v21, 0xffff0000, v118
    v_lshlrev_b32 v22, 16, v119
    v_and_b32 v23, 0xffff0000, v119
    v_add_f32 v96, v96, v16
    v_add_f32 v97, v97, v17
    v_add_f32 v98, v98, v18
    v_add_f32 v99, v99, v19
    v_add_f32 v100, v100, v20
    v_add_f32 v101, v101, v21
    v_add_f32 v102, v102, v22
    v_add_f32 v103, v103, v23
    v_cvt_pk_bf16_f32 v116, v96, v97
    v_cvt_pk_bf16_f32 v117, v98, v99
    v_cvt_pk_bf16_f32 v118, v100, v101
    v_cvt_pk_bf16_f32 v119, v102, v103
    s_lshl_b32 s44, s37, 5
    v_lshl_add_u32 v12, v7, 4, s44
    v_lshl_add_u32 v12, v125, 10, v12
    v_permlane32_swap_b32 v116, v118
    v_permlane32_swap_b32 v117, v119
    v_mov_b32 v82, 156160
    s_cmp_lg_u32 s24, 0
    s_cbranch_scc1 L_l1_kw
    s_mov_b32 s29, 65536
    s_branch L_l1_pb_w
L_l1_pb:
L_l1_pb_l:
    global_load_dwordx4 v[76:79], v80, s[10:11] sc0 sc1
L_l1_pb_w:
    s_waitcnt vmcnt(0)
    v_cmp_ne_u32 vcc, s31, v79
    s_sub_u32 s29, s29, 1
    s_cbranch_vccz L_l1_pb_ok
    s_cbranch_scc0 L_l1_pb
L_l1_pb_ok:
    v_mov_b32 v81, v76
    s_nop 1
    v_max_u32_dpp v81, v81, v81 quad_perm:[1,0,3,2] row_mask:0xf bank_mask:0xf
    s_nop 1
    v_max_u32_dpp v81, v81, v81 quad_perm:[2,3,0,1] row_mask:0xf bank_mask:0xf
    s_nop 1
    v_max_u32_dpp v81, v81, v81 row_half_mirror row_mask:0xf bank_mask:0xf
    s_nop 1
    v_max_u32_dpp v81, v81, v81 row_mirror row_mask:0xf bank_mask:0xf
    v_mov_b32 v83, v81
    s_nop 1
    v_permlane16_swap_b32 v81, v83
    v_max_u32 v81, v81, v83
    v_cmp_eq_u32 vcc, v81, v76
    s_mov_b64 exec, vcc
    ds_write_b96 v82, v[76:78]
    s_mov_b64 exec, -1
L_l1_kw:
    s_waitcnt lgkmcnt(0)
    s_barrier
    ds_read_b96 v[76:78], v82
    s_waitcnt lgkmcnt(0)
    v_readfirstlane_b32 s38, v76
    v_readfirstlane_b32 s60, v77
    v_readfirstlane_b32 s61, v78
    s_and_b32 s62, s38, 0xffff0000
    s_and_b32 s38, s38, 0x7ff
    s_sub_u32 s38, 2047, s38
    s_ashr_i32 s44, s62, 31
    s_not_b32 s44, s44
    s_or_b32 s44, s44, 0x80000000
    s_xor_b32 s62, s62, s44
    s_and_b32 s62, s62, 0xffff0000
    s_cmp_eq_u32 s38, s100
    s_cselect_b32 s30, 1, 0
    s_cmp_eq_u32 s38, s101
    s_cselect_b32 s30, 2, s30
    s_cmp_lg_u32 s30, 0
    s_cbranch_scc1 L_hit
    s_lshr_b32 s44, s38, 4
    s_lshl_b32 s44, s44, 14
    s_and_b32 s45, s38, 15
    s_lshl_b32 s45, s45, 4
    s_add_u32 s44, s44, s45
    s_cmp_ge_u32 s2, 224
    s_cbranch_scc1 L_l1_frow
    s_lshl_b32 s45, s24, 11
    s_add_u32 s44, s44, s45
    v_and_b32 v80, 48, v1
    v_lshl_add_u32 v80, v80, 4, s44
    v_add_u32 v81, 0x400, v80
    s_branch L_l1_rowld
L_l1_frow:
    s_sub_u32 s45, s2, 224
    s_lshl_b32 s45, s45, 9
    s_add_u32 s44, s44, s45
    v_bfe_u32 v80, v1, 3, 1
    v_lshl_add_u32 v80, v80, 8, s44
    v_mov_b32 v81, v80
L_l1_rowld:
    global_load_dwordx4 v[84:87], v80, s[58:59] sc1
    global_load_dwordx4 v[88:91], v81, s[58:59] sc1
    v_cmp_ne_u32 vcc, s38, v125
    s_and_saveexec_b64 s[42:43], vcc
    global_store_dwordx4 v12, v[116:119], s[20:21]
    s_mov_b64 exec, -1
    v_mov_b32 v78, s60
    v_mul_f32 v78, s61, v78
    v_and_b32 v80, 48, v1
    s_lshl_b32 s44, s24, 6
    s_add_u32 s44, s44, 156416
    v_add_u32 v80, s44, v80
    v_lshrrev_b32 v81, 4, v0
    v_mul_u32_u24 v81, 14336, v81
    v_and_b32 v82, 15, v0
    v_lshl_add_u32 v81, v82, 2, v81
    s_lshl_b32 s42, s3, 6
    s_add_u32 s42, s42, 0x1100000
    v_add_u32 v81, s42, v81
    v_and_b32 v82, 15, v1
    v_lshlrev_b32 v82, 2, v82
    v_add_u32 v82, 156416, v82
    v_accvgpr_read_b32 v96, a120
    v_accvgpr_read_b32 v97, a121
    v_accvgpr_read_b32 v98, a122
    v_accvgpr_read_b32 v99, a123
    v_accvgpr_read_b32 v100, a124
    v_accvgpr_read_b32 v101, a125
    v_accvgpr_read_b32 v102, a126
    v_accvgpr_read_b32 v103, a127
    v_lshlrev_b32 v96, 16, v96
    v_lshlrev_b32 v97, 16, v97
    v_lshlrev_b32 v98, 16, v98
    v_lshlrev_b32 v99, 16, v99
    v_lshlrev_b32 v100, 16, v100
    v_lshlrev_b32 v101, 16, v101
    v_lshlrev_b32 v102, 16, v102
    v_lshlrev_b32 v103, 16, v103
    s_waitcnt vmcnt(1)
    s_cmp_ge_u32 s2, 224
    s_cbranch_scc1 L_l1_s1skip
    v_lshlrev_b32 v92, 16, v84
    v_and_b32 v93, 0xffff0000, v84
    v_fma_f32 v92, v92, s61, -v78
    v_fma_f32 v93, v93, s61, -v78
    v_cvt_pk_bf16_f32 v84, v92, v93
    v_lshlrev_b32 v94, 16, v85
    v_and_b32 v95, 0xffff0000, v85
    v_fma_f32 v94, v94, s61, -v78
    v_fma_f32 v95, v95, s61, -v78
    v_cvt_pk_bf16_f32 v85, v94, v95
    v_lshlrev_b32 v92, 16, v86
    v_and_b32 v93, 0xffff0000, v86
    v_fma_f32 v92, v92, s61, -v78
    v_fma_f32 v93, v93, s61, -v78
    v_cvt_pk_bf16_f32 v86, v92, v93
    v_lshlrev_b32 v94, 16, v87
    v_and_b32 v95, 0xffff0000, v87
    v_fma_f32 v94, v94, s61, -v78
    v_fma_f32 v95, v95, s61, -v78
    v_cvt_pk_bf16_f32 v87, v94, v95
    v_lshlrev_b32 v92, 16, v88
    v_and_b32 v93, 0xffff0000, v88
    v_fma_f32 v92, v92, s61, -v78
    v_fma_f32 v93, v93, s61, -v78
    v_cvt_pk_bf16_f32 v88, v92, v93
    v_lshlrev_b32 v94, 16, v89
    v_and_b32 v95, 0xffff0000, v89
    v_fma_f32 v94, v94, s61, -v78
    v_fma_f32 v95, v95, s61, -v78
    v_cvt_pk_bf16_f32 v89, v94, v95
    v_lshlrev_b32 v92, 16, v90
    v_and_b32 v93, 0xffff0000, v90
    v_fma_f32 v92, v92, s61, -v78
    v_fma_f32 v93, v93, s61, -v78
    v_cvt_pk_bf16_f32 v90, v92, v93
    v_lshlrev_b32 v94, 16, v91
    v_and_b32 v95, 0xffff0000, v91
    v_fma_f32 v94, v94, s61, -v78
    v_fma_f32 v95, v95, s61, -v78
    v_cvt_pk_bf16_f32 v91, v94, v95
    s_nop 1
    v_mfma_f32_16x16x32_bf16 v[92:95], a[112:115], v[84:87], 0
    v_mfma_f32_16x16x32_bf16 v[92:95], a[116:119], v[88:91], v[92:95]
    s_mov_b32 exec_lo, 0x00010001
    s_mov_b32 exec_hi, 0x00010001
    s_nop 5
    ds_write_b128 v80, v[92:95]
    s_mov_b64 exec, -1
    s_waitcnt lgkmcnt(0)
    s_barrier
L_l1_s1skip:
    s_cmp_ge_u32 s2, 224
    s_cbranch_scc1 L_l1_s2skip
    ds_read_b32 v84, v82 offset:0
    ds_read_b32 v85, v82 offset:64
    ds_read_b32 v86, v82 offset:128
    ds_read_b32 v87, v82 offset:192
    ds_read_b32 v88, v82 offset:256
    ds_read_b32 v89, v82 offset:320
    ds_read_b32 v90, v82 offset:384
    ds_read_b32 v91, v82 offset:448
    s_waitcnt lgkmcnt(0)
    v_add_f32 v84, v84, v85
    v_add_f32 v86, v86, v87
    v_add_f32 v88, v88, v89
    v_add_f32 v90, v90, v91
    v_add_f32 v84, v84, v86
    v_add_f32 v88, v88, v90
    v_add_f32 v84, v84, v88
    v_cvt_pk_bf16_f32 v84, v84, v84
    v_and_b32 v84, 0xffff0000, v84
    v_mul_f32 v76, 0xbfb8aa3b, v84
    v_exp_f32 v76, v76
    s_nop 0
    v_add_f32 v76, 1.0, v76
    v_rcp_f32 v76, v76
    s_nop 0
    v_mul_f32 v76, v76, v84
    v_cvt_pk_bf16_f32 v76, v76, v76
    v_and_b32 v76, 0xffff0000, v76
    s_nop 1
    v_mul_f32_dpp v76, v84, v76 row_ror:8 row_mask:0xf bank_mask:0xf
    v_cvt_pk_bf16_f32 v76, v76, v76
    v_and_b32 v76, 0xffff0000, v76
    s_nop 0
    v_readlane_b32 s44, v76, 0
    v_readlane_b32 s45, v76, 1
    v_readlane_b32 s46, v76, 2
    v_readlane_b32 s47, v76, 3
    v_readlane_b32 s48, v76, 4
    v_readlane_b32 s49, v76, 5
    v_readlane_b32 s50, v76, 6
    v_readlane_b32 s51, v76, 7
    v_mul_f32 v78, s44, v96
    v_mul_f32 v79, s45, v97
    v_fmac_f32 v78, s46, v98
    v_fmac_f32 v79, s47, v99
    v_fmac_f32 v78, s48, v100
    v_fmac_f32 v79, s49, v101
    v_fmac_f32 v78, s50, v102
    v_fmac_f32 v79, s51, v103
    v_add_f32 v78, v78, v79
    v_min_u32 v84, 0xfffffffe, v78
    s_nop 0
    s_nop 0
    v_mov_b32_dpp v85, v84 quad_perm:[1,1,1,1] row_mask:0xf bank_mask:0xf
    v_mov_b32_dpp v86, v84 quad_perm:[2,2,2,2] row_mask:0xf bank_mask:0xf
    v_mov_b32_dpp v87, v84 quad_perm:[3,3,3,3] row_mask:0xf bank_mask:0xf
    s_mov_b32 exec_lo, 0x11111111
    s_mov_b32 exec_hi, 0x11111111
    global_store_dwordx4 v81, v[84:87], s[10:11] sc0 sc1
    s_mov_b64 exec, -1
L_l1_s2skip:
    s_cmp_lt_u32 s2, 224
    s_cbranch_scc1 L_l1_fskip
    v_bfe_u32 v82, v1, 1, 1
    v_cmp_eq_u32 vcc, 1, v82
    v_bfe_u32 v82, v1, 2, 1
    s_nop 0
    v_cndmask_b32 v84, v84, v85, vcc
    v_cndmask_b32 v86, v86, v87, vcc
    v_cmp_eq_u32 vcc, 1, v82
    v_and_b32 v82, 1, v1
    s_nop 0
    v_cndmask_b32 v84, v84, v86, vcc
    v_cmp_eq_u32 vcc, 1, v82
    v_lshlrev_b32 v85, 16, v84
    v_and_b32 v86, 0xffff0000, v84
    v_cndmask_b32 v84, v85, v86, vcc
    s_sub_u32 s44, s2, 224
    s_mul_i32 s45, s44, 14336
    s_add_u32 s45, s45, 0x1100000
    v_min_u32 v88, 447, v0
    v_lshl_add_u32 v88, v88, 4, s45
    v_add_u32 v89, 7168, v88
    s_mov_b64 exec, 1
    s_mov_b32 s29, 65536
L_l1_pl:
L_l1_pl_l:
    global_load_dword v96, v89, s[10:11] sc0 sc1
L_l1_pl_w:
    s_waitcnt vmcnt(0)
    v_cmp_eq_u32 vcc, -1, v96
    s_sub_u32 s29, s29, 1
    s_cbranch_vccz L_l1_pl_ok
    s_cbranch_scc0 L_l1_pl
L_l1_pl_ok:
    s_mov_b64 exec, -1
    s_mov_b32 s29, 65536
L_l1_pf:
L_l1_pf_l:
    global_load_dwordx4 v[96:99], v88, s[10:11] sc0 sc1
    global_load_dwordx4 v[100:103], v89, s[10:11] sc0 sc1
L_l1_pf_w:
    s_waitcnt vmcnt(0)
    v_max3_u32 v92, v96, v97, v98
    v_max3_u32 v92, v92, v99, v100
    v_max3_u32 v92, v92, v101, v102
    v_max_u32 v92, v92, v103
    v_cmp_eq_u32 vcc, -1, v92
    s_sub_u32 s29, s29, 1
    s_cbranch_vccz L_l1_pf_ok
    s_cbranch_scc0 L_l1_pf
L_l1_pf_ok:
    v_add_f32 v96, v96, v100
    v_add_f32 v97, v97, v101
    v_add_f32 v98, v98, v102
    v_add_f32 v99, v99, v103
    s_nop 0
    v_add_f32_dpp v96, v96, v96 row_shr:4 row_mask:0xf bank_mask:0xf bound_ctrl:0
    v_add_f32_dpp v97, v97, v97 row_shr:4 row_mask:0xf bank_mask:0xf bound_ctrl:0
    v_add_f32_dpp v98, v98, v98 row_shr:4 row_mask:0xf bank_mask:0xf bound_ctrl:0
    v_add_f32_dpp v99, v99, v99 row_shr:4 row_mask:0xf bank_mask:0xf bound_ctrl:0
    s_nop 0
    v_add_f32_dpp v96, v96, v96 row_shr:8 row_mask:0xf bank_mask:0xf bound_ctrl:0
    v_add_f32_dpp v97, v97, v97 row_shr:8 row_mask:0xf bank_mask:0xf bound_ctrl:0
    v_add_f32_dpp v98, v98, v98 row_shr:8 row_mask:0xf bank_mask:0xf bound_ctrl:0
    v_add_f32_dpp v99, v99, v99 row_shr:8 row_mask:0xf bank_mask:0xf bound_ctrl:0
    v_mov_b32 v100, v96
    v_mov_b32 v101, v97
    v_mov_b32 v102, v98
    v_mov_b32 v103, v99
    s_nop 0
    v_permlane16_swap_b32 v96, v100
    v_permlane16_swap_b32 v97, v101
    v_permlane16_swap_b32 v98, v102
    v_permlane16_swap_b32 v99, v103
    v_add_f32 v96, v96, v100
    v_add_f32 v97, v97, v101
    v_add_f32 v98, v98, v102
    v_add_f32 v99, v99, v103
    v_mov_b32 v100, v96
    v_mov_b32 v101, v97
    v_mov_b32 v102, v98
    v_mov_b32 v103, v99
    s_nop 0
    v_permlane32_swap_b32 v96, v100
    v_permlane32_swap_b32 v97, v101
    v_permlane32_swap_b32 v98, v102
    v_permlane32_swap_b32 v99, v103
    v_add_f32 v96, v96, v100
    v_add_f32 v97, v97, v101
    v_add_f32 v98, v98, v102
    v_add_f32 v99, v99, v103
    v_and_b32 v92, 3, v1
    s_lshl_b32 s45, s24, 6
    s_add_u32 s45, s45, 156416
    v_lshl_add_u32 v92, v92, 4, s45
    s_mov_b32 exec_lo, 0xf000
    s_mov_b32 exec_hi, 0
    ds_write_b128 v92, v[96:99] offset:0
    s_mov_b64 exec, -1
    v_and_b32 v81, 15, v1
    v_lshlrev_b32 v81, 2, v81
    v_add_u32 v81, 156416, v81
    s_waitcnt lgkmcnt(0)
    s_barrier
    s_cmp_lg_u32 s24, 0
    s_cbranch_scc1 L_l1_fskip
    ds_read_b32 v92, v81 offset:0
    ds_read_b32 v93, v81 offset:64
    ds_read_b32 v94, v81 offset:128
    ds_read_b32 v95, v81 offset:192
    ds_read_b32 v96, v81 offset:256
    ds_read_b32 v97, v81 offset:320
    ds_read_b32 v98, v81 offset:384
    v_mov_b32 v76, 0xbfb8aa3b
    v_mul_f32 v76, s62, v76
    v_exp_f32 v76, v76
    v_subrev_f32 v77, s60, v84
    v_add_f32 v76, 1.0, v76
    v_rcp_f32 v76, v76
    v_mul_f32 v77, s61, v77
    v_cvt_pk_bf16_f32 v76, v76, v76
    v_and_b32 v76, 0xffff0000, v76
    v_cvt_pk_bf16_f32 v77, v77, v77
    v_and_b32 v77, 0xffff0000, v77
    s_waitcnt lgkmcnt(0)
    v_add_f32 v92, v92, v93
    v_add_f32 v94, v94, v95
    v_add_f32 v96, v96, v97
    v_add_f32 v92, v92, v94
    v_add_f32 v96, v96, v98
    v_add_f32 v92, v92, v96
    v_cvt_pk_bf16_f32 v92, v92, v92
    v_and_b32 v92, 0xffff0000, v92
    v_mul_f32 v92, v92, v76
    v_cvt_pk_bf16_f32 v92, v92, v92
    v_and_b32 v92, 0xffff0000, v92
    v_add_f32 v92, v92, v77
    v_cvt_pk_bf16_f32 v92, v92, v92
    v_and_b32 v92, 0xffff0000, v92
    v_add_f32 v92, v92, v84
    v_cvt_pk_bf16_f32 v92, v92, v92
    s_sub_u32 s44, s2, 224
    s_lshl_b32 s45, s38, 10
    s_lshl_b32 s44, s44, 5
    s_add_u32 s44, s44, s45
    v_lshl_add_u32 v80, v1, 1, s44
    s_mov_b32 exec_lo, 0xffff
    s_mov_b32 exec_hi, 0
    global_store_short v80, v92, s[20:21]
    s_mov_b64 exec, -1
L_l1_fskip:
    s_branch L_fdone
L_hit:
    s_cmp_lt_u32 s2, 224
    s_cbranch_scc1 L_hit_out
    s_cmp_eq_u32 s30, 2
    s_mov_b32 s40, 0x1180000
    s_cselect_b32 s40, 0x1200000, s40
    s_sub_u32 s44, s2, 224
    s_mul_i32 s45, s44, 14336
    s_add_u32 s45, s45, s40
    v_min_u32 v20, 447, v0
    v_lshl_add_u32 v20, v20, 4, s45
    v_add_u32 v21, 7168, v20
    s_mov_b32 s29, 65536
L_sg_pf:
L_sg_pf_l:
    global_load_dwordx4 v[28:31], v20, s[10:11] sc0 sc1
    global_load_dwordx4 v[32:35], v21, s[10:11] sc0 sc1
L_sg_pf_w:
    s_waitcnt vmcnt(0)
    v_max3_u32 v24, v28, v29, v30
    v_max3_u32 v24, v24, v31, v32
    v_max3_u32 v24, v24, v33, v34
    v_max_u32 v24, v24, v35
    v_cmp_eq_u32 vcc, -1, v24
    s_sub_u32 s29, s29, 1
    s_cbranch_vccz L_sg_pf_ok
    s_cbranch_scc0 L_sg_pf
L_sg_pf_ok:
    v_add_f32 v28, v28, v32
    v_add_f32 v29, v29, v33
    v_add_f32 v30, v30, v34
    v_add_f32 v31, v31, v35
    s_nop 0
    v_add_f32_dpp v28, v28, v28 row_shr:4 row_mask:0xf bank_mask:0xf bound_ctrl:0
    v_add_f32_dpp v29, v29, v29 row_shr:4 row_mask:0xf bank_mask:0xf bound_ctrl:0
    v_add_f32_dpp v30, v30, v30 row_shr:4 row_mask:0xf bank_mask:0xf bound_ctrl:0
    v_add_f32_dpp v31, v31, v31 row_shr:4 row_mask:0xf bank_mask:0xf bound_ctrl:0
    s_nop 0
    v_add_f32_dpp v28, v28, v28 row_shr:8 row_mask:0xf bank_mask:0xf bound_ctrl:0
    v_add_f32_dpp v29, v29, v29 row_shr:8 row_mask:0xf bank_mask:0xf bound_ctrl:0
    v_add_f32_dpp v30, v30, v30 row_shr:8 row_mask:0xf bank_mask:0xf bound_ctrl:0
    v_add_f32_dpp v31, v31, v31 row_shr:8 row_mask:0xf bank_mask:0xf bound_ctrl:0
    v_mov_b32 v32, v28
    v_mov_b32 v33, v29
    v_mov_b32 v34, v30
    v_mov_b32 v35, v31
    s_nop 0
    v_permlane16_swap_b32 v28, v32
    v_permlane16_swap_b32 v29, v33
    v_permlane16_swap_b32 v30, v34
    v_permlane16_swap_b32 v31, v35
    v_add_f32 v28, v28, v32
    v_add_f32 v29, v29, v33
    v_add_f32 v30, v30, v34
    v_add_f32 v31, v31, v35
    v_mov_b32 v32, v28
    v_mov_b32 v33, v29
    v_mov_b32 v34, v30
    v_mov_b32 v35, v31
    s_nop 0
    v_permlane32_swap_b32 v28, v32
    v_permlane32_swap_b32 v29, v33
    v_permlane32_swap_b32 v30, v34
    v_permlane32_swap_b32 v31, v35
    v_add_f32 v28, v28, v32
    v_add_f32 v29, v29, v33
    v_add_f32 v30, v30, v34
    v_add_f32 v31, v31, v35
    v_and_b32 v24, 3, v1
    s_lshl_b32 s45, s24, 6
    s_add_u32 s45, s45, 152064
    v_lshl_add_u32 v24, v24, 4, s45
    s_mov_b32 exec_lo, 0xf000
    s_mov_b32 exec_hi, 0
    ds_write_b128 v24, v[28:31] offset:0
    s_mov_b64 exec, -1
    v_and_b32 v16, 15, v1
    v_lshlrev_b32 v16, 2, v16
    v_add_u32 v16, 152064, v16
    s_waitcnt lgkmcnt(0)
    s_barrier
    s_cmp_lg_u32 s24, 0
    s_cbranch_scc1 L_hit_out
    v_mov_b32 v17, v56
    s_cmp_eq_u32 s30, 2
    s_cselect_b64 vcc, -1, 0
    v_permlane16_swap_b32 v56, v17
    s_nop 0
    v_cndmask_b32 v56, v56, v17, vcc
    ds_read_b32 v92, v16 offset:0
    ds_read_b32 v93, v16 offset:64
    ds_read_b32 v94, v16 offset:128
    ds_read_b32 v95, v16 offset:192
    ds_read_b32 v96, v16 offset:256
    ds_read_b32 v97, v16 offset:320
    ds_read_b32 v98, v16 offset:384
    v_mov_b32 v76, 0xbfb8aa3b
    v_mul_f32 v76, s62, v76
    v_exp_f32 v76, v76
    v_subrev_f32 v77, s60, v56
    v_add_f32 v76, 1.0, v76
    v_rcp_f32 v76, v76
    v_mul_f32 v77, s61, v77
    v_cvt_pk_bf16_f32 v76, v76, v76
    v_and_b32 v76, 0xffff0000, v76
    v_cvt_pk_bf16_f32 v77, v77, v77
    v_and_b32 v77, 0xffff0000, v77
    s_waitcnt lgkmcnt(0)
    v_add_f32 v92, v92, v93
    v_add_f32 v94, v94, v95
    v_add_f32 v96, v96, v97
    v_add_f32 v92, v92, v94
    v_add_f32 v96, v96, v98
    v_add_f32 v92, v92, v96
    v_cvt_pk_bf16_f32 v92, v92, v92
    v_and_b32 v92, 0xffff0000, v92
    v_mul_f32 v92, v92, v76
    v_cvt_pk_bf16_f32 v92, v92, v92
    v_and_b32 v92, 0xffff0000, v92
    v_add_f32 v92, v92, v77
    v_cvt_pk_bf16_f32 v92, v92, v92
    v_and_b32 v92, 0xffff0000, v92
    v_add_f32 v92, v92, v56
    v_cvt_pk_bf16_f32 v92, v92, v92
    s_sub_u32 s44, s2, 224
    s_lshl_b32 s45, s38, 10
    s_lshl_b32 s44, s44, 5
    s_add_u32 s44, s44, s45
    v_lshl_add_u32 v80, v1, 1, s44
    s_mov_b32 exec_lo, 0xffff
    s_mov_b32 exec_hi, 0
    global_store_short v80, v92, s[20:21]
    s_mov_b64 exec, -1
L_hit_out:
    v_cmp_ne_u32 vcc, s38, v125
    s_and_saveexec_b64 s[42:43], vcc
    global_store_dwordx4 v12, v[116:119], s[20:21]
    s_mov_b64 exec, -1
L_fdone:
    s_cmp_lg_u32 s2, 0
    s_cbranch_scc1 L_end
    v_mov_b32 v12, 0x12a2000
    v_mov_b32 v13, s31
    v_cmp_eq_u32 vcc, 0, v0
    s_and_saveexec_b64 s[42:43], vcc
    s_cbranch_execz L_end
    global_store_dword v12, v13, s[10:11] sc0 sc1
L_end:
L_exit:
    s_endpgm

.section .rodata,"a"
.p2align 6
.amdhsa_kernel interleave_layers__softmax_full_mha__moe_arch_mod__prompt_kernel
  .amdhsa_next_free_vgpr 256
  .amdhsa_next_free_sgpr 102
  .amdhsa_accum_offset 128
  .amdhsa_group_segment_fixed_size 0
  .amdhsa_kernarg_size 88
  .amdhsa_user_sgpr_count 2
  .amdhsa_user_sgpr_kernarg_segment_ptr 1
  .amdhsa_system_sgpr_workgroup_id_x 1
.end_amdhsa_kernel
```
